```python
import torch

def _softmax(x, axis=-1):
    return torch.softmax(x, dim=axis)

def _gelu(x):
    return torch.nn.functional.gelu(x, approximate='tanh')

def _silu(x):
    return torch.nn.functional.silu(x)

def _sigmoid(x):
    return torch.sigmoid(x)

def _layernorm(x, axis=-1, eps=1e-05):
    m = x.mean(dim=axis, keepdim=True)
    v = x.var(dim=axis, keepdim=True, unbiased=False)
    return (x - m) / torch.sqrt(v + eps)

def _scatter_add(tgt, idx, src, axis=0):
    return tgt.clone().index_add_(axis, idx, src)

def _segment_sum(src, seg, n):
    out = torch.zeros((n,) + src.shape[1:], dtype=src.dtype)
    return out.index_add_(0, seg, src)

def _pad(x, pw):
    flat = tuple((v for pair in reversed(pw) for v in pair))
    return torch.nn.functional.pad(x, flat)
kernel_name = 'parallel_sum__memory_aug_recurrent_mem_tr__dense_activation_squared_relu__prompt'

def setup_inputs():

    _w = lambda a: (lambda t: t.to(torch.bfloat16) if t.is_floating_point() else t)(torch.as_tensor(a))

    def _A_setup():
        B, S, Dm = (1, 2048, 448)
        H, Dh = (16, 256)
        M, seg = (8, 32)
        seg = min(seg, S)
        S = S // seg * seg
        return {'x': _w((lambda *s: torch.randn(*s, dtype=torch.bfloat16) * 0.05)(B, S, Dm)), 'mem0': _w((lambda *s: torch.randn(*s, dtype=torch.bfloat16) * 1.6)(B, M, Dm)), 'Wq': _w((lambda *s: torch.randn(*s, dtype=torch.bfloat16) * 0.8)(Dm, H, Dh) * Dm ** (-0.5)), 'Wk': _w((lambda *s: torch.randn(*s, dtype=torch.bfloat16) * 0.8)(Dm, H, Dh) * Dm ** (-0.5)), 'Wv': _w((lambda *s: torch.randn(*s, dtype=torch.bfloat16) * 1.6)(Dm, H, Dh) * Dm ** (-0.5)), 'Wo': _w((lambda *s: torch.randn(*s, dtype=torch.bfloat16) * 1.6)(H, Dh, Dm) * (H * Dh) ** (-0.5)), 'seg_len': seg}
    _A_in = _A_setup()

    def _B_setup():
        B, S, D, F = (1, 2048, 448, 1792)
        return {'x': _w((lambda *s: torch.randn(*s, dtype=torch.bfloat16) * 0.05)(B, S, D)), 'w1': _w((lambda *s: torch.randn(*s, dtype=torch.bfloat16) * 0.05)(D, F)), 'b1': _w((lambda *s: torch.randn(*s, dtype=torch.bfloat16) * 0.4)(F)), 'w2': _w((lambda *s: torch.randn(*s, dtype=torch.bfloat16) * 0.05)(F, D)), 'b2': _w((lambda *s: torch.randn(*s, dtype=torch.bfloat16) * 0.8)(D))}
    _B_in = _B_setup()
    return {'A_x': _A_in['x'], 'A_mem0': _A_in['mem0'], 'A_Wq': _A_in['Wq'], 'A_Wk': _A_in['Wk'], 'A_Wv': _A_in['Wv'], 'A_Wo': _A_in['Wo'], 'A_seg_len': _A_in['seg_len'], 'B_x': _B_in['x'], 'B_w1': _B_in['w1'], 'B_b1': _B_in['b1'], 'B_w2': _B_in['w2'], 'B_b2': _B_in['b2']}

def reference(A_x, A_mem0, A_Wq, A_Wk, A_Wv, A_Wo, A_seg_len, B_x, B_w1, B_b1, B_w2, B_b2):

    def _A_ref(x, mem0, Wq, Wk, Wv, Wo, seg_len):
        B, S, Dm = x.shape
        H, Dh = (Wq.shape[1], Wq.shape[2])
        M = mem0.shape[1]
        scale = Dh ** (-0.5)
        n_seg = S // seg_len
        L = M + seg_len
        idx = torch.arange(L)
        mask = (idx[:, None] < M) | (idx[:, None] >= idx[None, :])
        mem = mem0
        outs = []
        for s in range(n_seg):
            xs = x[:, s * seg_len:(s + 1) * seg_len, :].clone()
            h = torch.concatenate([mem, xs], axis=1)
            q = torch.einsum('btd,dhe->bhte', h, Wq)
            k = torch.einsum('btd,dhe->bhte', h, Wk)
            v = torch.einsum('btd,dhe->bhte', h, Wv)
            scores = torch.einsum('bhqe,bhke->bhqk', q, k) * scale
            scores = torch.where(mask[None, None], scores, -1000000000.0)
            p = _softmax(scores, axis=-1)
            o = torch.einsum('bhqk,bhke->bhqe', p, v)
            o = torch.einsum('bhte,hed->btd', o, Wo)
            mem = o[:, :M, :].clone()
            outs.append(o[:, M:, :])
        return torch.concatenate(outs, axis=1)

    def _B_ref(x, w1, b1, w2, b2):
        h = torch.einsum('bsd,df->bsf', x, w1) + b1
        zero = torch.zeros_like(h)
        r = torch.where(h > zero, h, zero)
        h = r * r
        out = torch.einsum('bsf,fd->bsd', h, w2) + b2
        return out
    x = A_x
    xn = _layernorm(x, axis=-1)
    return x + _A_ref(xn, A_mem0, A_Wq, A_Wk, A_Wv, A_Wo, A_seg_len) + _B_ref(xn, B_w1, B_b1, B_w2, B_b2)
```

```asm
; @launch grid=(256,1,1) block=(256,1,1) lds=163840
.amdgcn_target "amdgcn-amd-amdhsa--gfx950"
.text
.globl parallel_sum__memory_aug_recurrent_mem_tr__dense_activation_squared_relu__prompt_kernel
.p2align 8
.type parallel_sum__memory_aug_recurrent_mem_tr__dense_activation_squared_relu__prompt_kernel,@function
parallel_sum__memory_aug_recurrent_mem_tr__dense_activation_squared_relu__prompt_kernel:
    s_cmp_ge_u32 s2, 256
    s_cbranch_scc1 K2_exit
    s_load_dwordx8 s[44:51], s[0:1], 16
    s_load_dwordx4 s[40:43], s[0:1], 0
    s_load_dwordx8 s[52:59], s[0:1], 64
    s_load_dwordx4 s[72:75], s[0:1], 96
    s_load_dwordx2 s[38:39], s[0:1], 112
    s_getpc_b64 s[28:29]
    s_lshr_b32 s30, s2, 3
    s_and_b32 s30, s30, 1
    s_lshl_b32 s30, s30, 15
    v_lshlrev_b32 v14, 7, v0
    v_add_u32 v14, s30, v14
    v_min_u32 v14, K2_exit-P0_here, v14
P0_here:
    v_mov_b32 v15, s29
    v_add_co_u32 v14, vcc, s28, v14
    s_nop 1
    v_addc_co_u32 v15, vcc, 0, v15, vcc
    global_load_dword v253, v[14:15], off
    s_getreg_b32 s3, hwreg(HW_REG_XCC_ID)
    v_lshrrev_b32 v2, 6, v0
    v_and_b32 v1, 63, v0
    s_sub_u32 s3, s3, 3
    s_and_b32 s3, s3, 7
    s_mov_b32 s26, s3
    v_readfirstlane_b32 s24, v2
    s_mov_b32 s27, 32768
    s_and_b32 s28, s2, 7
    s_xor_b32 s28, s28, 4
    s_lshl_b32 s30, s28, 2
    s_lshr_b32 s31, s2, 3
    s_and_b32 s31, s31, 3
    s_add_u32 s30, s30, s31
    s_and_b32 s31, s30, 15
    s_lshr_b32 s32, s2, 5
    s_and_b32 s33, s32, 1
    s_lshr_b32 s34, s32, 1
    s_mul_i32 s35, s33, 7
    s_add_u32 s35, s35, s24
    v_and_b32 v2, 15, v1
    v_lshrrev_b32 v3, 4, v1
    v_lshlrev_b32 v4, 4, v1
    v_lshrrev_b32 v10, 5, v1
    v_and_b32 v11, 31, v1
    v_lshlrev_b32 v12, 13, v10
    v_add_u32 v13, 0, v10
    v_xor_b32 v13, v13, v11
    v_lshl_add_u32 v16, v13, 4, v12
    v_add_u32 v13, 2, v10
    v_xor_b32 v13, v13, v11
    v_lshl_add_u32 v17, v13, 4, v12
    v_add_u32 v13, 4, v10
    v_xor_b32 v13, v13, v11
    v_lshl_add_u32 v18, v13, 4, v12
    v_add_u32 v13, 6, v10
    v_xor_b32 v13, v13, v11
    v_lshl_add_u32 v19, v13, 4, v12
    v_add_u32 v13, 8, v10
    v_xor_b32 v13, v13, v11
    v_lshl_add_u32 v20, v13, 4, v12
    v_add_u32 v13, 10, v10
    v_xor_b32 v13, v13, v11
    v_lshl_add_u32 v21, v13, 4, v12
    v_add_u32 v13, 12, v10
    v_xor_b32 v13, v13, v11
    v_lshl_add_u32 v22, v13, 4, v12
    v_add_u32 v13, 14, v10
    v_xor_b32 v13, v13, v11
    v_lshl_add_u32 v23, v13, 4, v12
    s_lshl_b32 s61, s31, 9
    s_mov_b32 s66, 3670016
    s_mov_b32 s67, 0x20000
    s_mov_b32 s70, 3670016
    s_mov_b32 s71, 0x20000
    s_lshl_b32 s60, s35, 18
    s_add_u32 s60, s60, s61
    s_lshl_b32 s62, s24, 15
    s_xor_b32 s29, s33, 1
    s_cmp_ge_u32 s30, 16
    s_cbranch_scc1 P0_cB
    s_lshl_b32 s28, s24, 1
    s_add_u32 s28, s28, s33
    s_lshl_b32 s13, s28, 10
    s_add_u32 s13, s13, 98304
    s_lshl_b32 s28, s28, 1
    v_add_u32 v13, s28, v10
    v_xor_b32 v14, v13, v11
    v_lshl_add_u32 v24, v14, 4, v12
    s_mul_i32 s12, s34, 112
    s_add_u32 s12, s12, s28
    s_lshl_b32 s12, s12, 13
    s_add_u32 s12, s12, s61
    s_lshl_b32 s28, s24, 1
    s_add_u32 s28, s28, s29
    s_lshl_b32 s15, s28, 10
    s_add_u32 s15, s15, 98304
    s_lshl_b32 s28, s28, 1
    v_add_u32 v13, s28, v10
    v_xor_b32 v14, v13, v11
    v_lshl_add_u32 v25, v14, 4, v12
    s_mul_i32 s14, s34, 112
    s_add_u32 s14, s14, s28
    s_lshl_b32 s14, s14, 13
    s_add_u32 s14, s14, s61
    v_mov_b32 v26, 0
    v_mov_b32 v27, 0
    v_mov_b32 v28, 0
    v_mov_b32 v29, 0
    v_mov_b32 v30, 0
    s_waitcnt lgkmcnt(0)
    s_mov_b32 s64, s44
    s_mov_b32 s65, s45
    s_mov_b32 s68, s46
    s_mov_b32 s69, s47
    s_branch P0_cset
P0_cB:
    s_mov_b32 s28, 0x12492493
    v_add_u32 v13, 0, v1
    v_mul_hi_u32 v14, s28, v13
    v_mul_u32_u24 v15, 14, v14
    v_sub_u32 v15, v13, v15
    v_mul_u32_u24 v14, 896, v14
    v_lshl_add_u32 v24, v15, 4, v14
    v_add_u32 v13, 64, v1
    v_mul_hi_u32 v14, s28, v13
    v_mul_u32_u24 v15, 14, v14
    v_sub_u32 v15, v13, v15
    v_mul_u32_u24 v14, 896, v14
    v_lshl_add_u32 v25, v15, 4, v14
    v_add_u32 v13, 128, v1
    v_mul_hi_u32 v14, s28, v13
    v_mul_u32_u24 v15, 14, v14
    v_sub_u32 v15, v13, v15
    v_mul_u32_u24 v14, 896, v14
    v_lshl_add_u32 v26, v15, 4, v14
    v_add_u32 v13, 192, v1
    v_mul_hi_u32 v14, s28, v13
    v_mul_u32_u24 v15, 14, v14
    v_sub_u32 v15, v13, v15
    v_mul_u32_u24 v14, 896, v14
    v_lshl_add_u32 v27, v15, 4, v14
    v_add_u32 v13, 256, v1
    v_mul_hi_u32 v14, s28, v13
    v_mul_u32_u24 v15, 14, v14
    v_sub_u32 v15, v13, v15
    v_mul_u32_u24 v14, 896, v14
    v_lshl_add_u32 v28, v15, 4, v14
    v_add_u32 v13, 320, v1
    v_mul_hi_u32 v14, s28, v13
    v_mul_u32_u24 v15, 14, v14
    v_sub_u32 v15, v13, v15
    v_mul_u32_u24 v14, 896, v14
    v_lshl_add_u32 v29, v15, 4, v14
    v_add_u32 v13, 384, v1
    v_mul_hi_u32 v14, s28, v13
    v_mul_u32_u24 v15, 14, v14
    v_sub_u32 v15, v13, v15
    v_mul_u32_u24 v14, 896, v14
    v_lshl_add_u32 v30, v15, 4, v14
    s_lshl_b32 s28, s24, 1
    s_add_u32 s28, s28, s33
    s_mul_i32 s13, s28, 7168
    s_add_u32 s13, s13, 98304
    s_mul_i32 s12, s28, 28672
    s_mul_i32 s28, s31, 229376
    s_add_u32 s12, s12, s28
    s_mul_i32 s28, s34, 224
    s_add_u32 s12, s12, s28
    s_lshl_b32 s28, s24, 1
    s_add_u32 s28, s28, s29
    s_mul_i32 s15, s28, 7168
    s_add_u32 s15, s15, 98304
    s_mul_i32 s14, s28, 28672
    s_mul_i32 s28, s31, 229376
    s_add_u32 s14, s14, s28
    s_mul_i32 s28, s34, 224
    s_add_u32 s14, s14, s28
    s_waitcnt lgkmcnt(0)
    s_mov_b32 s64, s48
    s_mov_b32 s65, s49
    s_mov_b32 s68, s50
    s_mov_b32 s69, s51
P0_cset:
    s_mov_b32 s8, s40
    s_mov_b32 s9, s41
    s_mov_b32 s10, 1835008
    s_mov_b32 s11, 0x20000
    s_cmp_lg_u32 s24, 3
    s_cbranch_scc1 P0_nox
    v_and_b32 v7, 7, v1
    s_lshl_b32 s28, s2, 3
    v_add_u32 v7, s28, v7
    v_mul_u32_u24 v5, 896, v7
    v_lshrrev_b32 v6, 3, v1
    v_lshl_add_u32 v5, v6, 5, v5
    v_cmp_gt_u32 vcc, 32, v1
    v_mov_b32 v6, 0x7ffffff0
    s_nop 0
    v_cndmask_b32 v6, v6, v5, vcc
    buffer_load_dwordx4 v[200:203], v5, s[8:11], 0 offen offset:0
    buffer_load_dwordx4 v[204:207], v5, s[8:11], 0 offen offset:16
    buffer_load_dwordx4 v[208:211], v5, s[8:11], 0 offen offset:256
    buffer_load_dwordx4 v[212:215], v5, s[8:11], 0 offen offset:272
    buffer_load_dwordx4 v[216:219], v5, s[8:11], 0 offen offset:512
    buffer_load_dwordx4 v[220:223], v5, s[8:11], 0 offen offset:528
    buffer_load_dwordx4 v[224:227], v6, s[8:11], 0 offen offset:768
    buffer_load_dwordx4 v[228:231], v6, s[8:11], 0 offen offset:784
P0_nox:
    s_cmp_ge_u32 s30, 16
    s_cbranch_scc1 Lp0_1
    s_add_u32 m0, s13, 0
    s_add_u32 s63, s12, 0
    buffer_load_dwordx4 v24, s[68:71], s63 offen  lds
    s_add_u32 m0, s13, 8192
    s_add_u32 s63, s12, 131072
    buffer_load_dwordx4 v24, s[68:71], s63 offen  lds
    s_add_u32 m0, s13, 16384
    s_add_u32 s63, s12, 262144
    buffer_load_dwordx4 v24, s[68:71], s63 offen  lds
    s_add_u32 m0, s13, 24576
    s_add_u32 s63, s12, 393216
    buffer_load_dwordx4 v24, s[68:71], s63 offen  lds
    s_add_u32 m0, s13, 32768
    s_add_u32 s63, s12, 524288
    buffer_load_dwordx4 v24, s[68:71], s63 offen  lds
    s_add_u32 m0, s13, 40960
    s_add_u32 s63, s12, 655360
    buffer_load_dwordx4 v24, s[68:71], s63 offen  lds
    s_add_u32 m0, s13, 49152
    s_add_u32 s63, s12, 786432
    buffer_load_dwordx4 v24, s[68:71], s63 offen  lds
    s_add_u32 m0, s15, 0
    s_add_u32 s63, s14, 0
    buffer_load_dwordx4 v25, s[68:71], s63 offen  lds
    s_add_u32 m0, s15, 8192
    s_add_u32 s63, s14, 131072
    buffer_load_dwordx4 v25, s[68:71], s63 offen  lds
    s_add_u32 m0, s15, 16384
    s_add_u32 s63, s14, 262144
    buffer_load_dwordx4 v25, s[68:71], s63 offen  lds
    s_add_u32 m0, s15, 24576
    s_add_u32 s63, s14, 393216
    buffer_load_dwordx4 v25, s[68:71], s63 offen  lds
    s_add_u32 m0, s15, 32768
    s_add_u32 s63, s14, 524288
    buffer_load_dwordx4 v25, s[68:71], s63 offen  lds
    s_add_u32 m0, s15, 40960
    s_add_u32 s63, s14, 655360
    buffer_load_dwordx4 v25, s[68:71], s63 offen  lds
    s_add_u32 m0, s15, 49152
    s_add_u32 s63, s14, 786432
    buffer_load_dwordx4 v25, s[68:71], s63 offen  lds
    s_branch Lp0_2
Lp0_1:
    s_add_u32 m0, s13, 0
    s_nop 0
    buffer_load_dwordx4 v24, s[68:71], s12 offen  lds
    s_add_u32 m0, s13, 1024
    s_nop 0
    buffer_load_dwordx4 v25, s[68:71], s12 offen  lds
    s_add_u32 m0, s13, 2048
    s_nop 0
    buffer_load_dwordx4 v26, s[68:71], s12 offen  lds
    s_add_u32 m0, s13, 3072
    s_nop 0
    buffer_load_dwordx4 v27, s[68:71], s12 offen  lds
    s_add_u32 m0, s13, 4096
    s_nop 0
    buffer_load_dwordx4 v28, s[68:71], s12 offen  lds
    s_add_u32 m0, s13, 5120
    s_nop 0
    buffer_load_dwordx4 v29, s[68:71], s12 offen  lds
    s_add_u32 m0, s13, 6144
    s_nop 0
    buffer_load_dwordx4 v30, s[68:71], s12 offen  lds
    s_add_u32 m0, s15, 0
    s_nop 0
    buffer_load_dwordx4 v24, s[68:71], s14 offen  lds
    s_add_u32 m0, s15, 1024
    s_nop 0
    buffer_load_dwordx4 v25, s[68:71], s14 offen  lds
    s_add_u32 m0, s15, 2048
    s_nop 0
    buffer_load_dwordx4 v26, s[68:71], s14 offen  lds
    s_add_u32 m0, s15, 3072
    s_nop 0
    buffer_load_dwordx4 v27, s[68:71], s14 offen  lds
    s_add_u32 m0, s15, 4096
    s_nop 0
    buffer_load_dwordx4 v28, s[68:71], s14 offen  lds
    s_add_u32 m0, s15, 5120
    s_nop 0
    buffer_load_dwordx4 v29, s[68:71], s14 offen  lds
    s_add_u32 m0, s15, 6144
    s_nop 0
    buffer_load_dwordx4 v30, s[68:71], s14 offen  lds
Lp0_2:
    s_cmp_eq_u32 s24, 3
    s_cbranch_scc1 P0_d3
    s_add_u32 m0, s62, 0
    s_add_u32 s63, s60, 0
    buffer_load_dwordx4 v16, s[64:67], s63 offen  lds
    s_add_u32 m0, s62, 1024
    s_add_u32 s63, s60, 16384
    buffer_load_dwordx4 v17, s[64:67], s63 offen  lds
    s_add_u32 m0, s62, 2048
    s_add_u32 s63, s60, 32768
    buffer_load_dwordx4 v18, s[64:67], s63 offen  lds
    s_add_u32 m0, s62, 3072
    s_add_u32 s63, s60, 49152
    buffer_load_dwordx4 v19, s[64:67], s63 offen  lds
    s_add_u32 m0, s62, 4096
    s_add_u32 s63, s60, 131072
    buffer_load_dwordx4 v20, s[64:67], s63 offen  lds
    s_add_u32 m0, s62, 5120
    s_add_u32 s63, s60, 147456
    buffer_load_dwordx4 v21, s[64:67], s63 offen  lds
    s_add_u32 m0, s62, 6144
    s_add_u32 s63, s60, 163840
    buffer_load_dwordx4 v22, s[64:67], s63 offen  lds
    s_add_u32 m0, s62, 7168
    s_add_u32 s63, s60, 180224
    buffer_load_dwordx4 v23, s[64:67], s63 offen  lds
    s_add_u32 m0, s62, 8192
    s_add_u32 s63, s60, 65536
    buffer_load_dwordx4 v16, s[64:67], s63 offen  lds
    s_add_u32 m0, s62, 9216
    s_add_u32 s63, s60, 81920
    buffer_load_dwordx4 v17, s[64:67], s63 offen  lds
    s_add_u32 m0, s62, 10240
    s_add_u32 s63, s60, 98304
    buffer_load_dwordx4 v18, s[64:67], s63 offen  lds
    s_add_u32 m0, s62, 11264
    s_add_u32 s63, s60, 114688
    buffer_load_dwordx4 v19, s[64:67], s63 offen  lds
    s_add_u32 m0, s62, 12288
    s_add_u32 s63, s60, 196608
    buffer_load_dwordx4 v20, s[64:67], s63 offen  lds
    s_add_u32 m0, s62, 13312
    s_add_u32 s63, s60, 212992
    buffer_load_dwordx4 v21, s[64:67], s63 offen  lds
    s_add_u32 m0, s62, 14336
    s_add_u32 s63, s60, 229376
    buffer_load_dwordx4 v22, s[64:67], s63 offen  lds
    s_add_u32 m0, s62, 15360
    s_add_u32 s63, s60, 245760
    buffer_load_dwordx4 v23, s[64:67], s63 offen  lds
    s_add_u32 m0, s62, 16384
    s_add_u32 s63, s60, 1048576
    buffer_load_dwordx4 v16, s[64:67], s63 offen  lds
    s_add_u32 m0, s62, 17408
    s_add_u32 s63, s60, 1064960
    buffer_load_dwordx4 v17, s[64:67], s63 offen  lds
    s_add_u32 m0, s62, 18432
    s_add_u32 s63, s60, 1081344
    buffer_load_dwordx4 v18, s[64:67], s63 offen  lds
    s_add_u32 m0, s62, 19456
    s_add_u32 s63, s60, 1097728
    buffer_load_dwordx4 v19, s[64:67], s63 offen  lds
    s_add_u32 m0, s62, 20480
    s_add_u32 s63, s60, 1179648
    buffer_load_dwordx4 v20, s[64:67], s63 offen  lds
    s_add_u32 m0, s62, 21504
    s_add_u32 s63, s60, 1196032
    buffer_load_dwordx4 v21, s[64:67], s63 offen  lds
    s_add_u32 m0, s62, 22528
    s_add_u32 s63, s60, 1212416
    buffer_load_dwordx4 v22, s[64:67], s63 offen  lds
    s_add_u32 m0, s62, 23552
    s_add_u32 s63, s60, 1228800
    buffer_load_dwordx4 v23, s[64:67], s63 offen  lds
    s_add_u32 m0, s62, 24576
    s_add_u32 s63, s60, 1114112
    buffer_load_dwordx4 v16, s[64:67], s63 offen  lds
    s_add_u32 m0, s62, 25600
    s_add_u32 s63, s60, 1130496
    buffer_load_dwordx4 v17, s[64:67], s63 offen  lds
    s_add_u32 m0, s62, 26624
    s_add_u32 s63, s60, 1146880
    buffer_load_dwordx4 v18, s[64:67], s63 offen  lds
    s_add_u32 m0, s62, 27648
    s_add_u32 s63, s60, 1163264
    buffer_load_dwordx4 v19, s[64:67], s63 offen  lds
    s_add_u32 m0, s62, 28672
    s_add_u32 s63, s60, 1245184
    buffer_load_dwordx4 v20, s[64:67], s63 offen  lds
    s_add_u32 m0, s62, 29696
    s_add_u32 s63, s60, 1261568
    buffer_load_dwordx4 v21, s[64:67], s63 offen  lds
    s_add_u32 m0, s62, 30720
    s_add_u32 s63, s60, 1277952
    buffer_load_dwordx4 v22, s[64:67], s63 offen  lds
    s_add_u32 m0, s62, 31744
    s_add_u32 s63, s60, 1294336
    buffer_load_dwordx4 v23, s[64:67], s63 offen  lds
    s_branch P0_srd
P0_d3:
    s_add_u32 s63, s60, 0
    buffer_load_dwordx4 a[128:131], v16, s[64:67], s63 offen
    s_add_u32 s63, s60, 16384
    buffer_load_dwordx4 a[132:135], v17, s[64:67], s63 offen
    s_add_u32 s63, s60, 32768
    buffer_load_dwordx4 a[136:139], v18, s[64:67], s63 offen
    s_add_u32 s63, s60, 49152
    buffer_load_dwordx4 a[140:143], v19, s[64:67], s63 offen
    s_add_u32 s63, s60, 131072
    buffer_load_dwordx4 a[144:147], v20, s[64:67], s63 offen
    s_add_u32 s63, s60, 147456
    buffer_load_dwordx4 a[148:151], v21, s[64:67], s63 offen
    s_add_u32 s63, s60, 163840
    buffer_load_dwordx4 a[152:155], v22, s[64:67], s63 offen
    s_add_u32 s63, s60, 180224
    buffer_load_dwordx4 a[156:159], v23, s[64:67], s63 offen
    s_add_u32 s63, s60, 65536
    buffer_load_dwordx4 a[160:163], v16, s[64:67], s63 offen
    s_add_u32 s63, s60, 81920
    buffer_load_dwordx4 a[164:167], v17, s[64:67], s63 offen
    s_add_u32 s63, s60, 98304
    buffer_load_dwordx4 a[168:171], v18, s[64:67], s63 offen
    s_add_u32 s63, s60, 114688
    buffer_load_dwordx4 a[172:175], v19, s[64:67], s63 offen
    s_add_u32 s63, s60, 196608
    buffer_load_dwordx4 a[176:179], v20, s[64:67], s63 offen
    s_add_u32 s63, s60, 212992
    buffer_load_dwordx4 a[180:183], v21, s[64:67], s63 offen
    s_add_u32 s63, s60, 229376
    buffer_load_dwordx4 a[184:187], v22, s[64:67], s63 offen
    s_add_u32 s63, s60, 245760
    buffer_load_dwordx4 a[188:191], v23, s[64:67], s63 offen
    s_mov_b32 s62, 155648
P0_srd:
    s_mov_b32 s4, s38
    s_mov_b32 s5, s39
    s_mov_b32 s6, 268435456
    s_mov_b32 s7, 0x20000
    s_mov_b32 s8, s72
    s_mov_b32 s9, s73
    s_mov_b32 s10, 1835008
    s_mov_b32 s11, 0x20000
    s_mov_b32 s12, s40
    s_mov_b32 s13, s41
    s_mov_b32 s14, 1835008
    s_mov_b32 s15, 0x20000
    s_mov_b32 s16, s54
    s_mov_b32 s17, s55
    s_mov_b32 s18, 3584
    s_mov_b32 s19, 0x20000
    s_mov_b32 s20, s58
    s_mov_b32 s21, s59
    s_mov_b32 s22, 896
    s_mov_b32 s23, 0x20000
    s_mov_b32 s76, s42
    s_mov_b32 s77, s43
    s_mov_b32 s78, 7168
    s_mov_b32 s79, 0x20000
    s_mov_b32 s80, s74
    s_mov_b32 s81, s75
    s_mov_b32 s82, 256
    s_mov_b32 s83, 0x20000
    s_mov_b32 s40, s52
    s_mov_b32 s41, s53
    s_mov_b32 s42, 1605632
    s_mov_b32 s43, 0x20000
    s_mov_b32 s44, s56
    s_mov_b32 s45, s57
    s_mov_b32 s46, 1605632
    s_mov_b32 s47, 0x20000
    s_cmp_lg_u32 s24, 3
    s_cbranch_scc1 P0_gemm
    v_mov_b32 v5, 0
    s_lshl_b32 s28, s3, 5
    v_mov_b32 v254, 1
    s_mov_b64 exec, 1
    buffer_atomic_add v254, v5, s[80:83], s28 offen sc0
    s_mov_b64 exec, -1
    s_and_b32 s28, s2, 63
    s_lshl_b32 s28, s28, 7
    v_mov_b32 v6, s28
    v_mov_b32 v5, 65536
    v_cmp_le_u32 vcc, 32, v1
    s_mov_b32 s28, 72941568
    s_nop 0
    v_cndmask_b32 v5, v5, v6, vcc
    buffer_load_dword v255, v5, s[4:7], s28 offen sc1
    v_bfe_u32 v5, v1, 2, 2
    v_and_b32 v6, 1, v1
    v_lshl_add_u32 v5, v5, 1, v6
    v_mul_u32_u24 v5, 896, v5
    v_lshl_add_u32 v5, v3, 5, v5
    v_bfe_u32 v6, v1, 1, 1
    v_lshl_add_u32 v5, v6, 4, v5
    s_min_u32 s36, s2, 6
    s_lshl_b32 s37, s36, 7
    buffer_load_dwordx4 v[232:235], v5, s[76:79], s37 offen
    v_and_b32 v5, 7, v1
    v_mul_u32_u24 v5, 896, v5
    v_lshl_add_u32 v5, v3, 5, v5
    v_bfe_u32 v6, v1, 3, 1
    v_lshl_add_u32 v5, v6, 3, v5
    buffer_load_dwordx2 v[236:237], v5, s[76:79], s37 offen
    buffer_load_dwordx2 v[238:239], v5, s[76:79], s37 offen offset:16
P0_gemm:
    v_lshrrev_b32 v8, 2, v2
    v_and_b32 v9, 3, v2
    v_xor_b32 v9, v9, v3
    v_lshlrev_b32 v9, 4, v9
    v_lshl_add_u32 v9, v2, 9, v9
    v_xor_b32 v10, 0, v8
    v_lshl_add_u32 v10, v10, 6, v9
    v_add_u32 v12, s62, v10
    v_add_u32 v16, 98304, v10
    v_xor_b32 v10, 1, v8
    v_lshl_add_u32 v10, v10, 6, v9
    v_add_u32 v13, s62, v10
    v_add_u32 v17, 98304, v10
    v_xor_b32 v10, 2, v8
    v_lshl_add_u32 v10, v10, 6, v9
    v_add_u32 v14, s62, v10
    v_add_u32 v18, 98304, v10
    v_xor_b32 v10, 3, v8
    v_lshl_add_u32 v10, v10, 6, v9
    v_add_u32 v15, s62, v10
    v_add_u32 v19, 98304, v10
    v_lshl_add_u32 v20, v3, 3, v8
    v_mul_u32_u24 v20, 224, v20
    v_and_b32 v10, 3, v2
    v_lshl_add_u32 v20, v10, 3, v20
    v_add_u32 v20, 98304, v20
    v_add_u32 v21, 155648, v4
    v_mul_u32_u24 v22, 7168, v3
    v_lshl_add_u32 v22, v2, 4, v22
    s_mul_i32 s85, s30, 401408
    s_mul_i32 s28, s35, 28672
    s_add_u32 s85, s85, s28
    s_mul_i32 s28, s34, 1792
    s_add_u32 s85, s85, s28
    s_add_u32 s85, s85, 2097152
    s_add_u32 s84, s85, 114688
    s_mov_b32 s87, 0x3db8aa3b
    s_cmp_eq_u32 s24, 3
    s_cbranch_scc1 P0_w3
    s_waitcnt vmcnt(24)
    ds_read_b128 a[0:3], v12 offset:0
    ds_read_b128 a[4:7], v13 offset:0
    ds_read_b128 a[8:11], v14 offset:0
    ds_read_b128 a[12:15], v15 offset:0
    ds_read_b128 a[16:19], v12 offset:256
    ds_read_b128 a[20:23], v13 offset:256
    ds_read_b128 a[24:27], v14 offset:256
    ds_read_b128 a[28:31], v15 offset:256
    s_waitcnt vmcnt(16)
    ds_read_b128 a[32:35], v12 offset:8192
    ds_read_b128 a[36:39], v13 offset:8192
    ds_read_b128 a[40:43], v14 offset:8192
    ds_read_b128 a[44:47], v15 offset:8192
    ds_read_b128 a[48:51], v12 offset:8448
    ds_read_b128 a[52:55], v13 offset:8448
    ds_read_b128 a[56:59], v14 offset:8448
    ds_read_b128 a[60:63], v15 offset:8448
    s_waitcnt vmcnt(8)
    ds_read_b128 a[64:67], v12 offset:16384
    ds_read_b128 a[68:71], v13 offset:16384
    ds_read_b128 a[72:75], v14 offset:16384
    ds_read_b128 a[76:79], v15 offset:16384
    ds_read_b128 a[80:83], v12 offset:16640
    ds_read_b128 a[84:87], v13 offset:16640
    ds_read_b128 a[88:91], v14 offset:16640
    ds_read_b128 a[92:95], v15 offset:16640
    s_waitcnt vmcnt(0)
    ds_read_b128 a[96:99], v12 offset:24576
    ds_read_b128 a[100:103], v13 offset:24576
    ds_read_b128 a[104:107], v14 offset:24576
    ds_read_b128 a[108:111], v15 offset:24576
    ds_read_b128 a[112:115], v12 offset:24832
    ds_read_b128 a[116:119], v13 offset:24832
    ds_read_b128 a[120:123], v14 offset:24832
    ds_read_b128 a[124:127], v15 offset:24832
    s_barrier
    s_cmp_ge_u32 s30, 16
    s_cbranch_scc1 P0_g21
    s_branch P0_g20
P0_w3:
    s_waitcnt vmcnt(35)
    v_lshlrev_b32 v100, 16, v200
    v_and_b32 v101, 0xffff0000, v200
    v_lshlrev_b32 v102, 16, v201
    v_and_b32 v103, 0xffff0000, v201
    v_lshlrev_b32 v104, 16, v202
    v_and_b32 v105, 0xffff0000, v202
    v_lshlrev_b32 v106, 16, v203
    v_and_b32 v107, 0xffff0000, v203
    v_lshlrev_b32 v108, 16, v204
    v_and_b32 v109, 0xffff0000, v204
    v_lshlrev_b32 v110, 16, v205
    v_and_b32 v111, 0xffff0000, v205
    v_lshlrev_b32 v112, 16, v206
    v_and_b32 v113, 0xffff0000, v206
    v_lshlrev_b32 v114, 16, v207
    v_and_b32 v115, 0xffff0000, v207
    v_lshlrev_b32 v116, 16, v208
    v_and_b32 v117, 0xffff0000, v208
    v_lshlrev_b32 v118, 16, v209
    v_and_b32 v119, 0xffff0000, v209
    v_lshlrev_b32 v120, 16, v210
    v_and_b32 v121, 0xffff0000, v210
    v_lshlrev_b32 v122, 16, v211
    v_and_b32 v123, 0xffff0000, v211
    v_lshlrev_b32 v124, 16, v212
    v_and_b32 v125, 0xffff0000, v212
    v_lshlrev_b32 v126, 16, v213
    v_and_b32 v127, 0xffff0000, v213
    v_lshlrev_b32 v128, 16, v214
    v_and_b32 v129, 0xffff0000, v214
    v_lshlrev_b32 v130, 16, v215
    v_and_b32 v131, 0xffff0000, v215
    v_lshlrev_b32 v132, 16, v216
    v_and_b32 v133, 0xffff0000, v216
    v_lshlrev_b32 v134, 16, v217
    v_and_b32 v135, 0xffff0000, v217
    v_lshlrev_b32 v136, 16, v218
    v_and_b32 v137, 0xffff0000, v218
    v_lshlrev_b32 v138, 16, v219
    v_and_b32 v139, 0xffff0000, v219
    v_lshlrev_b32 v140, 16, v220
    v_and_b32 v141, 0xffff0000, v220
    v_lshlrev_b32 v142, 16, v221
    v_and_b32 v143, 0xffff0000, v221
    v_lshlrev_b32 v144, 16, v222
    v_and_b32 v145, 0xffff0000, v222
    v_lshlrev_b32 v146, 16, v223
    v_and_b32 v147, 0xffff0000, v223
    v_lshlrev_b32 v148, 16, v224
    v_and_b32 v149, 0xffff0000, v224
    v_lshlrev_b32 v150, 16, v225
    v_and_b32 v151, 0xffff0000, v225
    v_lshlrev_b32 v152, 16, v226
    v_and_b32 v153, 0xffff0000, v226
    v_lshlrev_b32 v154, 16, v227
    v_and_b32 v155, 0xffff0000, v227
    v_lshlrev_b32 v156, 16, v228
    v_and_b32 v157, 0xffff0000, v228
    v_lshlrev_b32 v158, 16, v229
    v_and_b32 v159, 0xffff0000, v229
    v_lshlrev_b32 v160, 16, v230
    v_and_b32 v161, 0xffff0000, v230
    v_lshlrev_b32 v162, 16, v231
    v_and_b32 v163, 0xffff0000, v231
    v_add_f32 v170, v100, v101
    v_add_f32 v171, v102, v103
    v_add_f32 v170, v170, v104
    v_add_f32 v171, v171, v105
    v_add_f32 v170, v170, v106
    v_add_f32 v171, v171, v107
    v_add_f32 v170, v170, v108
    v_add_f32 v171, v171, v109
    v_add_f32 v170, v170, v110
    v_add_f32 v171, v171, v111
    v_add_f32 v170, v170, v112
    v_add_f32 v171, v171, v113
    v_add_f32 v170, v170, v114
    v_add_f32 v171, v171, v115
    v_add_f32 v170, v170, v116
    v_add_f32 v171, v171, v117
    v_add_f32 v170, v170, v118
    v_add_f32 v171, v171, v119
    v_add_f32 v170, v170, v120
    v_add_f32 v171, v171, v121
    v_add_f32 v170, v170, v122
    v_add_f32 v171, v171, v123
    v_add_f32 v170, v170, v124
    v_add_f32 v171, v171, v125
    v_add_f32 v170, v170, v126
    v_add_f32 v171, v171, v127
    v_add_f32 v170, v170, v128
    v_add_f32 v171, v171, v129
    v_add_f32 v170, v170, v130
    v_add_f32 v171, v171, v131
    v_add_f32 v170, v170, v132
    v_add_f32 v171, v171, v133
    v_add_f32 v170, v170, v134
    v_add_f32 v171, v171, v135
    v_add_f32 v170, v170, v136
    v_add_f32 v171, v171, v137
    v_add_f32 v170, v170, v138
    v_add_f32 v171, v171, v139
    v_add_f32 v170, v170, v140
    v_add_f32 v171, v171, v141
    v_add_f32 v170, v170, v142
    v_add_f32 v171, v171, v143
    v_add_f32 v170, v170, v144
    v_add_f32 v171, v171, v145
    v_add_f32 v170, v170, v146
    v_add_f32 v171, v171, v147
    v_add_f32 v170, v170, v148
    v_add_f32 v171, v171, v149
    v_add_f32 v170, v170, v150
    v_add_f32 v171, v171, v151
    v_add_f32 v170, v170, v152
    v_add_f32 v171, v171, v153
    v_add_f32 v170, v170, v154
    v_add_f32 v171, v171, v155
    v_add_f32 v170, v170, v156
    v_add_f32 v171, v171, v157
    v_add_f32 v170, v170, v158
    v_add_f32 v171, v171, v159
    v_add_f32 v170, v170, v160
    v_add_f32 v171, v171, v161
    v_add_f32 v170, v170, v162
    v_add_f32 v171, v171, v163
    v_add_f32 v170, v170, v171
    s_nop 1
    v_add_f32_dpp v170, v170, v170 row_ror:8 row_mask:0xf bank_mask:0xf
    v_mov_b32 v177, v170
    s_nop 1
    v_permlane16_swap_b32 v170, v177
    v_add_f32 v170, v170, v177
    v_mov_b32 v177, v170
    s_nop 1
    v_permlane32_swap_b32 v170, v177
    v_add_f32 v170, v170, v177
    v_mul_f32 v170, 0x3b124925, v170
    v_mov_b32 v172, 0
    v_mov_b32 v173, 0
    v_sub_f32 v174, v100, v170
    v_sub_f32 v175, v101, v170
    v_fmac_f32 v172, v174, v174
    v_fmac_f32 v173, v175, v175
    v_sub_f32 v174, v102, v170
    v_sub_f32 v175, v103, v170
    v_fmac_f32 v172, v174, v174
    v_fmac_f32 v173, v175, v175
    v_sub_f32 v174, v104, v170
    v_sub_f32 v175, v105, v170
    v_fmac_f32 v172, v174, v174
    v_fmac_f32 v173, v175, v175
    v_sub_f32 v174, v106, v170
    v_sub_f32 v175, v107, v170
    v_fmac_f32 v172, v174, v174
    v_fmac_f32 v173, v175, v175
    v_sub_f32 v174, v108, v170
    v_sub_f32 v175, v109, v170
    v_fmac_f32 v172, v174, v174
    v_fmac_f32 v173, v175, v175
    v_sub_f32 v174, v110, v170
    v_sub_f32 v175, v111, v170
    v_fmac_f32 v172, v174, v174
    v_fmac_f32 v173, v175, v175
    v_sub_f32 v174, v112, v170
    v_sub_f32 v175, v113, v170
    v_fmac_f32 v172, v174, v174
    v_fmac_f32 v173, v175, v175
    v_sub_f32 v174, v114, v170
    v_sub_f32 v175, v115, v170
    v_fmac_f32 v172, v174, v174
    v_fmac_f32 v173, v175, v175
    v_sub_f32 v174, v116, v170
    v_sub_f32 v175, v117, v170
    v_fmac_f32 v172, v174, v174
    v_fmac_f32 v173, v175, v175
    v_sub_f32 v174, v118, v170
    v_sub_f32 v175, v119, v170
    v_fmac_f32 v172, v174, v174
    v_fmac_f32 v173, v175, v175
    v_sub_f32 v174, v120, v170
    v_sub_f32 v175, v121, v170
    v_fmac_f32 v172, v174, v174
    v_fmac_f32 v173, v175, v175
    v_sub_f32 v174, v122, v170
    v_sub_f32 v175, v123, v170
    v_fmac_f32 v172, v174, v174
    v_fmac_f32 v173, v175, v175
    v_sub_f32 v174, v124, v170
    v_sub_f32 v175, v125, v170
    v_fmac_f32 v172, v174, v174
    v_fmac_f32 v173, v175, v175
    v_sub_f32 v174, v126, v170
    v_sub_f32 v175, v127, v170
    v_fmac_f32 v172, v174, v174
    v_fmac_f32 v173, v175, v175
    v_sub_f32 v174, v128, v170
    v_sub_f32 v175, v129, v170
    v_fmac_f32 v172, v174, v174
    v_fmac_f32 v173, v175, v175
    v_sub_f32 v174, v130, v170
    v_sub_f32 v175, v131, v170
    v_fmac_f32 v172, v174, v174
    v_fmac_f32 v173, v175, v175
    v_sub_f32 v174, v132, v170
    v_sub_f32 v175, v133, v170
    v_fmac_f32 v172, v174, v174
    v_fmac_f32 v173, v175, v175
    v_sub_f32 v174, v134, v170
    v_sub_f32 v175, v135, v170
    v_fmac_f32 v172, v174, v174
    v_fmac_f32 v173, v175, v175
    v_sub_f32 v174, v136, v170
    v_sub_f32 v175, v137, v170
    v_fmac_f32 v172, v174, v174
    v_fmac_f32 v173, v175, v175
    v_sub_f32 v174, v138, v170
    v_sub_f32 v175, v139, v170
    v_fmac_f32 v172, v174, v174
    v_fmac_f32 v173, v175, v175
    v_sub_f32 v174, v140, v170
    v_sub_f32 v175, v141, v170
    v_fmac_f32 v172, v174, v174
    v_fmac_f32 v173, v175, v175
    v_sub_f32 v174, v142, v170
    v_sub_f32 v175, v143, v170
    v_fmac_f32 v172, v174, v174
    v_fmac_f32 v173, v175, v175
    v_sub_f32 v174, v144, v170
    v_sub_f32 v175, v145, v170
    v_fmac_f32 v172, v174, v174
    v_fmac_f32 v173, v175, v175
    v_sub_f32 v174, v146, v170
    v_sub_f32 v175, v147, v170
    v_fmac_f32 v172, v174, v174
    v_fmac_f32 v173, v175, v175
    s_mov_b32 exec_hi, 0
    v_sub_f32 v174, v148, v170
    v_sub_f32 v175, v149, v170
    v_fmac_f32 v172, v174, v174
    v_fmac_f32 v173, v175, v175
    v_sub_f32 v174, v150, v170
    v_sub_f32 v175, v151, v170
    v_fmac_f32 v172, v174, v174
    v_fmac_f32 v173, v175, v175
    v_sub_f32 v174, v152, v170
    v_sub_f32 v175, v153, v170
    v_fmac_f32 v172, v174, v174
    v_fmac_f32 v173, v175, v175
    v_sub_f32 v174, v154, v170
    v_sub_f32 v175, v155, v170
    v_fmac_f32 v172, v174, v174
    v_fmac_f32 v173, v175, v175
    v_sub_f32 v174, v156, v170
    v_sub_f32 v175, v157, v170
    v_fmac_f32 v172, v174, v174
    v_fmac_f32 v173, v175, v175
    v_sub_f32 v174, v158, v170
    v_sub_f32 v175, v159, v170
    v_fmac_f32 v172, v174, v174
    v_fmac_f32 v173, v175, v175
    v_sub_f32 v174, v160, v170
    v_sub_f32 v175, v161, v170
    v_fmac_f32 v172, v174, v174
    v_fmac_f32 v173, v175, v175
    v_sub_f32 v174, v162, v170
    v_sub_f32 v175, v163, v170
    v_fmac_f32 v172, v174, v174
    v_fmac_f32 v173, v175, v175
    s_mov_b64 exec, -1
    v_add_f32 v172, v172, v173
    s_nop 1
    v_add_f32_dpp v172, v172, v172 row_ror:8 row_mask:0xf bank_mask:0xf
    v_mov_b32 v177, v172
    s_nop 1
    v_permlane16_swap_b32 v172, v177
    v_add_f32 v172, v172, v177
    v_mov_b32 v177, v172
    s_nop 1
    v_permlane32_swap_b32 v172, v177
    v_add_f32 v172, v172, v177
    v_mul_f32 v172, 0x3b124925, v172
    v_cvt_pk_bf16_f32 v176, v170, v172
    v_lshlrev_b32 v170, 16, v176
    v_and_b32 v172, 0xffff0000, v176
    v_add_f32 v172, 0x3727c5ac, v172
    v_cvt_pk_bf16_f32 v172, v172, v172
    v_and_b32 v172, 0xffff0000, v172
    v_sqrt_f32 v172, v172
    s_nop 0
    v_cvt_pk_bf16_f32 v172, v172, v172
    v_and_b32 v172, 0xffff0000, v172
    v_rcp_f32 v172, v172
    s_nop 0
    v_sub_f32 v174, v100, v170
    v_sub_f32 v175, v101, v170
    v_cvt_pk_bf16_f32 v176, v174, v175
    v_lshlrev_b32 v174, 16, v176
    v_and_b32 v175, 0xffff0000, v176
    v_mul_f32 v174, v174, v172
    v_mul_f32 v175, v175, v172
    v_cvt_pk_bf16_f32 v200, v174, v175
    v_sub_f32 v174, v102, v170
    v_sub_f32 v175, v103, v170
    v_cvt_pk_bf16_f32 v176, v174, v175
    v_lshlrev_b32 v174, 16, v176
    v_and_b32 v175, 0xffff0000, v176
    v_mul_f32 v174, v174, v172
    v_mul_f32 v175, v175, v172
    v_cvt_pk_bf16_f32 v202, v174, v175
    v_sub_f32 v174, v104, v170
    v_sub_f32 v175, v105, v170
    v_cvt_pk_bf16_f32 v176, v174, v175
    v_lshlrev_b32 v174, 16, v176
    v_and_b32 v175, 0xffff0000, v176
    v_mul_f32 v174, v174, v172
    v_mul_f32 v175, v175, v172
    v_cvt_pk_bf16_f32 v204, v174, v175
    v_sub_f32 v174, v106, v170
    v_sub_f32 v175, v107, v170
    v_cvt_pk_bf16_f32 v176, v174, v175
    v_lshlrev_b32 v174, 16, v176
    v_and_b32 v175, 0xffff0000, v176
    v_mul_f32 v174, v174, v172
    v_mul_f32 v175, v175, v172
    v_cvt_pk_bf16_f32 v206, v174, v175
    v_sub_f32 v174, v108, v170
    v_sub_f32 v175, v109, v170
    v_cvt_pk_bf16_f32 v176, v174, v175
    v_lshlrev_b32 v174, 16, v176
    v_and_b32 v175, 0xffff0000, v176
    v_mul_f32 v174, v174, v172
    v_mul_f32 v175, v175, v172
    v_cvt_pk_bf16_f32 v201, v174, v175
    v_sub_f32 v174, v110, v170
    v_sub_f32 v175, v111, v170
    v_cvt_pk_bf16_f32 v176, v174, v175
    v_lshlrev_b32 v174, 16, v176
    v_and_b32 v175, 0xffff0000, v176
    v_mul_f32 v174, v174, v172
    v_mul_f32 v175, v175, v172
    v_cvt_pk_bf16_f32 v203, v174, v175
    v_sub_f32 v174, v112, v170
    v_sub_f32 v175, v113, v170
    v_cvt_pk_bf16_f32 v176, v174, v175
    v_lshlrev_b32 v174, 16, v176
    v_and_b32 v175, 0xffff0000, v176
    v_mul_f32 v174, v174, v172
    v_mul_f32 v175, v175, v172
    v_cvt_pk_bf16_f32 v205, v174, v175
    v_sub_f32 v174, v114, v170
    v_sub_f32 v175, v115, v170
    v_cvt_pk_bf16_f32 v176, v174, v175
    v_lshlrev_b32 v174, 16, v176
    v_and_b32 v175, 0xffff0000, v176
    v_mul_f32 v174, v174, v172
    v_mul_f32 v175, v175, v172
    v_cvt_pk_bf16_f32 v207, v174, v175
    v_sub_f32 v174, v116, v170
    v_sub_f32 v175, v117, v170
    v_cvt_pk_bf16_f32 v176, v174, v175
    v_lshlrev_b32 v174, 16, v176
    v_and_b32 v175, 0xffff0000, v176
    v_mul_f32 v174, v174, v172
    v_mul_f32 v175, v175, v172
    v_cvt_pk_bf16_f32 v208, v174, v175
    v_sub_f32 v174, v118, v170
    v_sub_f32 v175, v119, v170
    v_cvt_pk_bf16_f32 v176, v174, v175
    v_lshlrev_b32 v174, 16, v176
    v_and_b32 v175, 0xffff0000, v176
    v_mul_f32 v174, v174, v172
    v_mul_f32 v175, v175, v172
    v_cvt_pk_bf16_f32 v210, v174, v175
    v_sub_f32 v174, v120, v170
    v_sub_f32 v175, v121, v170
    v_cvt_pk_bf16_f32 v176, v174, v175
    v_lshlrev_b32 v174, 16, v176
    v_and_b32 v175, 0xffff0000, v176
    v_mul_f32 v174, v174, v172
    v_mul_f32 v175, v175, v172
    v_cvt_pk_bf16_f32 v212, v174, v175
    v_sub_f32 v174, v122, v170
    v_sub_f32 v175, v123, v170
    v_cvt_pk_bf16_f32 v176, v174, v175
    v_lshlrev_b32 v174, 16, v176
    v_and_b32 v175, 0xffff0000, v176
    v_mul_f32 v174, v174, v172
    v_mul_f32 v175, v175, v172
    v_cvt_pk_bf16_f32 v214, v174, v175
    v_sub_f32 v174, v124, v170
    v_sub_f32 v175, v125, v170
    v_cvt_pk_bf16_f32 v176, v174, v175
    v_lshlrev_b32 v174, 16, v176
    v_and_b32 v175, 0xffff0000, v176
    v_mul_f32 v174, v174, v172
    v_mul_f32 v175, v175, v172
    v_cvt_pk_bf16_f32 v209, v174, v175
    v_sub_f32 v174, v126, v170
    v_sub_f32 v175, v127, v170
    v_cvt_pk_bf16_f32 v176, v174, v175
    v_lshlrev_b32 v174, 16, v176
    v_and_b32 v175, 0xffff0000, v176
    v_mul_f32 v174, v174, v172
    v_mul_f32 v175, v175, v172
    v_cvt_pk_bf16_f32 v211, v174, v175
    v_sub_f32 v174, v128, v170
    v_sub_f32 v175, v129, v170
    v_cvt_pk_bf16_f32 v176, v174, v175
    v_lshlrev_b32 v174, 16, v176
    v_and_b32 v175, 0xffff0000, v176
    v_mul_f32 v174, v174, v172
    v_mul_f32 v175, v175, v172
    v_cvt_pk_bf16_f32 v213, v174, v175
    v_sub_f32 v174, v130, v170
    v_sub_f32 v175, v131, v170
    v_cvt_pk_bf16_f32 v176, v174, v175
    v_lshlrev_b32 v174, 16, v176
    v_and_b32 v175, 0xffff0000, v176
    v_mul_f32 v174, v174, v172
    v_mul_f32 v175, v175, v172
    v_cvt_pk_bf16_f32 v215, v174, v175
    v_sub_f32 v174, v132, v170
    v_sub_f32 v175, v133, v170
    v_cvt_pk_bf16_f32 v176, v174, v175
    v_lshlrev_b32 v174, 16, v176
    v_and_b32 v175, 0xffff0000, v176
    v_mul_f32 v174, v174, v172
    v_mul_f32 v175, v175, v172
    v_cvt_pk_bf16_f32 v216, v174, v175
    v_sub_f32 v174, v134, v170
    v_sub_f32 v175, v135, v170
    v_cvt_pk_bf16_f32 v176, v174, v175
    v_lshlrev_b32 v174, 16, v176
    v_and_b32 v175, 0xffff0000, v176
    v_mul_f32 v174, v174, v172
    v_mul_f32 v175, v175, v172
    v_cvt_pk_bf16_f32 v218, v174, v175
    v_sub_f32 v174, v136, v170
    v_sub_f32 v175, v137, v170
    v_cvt_pk_bf16_f32 v176, v174, v175
    v_lshlrev_b32 v174, 16, v176
    v_and_b32 v175, 0xffff0000, v176
    v_mul_f32 v174, v174, v172
    v_mul_f32 v175, v175, v172
    v_cvt_pk_bf16_f32 v220, v174, v175
    v_sub_f32 v174, v138, v170
    v_sub_f32 v175, v139, v170
    v_cvt_pk_bf16_f32 v176, v174, v175
    v_lshlrev_b32 v174, 16, v176
    v_and_b32 v175, 0xffff0000, v176
    v_mul_f32 v174, v174, v172
    v_mul_f32 v175, v175, v172
    v_cvt_pk_bf16_f32 v222, v174, v175
    v_sub_f32 v174, v140, v170
    v_sub_f32 v175, v141, v170
    v_cvt_pk_bf16_f32 v176, v174, v175
    v_lshlrev_b32 v174, 16, v176
    v_and_b32 v175, 0xffff0000, v176
    v_mul_f32 v174, v174, v172
    v_mul_f32 v175, v175, v172
    v_cvt_pk_bf16_f32 v217, v174, v175
    v_sub_f32 v174, v142, v170
    v_sub_f32 v175, v143, v170
    v_cvt_pk_bf16_f32 v176, v174, v175
    v_lshlrev_b32 v174, 16, v176
    v_and_b32 v175, 0xffff0000, v176
    v_mul_f32 v174, v174, v172
    v_mul_f32 v175, v175, v172
    v_cvt_pk_bf16_f32 v219, v174, v175
    v_sub_f32 v174, v144, v170
    v_sub_f32 v175, v145, v170
    v_cvt_pk_bf16_f32 v176, v174, v175
    v_lshlrev_b32 v174, 16, v176
    v_and_b32 v175, 0xffff0000, v176
    v_mul_f32 v174, v174, v172
    v_mul_f32 v175, v175, v172
    v_cvt_pk_bf16_f32 v221, v174, v175
    v_sub_f32 v174, v146, v170
    v_sub_f32 v175, v147, v170
    v_cvt_pk_bf16_f32 v176, v174, v175
    v_lshlrev_b32 v174, 16, v176
    v_and_b32 v175, 0xffff0000, v176
    v_mul_f32 v174, v174, v172
    v_mul_f32 v175, v175, v172
    v_cvt_pk_bf16_f32 v223, v174, v175
    v_sub_f32 v174, v148, v170
    v_sub_f32 v175, v149, v170
    v_cvt_pk_bf16_f32 v176, v174, v175
    v_lshlrev_b32 v174, 16, v176
    v_and_b32 v175, 0xffff0000, v176
    v_mul_f32 v174, v174, v172
    v_mul_f32 v175, v175, v172
    v_cvt_pk_bf16_f32 v224, v174, v175
    v_sub_f32 v174, v150, v170
    v_sub_f32 v175, v151, v170
    v_cvt_pk_bf16_f32 v176, v174, v175
    v_lshlrev_b32 v174, 16, v176
    v_and_b32 v175, 0xffff0000, v176
    v_mul_f32 v174, v174, v172
    v_mul_f32 v175, v175, v172
    v_cvt_pk_bf16_f32 v226, v174, v175
    v_sub_f32 v174, v152, v170
    v_sub_f32 v175, v153, v170
    v_cvt_pk_bf16_f32 v176, v174, v175
    v_lshlrev_b32 v174, 16, v176
    v_and_b32 v175, 0xffff0000, v176
    v_mul_f32 v174, v174, v172
    v_mul_f32 v175, v175, v172
    v_cvt_pk_bf16_f32 v228, v174, v175
    v_sub_f32 v174, v154, v170
    v_sub_f32 v175, v155, v170
    v_cvt_pk_bf16_f32 v176, v174, v175
    v_lshlrev_b32 v174, 16, v176
    v_and_b32 v175, 0xffff0000, v176
    v_mul_f32 v174, v174, v172
    v_mul_f32 v175, v175, v172
    v_cvt_pk_bf16_f32 v230, v174, v175
    v_sub_f32 v174, v156, v170
    v_sub_f32 v175, v157, v170
    v_cvt_pk_bf16_f32 v176, v174, v175
    v_lshlrev_b32 v174, 16, v176
    v_and_b32 v175, 0xffff0000, v176
    v_mul_f32 v174, v174, v172
    v_mul_f32 v175, v175, v172
    v_cvt_pk_bf16_f32 v225, v174, v175
    v_sub_f32 v174, v158, v170
    v_sub_f32 v175, v159, v170
    v_cvt_pk_bf16_f32 v176, v174, v175
    v_lshlrev_b32 v174, 16, v176
    v_and_b32 v175, 0xffff0000, v176
    v_mul_f32 v174, v174, v172
    v_mul_f32 v175, v175, v172
    v_cvt_pk_bf16_f32 v227, v174, v175
    v_sub_f32 v174, v160, v170
    v_sub_f32 v175, v161, v170
    v_cvt_pk_bf16_f32 v176, v174, v175
    v_lshlrev_b32 v174, 16, v176
    v_and_b32 v175, 0xffff0000, v176
    v_mul_f32 v174, v174, v172
    v_mul_f32 v175, v175, v172
    v_cvt_pk_bf16_f32 v229, v174, v175
    v_sub_f32 v174, v162, v170
    v_sub_f32 v175, v163, v170
    v_cvt_pk_bf16_f32 v176, v174, v175
    v_lshlrev_b32 v174, 16, v176
    v_and_b32 v175, 0xffff0000, v176
    v_mul_f32 v174, v174, v172
    v_mul_f32 v175, v175, v172
    v_cvt_pk_bf16_f32 v231, v174, v175
    v_lshrrev_b32 v5, 4, v7
    v_mul_u32_u24 v5, 14336, v5
    v_and_b32 v6, 15, v7
    v_lshl_add_u32 v5, v6, 4, v5
    v_lshrrev_b32 v6, 3, v1
    v_lshl_add_u32 v5, v6, 9, v5
    s_mov_b32 s28, 0
    buffer_store_dwordx4 v[200:203], v5, s[4:7], s28 offen offset:0 sc1
    buffer_store_dwordx4 v[204:207], v5, s[4:7], s28 offen offset:256 sc1
    s_add_u32 s28, s28, 4096
    buffer_store_dwordx4 v[208:211], v5, s[4:7], s28 offen offset:0 sc1
    buffer_store_dwordx4 v[212:215], v5, s[4:7], s28 offen offset:256 sc1
    s_add_u32 s28, s28, 4096
    buffer_store_dwordx4 v[216:219], v5, s[4:7], s28 offen offset:0 sc1
    buffer_store_dwordx4 v[220:223], v5, s[4:7], s28 offen offset:256 sc1
    s_add_u32 s28, s28, 4096
    s_mov_b32 exec_hi, 0
    buffer_store_dwordx4 v[224:227], v5, s[4:7], s28 offen offset:0 sc1
    buffer_store_dwordx4 v[228:231], v5, s[4:7], s28 offen offset:256 sc1
    s_add_u32 s28, s28, 4096
    s_mov_b64 exec, -1
    s_waitcnt vmcnt(13)
    ds_write_b128 v21, a[128:131] offset:0
    ds_write_b128 v21, a[132:135] offset:1024
    ds_write_b128 v21, a[136:139] offset:2048
    ds_write_b128 v21, a[140:143] offset:3072
    ds_write_b128 v21, a[144:147] offset:4096
    ds_write_b128 v21, a[148:151] offset:5120
    ds_write_b128 v21, a[152:155] offset:6144
    ds_write_b128 v21, a[156:159] offset:7168
    ds_read_b128 a[0:3], v12 offset:0
    ds_read_b128 a[4:7], v13 offset:0
    ds_read_b128 a[8:11], v14 offset:0
    ds_read_b128 a[12:15], v15 offset:0
    ds_read_b128 a[16:19], v12 offset:256
    ds_read_b128 a[20:23], v13 offset:256
    ds_read_b128 a[24:27], v14 offset:256
    ds_read_b128 a[28:31], v15 offset:256
    s_waitcnt lgkmcnt(0)
    ds_write_b128 v21, a[160:163] offset:0
    ds_write_b128 v21, a[164:167] offset:1024
    ds_write_b128 v21, a[168:171] offset:2048
    ds_write_b128 v21, a[172:175] offset:3072
    ds_write_b128 v21, a[176:179] offset:4096
    ds_write_b128 v21, a[180:183] offset:5120
    ds_write_b128 v21, a[184:187] offset:6144
    ds_write_b128 v21, a[188:191] offset:7168
    ds_read_b128 a[32:35], v12 offset:0
    ds_read_b128 a[36:39], v13 offset:0
    ds_read_b128 a[40:43], v14 offset:0
    ds_read_b128 a[44:47], v15 offset:0
    ds_read_b128 a[48:51], v12 offset:256
    ds_read_b128 a[52:55], v13 offset:256
    ds_read_b128 a[56:59], v14 offset:256
    ds_read_b128 a[60:63], v15 offset:256
    s_waitcnt lgkmcnt(0)
    s_barrier
    v_mov_b32 v240, -1
    v_mov_b32 v241, -1
    v_mov_b32 v242, -1
    v_mov_b32 v243, -1
    s_mul_i32 s36, s2, 1792
    s_add_u32 s36, s36, 70261760
    buffer_store_dwordx4 v[240:243], v4, s[4:7], s36 offen sc1
    buffer_store_dwordx4 v[240:243], v4, s[4:7], s36 offen offset:768 sc1
    s_lshl_b32 s36, s2, 9
    s_sub_u32 s37, s2, 32
    s_cmp_lt_u32 s37, 14
    s_cselect_b32 s37, 262144, 0
    s_add_u32 s36, s36, s37
    s_add_u32 s36, s36, 69206016
    v_lshlrev_b32 v5, 3, v1
    buffer_store_dwordx2 v[240:241], v5, s[4:7], s36 offen sc1
    s_mul_i32 s36, s2, 896
    s_add_u32 s36, s36, 62947328
    buffer_store_dwordx4 v[240:243], v4, s[4:7], s36 offen sc1
    s_lshl_b32 s36, s2, 9
    s_add_u32 s36, s36, 65994752
    buffer_store_dwordx2 v[240:241], v5, s[4:7], s36 offen sc1
    s_lshl_b32 s36, s2, 7
    s_add_u32 s36, s36, 66633728
    v_lshlrev_b32 v5, 1, v1
    buffer_store_short v240, v5, s[4:7], s36 offen sc1
    s_lshr_b32 s36, s2, 2
    s_lshl_b32 s36, s36, 13
    s_and_b32 s37, s2, 3
    s_lshl_b32 s37, s37, 9
    s_add_u32 s36, s36, s37
    s_add_u32 s36, s36, 72351744
    v_lshlrev_b32 v5, 3, v1
    buffer_store_dwordx2 v[240:241], v5, s[4:7], s36 offen sc1
    s_waitcnt vmcnt(7)
    s_mov_b64 exec, -1
    s_cmp_ge_u32 s2, 7
    s_cbranch_scc1 P0_nom0
    s_lshl_b32 s37, s2, 10
    s_add_u32 s38, s37, 70254592
    s_add_u32 s37, s37, 69222400
    buffer_store_dwordx4 v[232:235], v4, s[4:7], s37 offen sc1
    buffer_store_dwordx4 v[232:235], v4, s[4:7], s38 offen sc1
    v_swap_b32 v237, v238
    v_lshrrev_b32 v5, 3, v1
    v_lshlrev_b32 v5, 8, v5
    v_and_b32 v6, 7, v1
    v_lshl_add_u32 v5, v6, 4, v5
    s_lshl_b32 s37, s2, 11
    s_add_u32 s37, s37, 1849344
    buffer_store_dwordx4 v[236:239], v5, s[4:7], s37 offen sc1
    buffer_store_dwordx4 v[236:239], v5, s[4:7], s37 offen offset:128 sc1
    s_sub_u32 s37, s37, 14336
    buffer_store_dwordx4 v[236:239], v5, s[4:7], s37 offen sc1
    buffer_store_dwordx4 v[236:239], v5, s[4:7], s37 offen offset:128 sc1
P0_nom0:
    s_cmp_ge_u32 s30, 16
    s_cbranch_scc1 P0_g11
    s_branch P0_g10
.p2align 6
P0_g10:
    ds_read_b128 v[24:27], v16 offset:0
    ds_read_b128 v[28:31], v17 offset:0
    ds_read_b128 v[32:35], v18 offset:0
    ds_read_b128 v[36:39], v19 offset:0
    ds_read_b128 v[40:43], v16 offset:256
    ds_read_b128 v[44:47], v17 offset:256
    ds_read_b128 v[48:51], v18 offset:256
    ds_read_b128 v[52:55], v19 offset:256
    s_waitcnt lgkmcnt(0)
    v_mfma_f32_16x16x32_bf16 v[88:91], a[0:3], v[24:27], 0
    ds_read_b128 v[56:59], v16 offset:8192
    ds_read_b128 v[60:63], v17 offset:8192
    v_mfma_f32_16x16x32_bf16 v[92:95], a[32:35], v[24:27], 0
    ds_read_b128 v[64:67], v18 offset:8192
    ds_read_b128 v[68:71], v19 offset:8192
    v_mfma_f32_16x16x32_bf16 v[88:91], a[4:7], v[28:31], v[88:91]
    ds_read_b128 v[72:75], v16 offset:8448
    ds_read_b128 v[76:79], v17 offset:8448
    v_mfma_f32_16x16x32_bf16 v[92:95], a[36:39], v[28:31], v[92:95]
    ds_read_b128 v[80:83], v18 offset:8448
    ds_read_b128 v[84:87], v19 offset:8448
    v_mfma_f32_16x16x32_bf16 v[88:91], a[8:11], v[32:35], v[88:91]
    v_mfma_f32_16x16x32_bf16 v[92:95], a[40:43], v[32:35], v[92:95]
    v_mfma_f32_16x16x32_bf16 v[88:91], a[12:15], v[36:39], v[88:91]
    v_mfma_f32_16x16x32_bf16 v[92:95], a[44:47], v[36:39], v[92:95]
    v_mfma_f32_16x16x32_bf16 v[88:91], a[16:19], v[40:43], v[88:91]
    v_mfma_f32_16x16x32_bf16 v[92:95], a[48:51], v[40:43], v[92:95]
    v_mfma_f32_16x16x32_bf16 v[88:91], a[20:23], v[44:47], v[88:91]
    v_mfma_f32_16x16x32_bf16 v[92:95], a[52:55], v[44:47], v[92:95]
    v_mfma_f32_16x16x32_bf16 v[88:91], a[24:27], v[48:51], v[88:91]
    v_mfma_f32_16x16x32_bf16 v[92:95], a[56:59], v[48:51], v[92:95]
    v_mfma_f32_16x16x32_bf16 v[88:91], a[28:31], v[52:55], v[88:91]
    v_mfma_f32_16x16x32_bf16 v[92:95], a[60:63], v[52:55], v[92:95]
    s_waitcnt lgkmcnt(0)
    v_mfma_f32_16x16x32_bf16 v[104:107], a[0:3], v[56:59], 0
    ds_read_b128 v[24:27], v16 offset:16384
    ds_read_b128 v[28:31], v17 offset:16384
    v_mfma_f32_16x16x32_bf16 v[108:111], a[32:35], v[56:59], 0
    ds_read_b128 v[32:35], v18 offset:16384
    ds_read_b128 v[36:39], v19 offset:16384
    v_mfma_f32_16x16x32_bf16 v[104:107], a[4:7], v[60:63], v[104:107]
    ds_read_b128 v[40:43], v16 offset:16640
    ds_read_b128 v[44:47], v17 offset:16640
    v_mfma_f32_16x16x32_bf16 v[108:111], a[36:39], v[60:63], v[108:111]
    ds_read_b128 v[48:51], v18 offset:16640
    ds_read_b128 v[52:55], v19 offset:16640
    v_mfma_f32_16x16x32_bf16 v[104:107], a[8:11], v[64:67], v[104:107]
    v_mul_f32 v88, s87, v88
    v_mul_f32 v89, s87, v89
    v_mfma_f32_16x16x32_bf16 v[108:111], a[40:43], v[64:67], v[108:111]
    v_mul_f32 v90, s87, v90
    v_mul_f32 v91, s87, v91
    v_mfma_f32_16x16x32_bf16 v[104:107], a[12:15], v[68:71], v[104:107]
    v_mul_f32 v92, s87, v92
    v_mul_f32 v93, s87, v93
    v_mfma_f32_16x16x32_bf16 v[108:111], a[44:47], v[68:71], v[108:111]
    v_mul_f32 v94, s87, v94
    v_mul_f32 v95, s87, v95
    v_mfma_f32_16x16x32_bf16 v[104:107], a[16:19], v[72:75], v[104:107]
    v_cvt_pk_bf16_f32 v120, v88, v89
    v_cvt_pk_bf16_f32 v121, v92, v93
    v_mfma_f32_16x16x32_bf16 v[108:111], a[48:51], v[72:75], v[108:111]
    v_cvt_pk_bf16_f32 v122, v90, v91
    v_cvt_pk_bf16_f32 v123, v94, v95
    v_mfma_f32_16x16x32_bf16 v[104:107], a[20:23], v[76:79], v[104:107]
    buffer_store_dwordx4 v[120:123], v22, s[4:7], s85 offen offset:0 sc1
    v_mfma_f32_16x16x32_bf16 v[108:111], a[52:55], v[76:79], v[108:111]
    v_mfma_f32_16x16x32_bf16 v[104:107], a[24:27], v[80:83], v[104:107]
    v_mfma_f32_16x16x32_bf16 v[108:111], a[56:59], v[80:83], v[108:111]
    v_mfma_f32_16x16x32_bf16 v[104:107], a[28:31], v[84:87], v[104:107]
    v_mfma_f32_16x16x32_bf16 v[108:111], a[60:63], v[84:87], v[108:111]
    s_waitcnt lgkmcnt(0)
    v_mfma_f32_16x16x32_bf16 v[88:91], a[0:3], v[24:27], 0
    ds_read_b128 v[56:59], v16 offset:24576
    ds_read_b128 v[60:63], v17 offset:24576
    v_mfma_f32_16x16x32_bf16 v[92:95], a[32:35], v[24:27], 0
    ds_read_b128 v[64:67], v18 offset:24576
    ds_read_b128 v[68:71], v19 offset:24576
    v_mfma_f32_16x16x32_bf16 v[88:91], a[4:7], v[28:31], v[88:91]
    ds_read_b128 v[72:75], v16 offset:24832
    ds_read_b128 v[76:79], v17 offset:24832
    v_mfma_f32_16x16x32_bf16 v[92:95], a[36:39], v[28:31], v[92:95]
    ds_read_b128 v[80:83], v18 offset:24832
    ds_read_b128 v[84:87], v19 offset:24832
    v_mfma_f32_16x16x32_bf16 v[88:91], a[8:11], v[32:35], v[88:91]
    v_mul_f32 v104, s87, v104
    v_mul_f32 v105, s87, v105
    v_mfma_f32_16x16x32_bf16 v[92:95], a[40:43], v[32:35], v[92:95]
    v_mul_f32 v106, s87, v106
    v_mul_f32 v107, s87, v107
    v_mfma_f32_16x16x32_bf16 v[88:91], a[12:15], v[36:39], v[88:91]
    v_mul_f32 v108, s87, v108
    v_mul_f32 v109, s87, v109
    v_mfma_f32_16x16x32_bf16 v[92:95], a[44:47], v[36:39], v[92:95]
    v_mul_f32 v110, s87, v110
    v_mul_f32 v111, s87, v111
    v_mfma_f32_16x16x32_bf16 v[88:91], a[16:19], v[40:43], v[88:91]
    v_cvt_pk_bf16_f32 v128, v104, v105
    v_cvt_pk_bf16_f32 v129, v108, v109
    v_mfma_f32_16x16x32_bf16 v[92:95], a[48:51], v[40:43], v[92:95]
    v_cvt_pk_bf16_f32 v130, v106, v107
    v_cvt_pk_bf16_f32 v131, v110, v111
    v_mfma_f32_16x16x32_bf16 v[88:91], a[20:23], v[44:47], v[88:91]
    buffer_store_dwordx4 v[128:131], v22, s[4:7], s85 offen offset:256 sc1
    v_mfma_f32_16x16x32_bf16 v[92:95], a[52:55], v[44:47], v[92:95]
    v_mfma_f32_16x16x32_bf16 v[88:91], a[24:27], v[48:51], v[88:91]
    v_mfma_f32_16x16x32_bf16 v[92:95], a[56:59], v[48:51], v[92:95]
    v_mfma_f32_16x16x32_bf16 v[88:91], a[28:31], v[52:55], v[88:91]
    v_mfma_f32_16x16x32_bf16 v[92:95], a[60:63], v[52:55], v[92:95]
    s_waitcnt lgkmcnt(0)
    v_mfma_f32_16x16x32_bf16 v[104:107], a[0:3], v[56:59], 0
    ds_read_b128 v[24:27], v16 offset:32768
    ds_read_b128 v[28:31], v17 offset:32768
    v_mfma_f32_16x16x32_bf16 v[108:111], a[32:35], v[56:59], 0
    ds_read_b128 v[32:35], v18 offset:32768
    ds_read_b128 v[36:39], v19 offset:32768
    v_mfma_f32_16x16x32_bf16 v[104:107], a[4:7], v[60:63], v[104:107]
    ds_read_b128 v[40:43], v16 offset:33024
    ds_read_b128 v[44:47], v17 offset:33024
    v_mfma_f32_16x16x32_bf16 v[108:111], a[36:39], v[60:63], v[108:111]
    ds_read_b128 v[48:51], v18 offset:33024
    ds_read_b128 v[52:55], v19 offset:33024
    v_mfma_f32_16x16x32_bf16 v[104:107], a[8:11], v[64:67], v[104:107]
    v_mul_f32 v88, s87, v88
    v_mul_f32 v89, s87, v89
    v_mfma_f32_16x16x32_bf16 v[108:111], a[40:43], v[64:67], v[108:111]
    v_mul_f32 v90, s87, v90
    v_mul_f32 v91, s87, v91
    v_mfma_f32_16x16x32_bf16 v[104:107], a[12:15], v[68:71], v[104:107]
    v_mul_f32 v92, s87, v92
    v_mul_f32 v93, s87, v93
    v_mfma_f32_16x16x32_bf16 v[108:111], a[44:47], v[68:71], v[108:111]
    v_mul_f32 v94, s87, v94
    v_mul_f32 v95, s87, v95
    v_mfma_f32_16x16x32_bf16 v[104:107], a[16:19], v[72:75], v[104:107]
    v_cvt_pk_bf16_f32 v120, v88, v89
    v_cvt_pk_bf16_f32 v121, v92, v93
    v_mfma_f32_16x16x32_bf16 v[108:111], a[48:51], v[72:75], v[108:111]
    v_cvt_pk_bf16_f32 v122, v90, v91
    v_cvt_pk_bf16_f32 v123, v94, v95
    v_mfma_f32_16x16x32_bf16 v[104:107], a[20:23], v[76:79], v[104:107]
    buffer_store_dwordx4 v[120:123], v22, s[4:7], s85 offen offset:512 sc1
    v_mfma_f32_16x16x32_bf16 v[108:111], a[52:55], v[76:79], v[108:111]
    v_mfma_f32_16x16x32_bf16 v[104:107], a[24:27], v[80:83], v[104:107]
    v_mfma_f32_16x16x32_bf16 v[108:111], a[56:59], v[80:83], v[108:111]
    v_mfma_f32_16x16x32_bf16 v[104:107], a[28:31], v[84:87], v[104:107]
    v_mfma_f32_16x16x32_bf16 v[108:111], a[60:63], v[84:87], v[108:111]
    s_waitcnt lgkmcnt(0)
    v_mfma_f32_16x16x32_bf16 v[88:91], a[0:3], v[24:27], 0
    ds_read_b128 v[56:59], v16 offset:40960
    ds_read_b128 v[60:63], v17 offset:40960
    v_mfma_f32_16x16x32_bf16 v[92:95], a[32:35], v[24:27], 0
    ds_read_b128 v[64:67], v18 offset:40960
    ds_read_b128 v[68:71], v19 offset:40960
    v_mfma_f32_16x16x32_bf16 v[88:91], a[4:7], v[28:31], v[88:91]
    ds_read_b128 v[72:75], v16 offset:41216
    ds_read_b128 v[76:79], v17 offset:41216
    v_mfma_f32_16x16x32_bf16 v[92:95], a[36:39], v[28:31], v[92:95]
    ds_read_b128 v[80:83], v18 offset:41216
    ds_read_b128 v[84:87], v19 offset:41216
    v_mfma_f32_16x16x32_bf16 v[88:91], a[8:11], v[32:35], v[88:91]
    v_mul_f32 v104, s87, v104
    v_mul_f32 v105, s87, v105
    v_mfma_f32_16x16x32_bf16 v[92:95], a[40:43], v[32:35], v[92:95]
    v_mul_f32 v106, s87, v106
    v_mul_f32 v107, s87, v107
    v_mfma_f32_16x16x32_bf16 v[88:91], a[12:15], v[36:39], v[88:91]
    v_mul_f32 v108, s87, v108
    v_mul_f32 v109, s87, v109
    v_mfma_f32_16x16x32_bf16 v[92:95], a[44:47], v[36:39], v[92:95]
    v_mul_f32 v110, s87, v110
    v_mul_f32 v111, s87, v111
    v_mfma_f32_16x16x32_bf16 v[88:91], a[16:19], v[40:43], v[88:91]
    v_cvt_pk_bf16_f32 v128, v104, v105
    v_cvt_pk_bf16_f32 v129, v108, v109
    v_mfma_f32_16x16x32_bf16 v[92:95], a[48:51], v[40:43], v[92:95]
    v_cvt_pk_bf16_f32 v130, v106, v107
    v_cvt_pk_bf16_f32 v131, v110, v111
    v_mfma_f32_16x16x32_bf16 v[88:91], a[20:23], v[44:47], v[88:91]
    buffer_store_dwordx4 v[128:131], v22, s[4:7], s85 offen offset:768 sc1
    v_mfma_f32_16x16x32_bf16 v[92:95], a[52:55], v[44:47], v[92:95]
    v_mfma_f32_16x16x32_bf16 v[88:91], a[24:27], v[48:51], v[88:91]
    v_mfma_f32_16x16x32_bf16 v[92:95], a[56:59], v[48:51], v[92:95]
    v_mfma_f32_16x16x32_bf16 v[88:91], a[28:31], v[52:55], v[88:91]
    v_mfma_f32_16x16x32_bf16 v[92:95], a[60:63], v[52:55], v[92:95]
    s_waitcnt lgkmcnt(0)
    v_mfma_f32_16x16x32_bf16 v[104:107], a[0:3], v[56:59], 0
    ds_read_b128 v[24:27], v16 offset:49152
    ds_read_b128 v[28:31], v17 offset:49152
    v_mfma_f32_16x16x32_bf16 v[108:111], a[32:35], v[56:59], 0
    ds_read_b128 v[32:35], v18 offset:49152
    ds_read_b128 v[36:39], v19 offset:49152
    v_mfma_f32_16x16x32_bf16 v[104:107], a[4:7], v[60:63], v[104:107]
    ds_read_b128 v[40:43], v16 offset:49408
    ds_read_b128 v[44:47], v17 offset:49408
    v_mfma_f32_16x16x32_bf16 v[108:111], a[36:39], v[60:63], v[108:111]
    ds_read_b128 v[48:51], v18 offset:49408
    ds_read_b128 v[52:55], v19 offset:49408
    v_mfma_f32_16x16x32_bf16 v[104:107], a[8:11], v[64:67], v[104:107]
    v_mul_f32 v88, s87, v88
    v_mul_f32 v89, s87, v89
    v_mfma_f32_16x16x32_bf16 v[108:111], a[40:43], v[64:67], v[108:111]
    v_mul_f32 v90, s87, v90
    v_mul_f32 v91, s87, v91
    v_mfma_f32_16x16x32_bf16 v[104:107], a[12:15], v[68:71], v[104:107]
    v_mul_f32 v92, s87, v92
    v_mul_f32 v93, s87, v93
    v_mfma_f32_16x16x32_bf16 v[108:111], a[44:47], v[68:71], v[108:111]
    v_mul_f32 v94, s87, v94
    v_mul_f32 v95, s87, v95
    v_mfma_f32_16x16x32_bf16 v[104:107], a[16:19], v[72:75], v[104:107]
    v_cvt_pk_bf16_f32 v120, v88, v89
    v_cvt_pk_bf16_f32 v121, v92, v93
    v_mfma_f32_16x16x32_bf16 v[108:111], a[48:51], v[72:75], v[108:111]
    v_cvt_pk_bf16_f32 v122, v90, v91
    v_cvt_pk_bf16_f32 v123, v94, v95
    v_mfma_f32_16x16x32_bf16 v[104:107], a[20:23], v[76:79], v[104:107]
    buffer_store_dwordx4 v[120:123], v22, s[4:7], s85 offen offset:1024 sc1
    v_mfma_f32_16x16x32_bf16 v[108:111], a[52:55], v[76:79], v[108:111]
    v_mfma_f32_16x16x32_bf16 v[104:107], a[24:27], v[80:83], v[104:107]
    v_mfma_f32_16x16x32_bf16 v[108:111], a[56:59], v[80:83], v[108:111]
    v_mfma_f32_16x16x32_bf16 v[104:107], a[28:31], v[84:87], v[104:107]
    v_mfma_f32_16x16x32_bf16 v[108:111], a[60:63], v[84:87], v[108:111]
    s_waitcnt lgkmcnt(0)
    v_mfma_f32_16x16x32_bf16 v[88:91], a[0:3], v[24:27], 0
    s_nop 1
    s_nop 1
    v_mfma_f32_16x16x32_bf16 v[92:95], a[32:35], v[24:27], 0
    s_nop 1
    s_nop 1
    v_mfma_f32_16x16x32_bf16 v[88:91], a[4:7], v[28:31], v[88:91]
    s_nop 1
    s_nop 1
    v_mfma_f32_16x16x32_bf16 v[92:95], a[36:39], v[28:31], v[92:95]
    v_mul_f32 v104, s87, v104
    v_mul_f32 v105, s87, v105
    v_mfma_f32_16x16x32_bf16 v[88:91], a[8:11], v[32:35], v[88:91]
    v_mul_f32 v106, s87, v106
    v_mul_f32 v107, s87, v107
    v_mfma_f32_16x16x32_bf16 v[92:95], a[40:43], v[32:35], v[92:95]
    v_mul_f32 v108, s87, v108
    v_mul_f32 v109, s87, v109
    v_mfma_f32_16x16x32_bf16 v[88:91], a[12:15], v[36:39], v[88:91]
    v_mul_f32 v110, s87, v110
    v_mul_f32 v111, s87, v111
    v_mfma_f32_16x16x32_bf16 v[92:95], a[44:47], v[36:39], v[92:95]
    v_cvt_pk_bf16_f32 v128, v104, v105
    v_cvt_pk_bf16_f32 v129, v108, v109
    v_mfma_f32_16x16x32_bf16 v[88:91], a[16:19], v[40:43], v[88:91]
    v_cvt_pk_bf16_f32 v130, v106, v107
    v_cvt_pk_bf16_f32 v131, v110, v111
    v_mfma_f32_16x16x32_bf16 v[92:95], a[48:51], v[40:43], v[92:95]
    buffer_store_dwordx4 v[128:131], v22, s[4:7], s85 offen offset:1280 sc1
    v_mfma_f32_16x16x32_bf16 v[88:91], a[20:23], v[44:47], v[88:91]
    v_mfma_f32_16x16x32_bf16 v[92:95], a[52:55], v[44:47], v[92:95]
    v_mfma_f32_16x16x32_bf16 v[88:91], a[24:27], v[48:51], v[88:91]
    v_mfma_f32_16x16x32_bf16 v[92:95], a[56:59], v[48:51], v[92:95]
    v_mfma_f32_16x16x32_bf16 v[88:91], a[28:31], v[52:55], v[88:91]
    v_mfma_f32_16x16x32_bf16 v[92:95], a[60:63], v[52:55], v[92:95]
    s_nop 7
    v_mul_f32 v88, s87, v88
    v_mul_f32 v89, s87, v89
    v_mul_f32 v90, s87, v90
    v_mul_f32 v91, s87, v91
    v_mul_f32 v92, s87, v92
    v_mul_f32 v93, s87, v93
    v_mul_f32 v94, s87, v94
    v_mul_f32 v95, s87, v95
    v_cvt_pk_bf16_f32 v120, v88, v89
    v_cvt_pk_bf16_f32 v121, v92, v93
    v_cvt_pk_bf16_f32 v122, v90, v91
    v_cvt_pk_bf16_f32 v123, v94, v95
    buffer_store_dwordx4 v[120:123], v22, s[4:7], s85 offen offset:1536 sc1
    s_branch P0_t
.p2align 6
P0_g11:
    ds_read_b64_tr_b16 v[24:25], v20 offset:0
    ds_read_b64_tr_b16 v[26:27], v20 offset:896
    ds_read_b64_tr_b16 v[28:29], v20 offset:7168
    ds_read_b64_tr_b16 v[30:31], v20 offset:8064
    ds_read_b64_tr_b16 v[32:33], v20 offset:14336
    ds_read_b64_tr_b16 v[34:35], v20 offset:15232
    ds_read_b64_tr_b16 v[36:37], v20 offset:21504
    ds_read_b64_tr_b16 v[38:39], v20 offset:22400
    ds_read_b64_tr_b16 v[40:41], v20 offset:28672
    ds_read_b64_tr_b16 v[42:43], v20 offset:29568
    ds_read_b64_tr_b16 v[44:45], v20 offset:35840
    ds_read_b64_tr_b16 v[46:47], v20 offset:36736
    ds_read_b64_tr_b16 v[48:49], v20 offset:43008
    ds_read_b64_tr_b16 v[50:51], v20 offset:43904
    ds_read_b64_tr_b16 v[52:53], v20 offset:50176
    ds_read_b64_tr_b16 v[54:55], v20 offset:51072
    s_waitcnt lgkmcnt(0)
    v_mfma_f32_16x16x32_bf16 v[88:91], a[0:3], v[24:27], 0
    ds_read_b64_tr_b16 v[56:57], v20 offset:32
    ds_read_b64_tr_b16 v[58:59], v20 offset:928
    v_mfma_f32_16x16x32_bf16 v[92:95], a[32:35], v[24:27], 0
    ds_read_b64_tr_b16 v[60:61], v20 offset:7200
    ds_read_b64_tr_b16 v[62:63], v20 offset:8096
    v_mfma_f32_16x16x32_bf16 v[88:91], a[4:7], v[28:31], v[88:91]
    ds_read_b64_tr_b16 v[64:65], v20 offset:14368
    ds_read_b64_tr_b16 v[66:67], v20 offset:15264
    v_mfma_f32_16x16x32_bf16 v[92:95], a[36:39], v[28:31], v[92:95]
    ds_read_b64_tr_b16 v[68:69], v20 offset:21536
    ds_read_b64_tr_b16 v[70:71], v20 offset:22432
    v_mfma_f32_16x16x32_bf16 v[88:91], a[8:11], v[32:35], v[88:91]
    ds_read_b64_tr_b16 v[72:73], v20 offset:28704
    ds_read_b64_tr_b16 v[74:75], v20 offset:29600
    v_mfma_f32_16x16x32_bf16 v[92:95], a[40:43], v[32:35], v[92:95]
    ds_read_b64_tr_b16 v[76:77], v20 offset:35872
    ds_read_b64_tr_b16 v[78:79], v20 offset:36768
    v_mfma_f32_16x16x32_bf16 v[88:91], a[12:15], v[36:39], v[88:91]
    ds_read_b64_tr_b16 v[80:81], v20 offset:43040
    ds_read_b64_tr_b16 v[82:83], v20 offset:43936
    v_mfma_f32_16x16x32_bf16 v[92:95], a[44:47], v[36:39], v[92:95]
    ds_read_b64_tr_b16 v[84:85], v20 offset:50208
    ds_read_b64_tr_b16 v[86:87], v20 offset:51104
    v_mfma_f32_16x16x32_bf16 v[88:91], a[16:19], v[40:43], v[88:91]
    v_mfma_f32_16x16x32_bf16 v[92:95], a[48:51], v[40:43], v[92:95]
    v_mfma_f32_16x16x32_bf16 v[88:91], a[20:23], v[44:47], v[88:91]
    v_mfma_f32_16x16x32_bf16 v[92:95], a[52:55], v[44:47], v[92:95]
    v_mfma_f32_16x16x32_bf16 v[88:91], a[24:27], v[48:51], v[88:91]
    v_mfma_f32_16x16x32_bf16 v[92:95], a[56:59], v[48:51], v[92:95]
    v_mfma_f32_16x16x32_bf16 v[88:91], a[28:31], v[52:55], v[88:91]
    v_mfma_f32_16x16x32_bf16 v[92:95], a[60:63], v[52:55], v[92:95]
    s_waitcnt lgkmcnt(0)
    v_mfma_f32_16x16x32_bf16 v[104:107], a[0:3], v[56:59], 0
    ds_read_b64_tr_b16 v[24:25], v20 offset:64
    ds_read_b64_tr_b16 v[26:27], v20 offset:960
    v_mfma_f32_16x16x32_bf16 v[108:111], a[32:35], v[56:59], 0
    ds_read_b64_tr_b16 v[28:29], v20 offset:7232
    ds_read_b64_tr_b16 v[30:31], v20 offset:8128
    v_mfma_f32_16x16x32_bf16 v[104:107], a[4:7], v[60:63], v[104:107]
    ds_read_b64_tr_b16 v[32:33], v20 offset:14400
    ds_read_b64_tr_b16 v[34:35], v20 offset:15296
    v_mfma_f32_16x16x32_bf16 v[108:111], a[36:39], v[60:63], v[108:111]
    ds_read_b64_tr_b16 v[36:37], v20 offset:21568
    ds_read_b64_tr_b16 v[38:39], v20 offset:22464
    v_mfma_f32_16x16x32_bf16 v[104:107], a[8:11], v[64:67], v[104:107]
    ds_read_b64_tr_b16 v[40:41], v20 offset:28736
    ds_read_b64_tr_b16 v[42:43], v20 offset:29632
    v_mfma_f32_16x16x32_bf16 v[108:111], a[40:43], v[64:67], v[108:111]
    ds_read_b64_tr_b16 v[44:45], v20 offset:35904
    ds_read_b64_tr_b16 v[46:47], v20 offset:36800
    v_mfma_f32_16x16x32_bf16 v[104:107], a[12:15], v[68:71], v[104:107]
    ds_read_b64_tr_b16 v[48:49], v20 offset:43072
    ds_read_b64_tr_b16 v[50:51], v20 offset:43968
    v_mfma_f32_16x16x32_bf16 v[108:111], a[44:47], v[68:71], v[108:111]
    ds_read_b64_tr_b16 v[52:53], v20 offset:50240
    ds_read_b64_tr_b16 v[54:55], v20 offset:51136
    v_mfma_f32_16x16x32_bf16 v[104:107], a[16:19], v[72:75], v[104:107]
    v_cvt_pk_bf16_f32 v120, v88, v89
    v_cvt_pk_bf16_f32 v121, v92, v93
    v_mfma_f32_16x16x32_bf16 v[108:111], a[48:51], v[72:75], v[108:111]
    v_cvt_pk_bf16_f32 v122, v90, v91
    v_cvt_pk_bf16_f32 v123, v94, v95
    v_mfma_f32_16x16x32_bf16 v[104:107], a[20:23], v[76:79], v[104:107]
    buffer_store_dwordx4 v[120:123], v22, s[4:7], s85 offen offset:0 sc1
    v_mfma_f32_16x16x32_bf16 v[108:111], a[52:55], v[76:79], v[108:111]
    v_mfma_f32_16x16x32_bf16 v[104:107], a[24:27], v[80:83], v[104:107]
    v_mfma_f32_16x16x32_bf16 v[108:111], a[56:59], v[80:83], v[108:111]
    v_mfma_f32_16x16x32_bf16 v[104:107], a[28:31], v[84:87], v[104:107]
    v_mfma_f32_16x16x32_bf16 v[108:111], a[60:63], v[84:87], v[108:111]
    s_waitcnt lgkmcnt(0)
    v_mfma_f32_16x16x32_bf16 v[88:91], a[0:3], v[24:27], 0
    ds_read_b64_tr_b16 v[56:57], v20 offset:96
    ds_read_b64_tr_b16 v[58:59], v20 offset:992
    v_mfma_f32_16x16x32_bf16 v[92:95], a[32:35], v[24:27], 0
    ds_read_b64_tr_b16 v[60:61], v20 offset:7264
    ds_read_b64_tr_b16 v[62:63], v20 offset:8160
    v_mfma_f32_16x16x32_bf16 v[88:91], a[4:7], v[28:31], v[88:91]
    ds_read_b64_tr_b16 v[64:65], v20 offset:14432
    ds_read_b64_tr_b16 v[66:67], v20 offset:15328
    v_mfma_f32_16x16x32_bf16 v[92:95], a[36:39], v[28:31], v[92:95]
    ds_read_b64_tr_b16 v[68:69], v20 offset:21600
    ds_read_b64_tr_b16 v[70:71], v20 offset:22496
    v_mfma_f32_16x16x32_bf16 v[88:91], a[8:11], v[32:35], v[88:91]
    ds_read_b64_tr_b16 v[72:73], v20 offset:28768
    ds_read_b64_tr_b16 v[74:75], v20 offset:29664
    v_mfma_f32_16x16x32_bf16 v[92:95], a[40:43], v[32:35], v[92:95]
    ds_read_b64_tr_b16 v[76:77], v20 offset:35936
    ds_read_b64_tr_b16 v[78:79], v20 offset:36832
    v_mfma_f32_16x16x32_bf16 v[88:91], a[12:15], v[36:39], v[88:91]
    ds_read_b64_tr_b16 v[80:81], v20 offset:43104
    ds_read_b64_tr_b16 v[82:83], v20 offset:44000
    v_mfma_f32_16x16x32_bf16 v[92:95], a[44:47], v[36:39], v[92:95]
    ds_read_b64_tr_b16 v[84:85], v20 offset:50272
    ds_read_b64_tr_b16 v[86:87], v20 offset:51168
    v_mfma_f32_16x16x32_bf16 v[88:91], a[16:19], v[40:43], v[88:91]
    v_cvt_pk_bf16_f32 v128, v104, v105
    v_cvt_pk_bf16_f32 v129, v108, v109
    v_mfma_f32_16x16x32_bf16 v[92:95], a[48:51], v[40:43], v[92:95]
    v_cvt_pk_bf16_f32 v130, v106, v107
    v_cvt_pk_bf16_f32 v131, v110, v111
    v_mfma_f32_16x16x32_bf16 v[88:91], a[20:23], v[44:47], v[88:91]
    buffer_store_dwordx4 v[128:131], v22, s[4:7], s85 offen offset:256 sc1
    v_mfma_f32_16x16x32_bf16 v[92:95], a[52:55], v[44:47], v[92:95]
    v_mfma_f32_16x16x32_bf16 v[88:91], a[24:27], v[48:51], v[88:91]
    v_mfma_f32_16x16x32_bf16 v[92:95], a[56:59], v[48:51], v[92:95]
    v_mfma_f32_16x16x32_bf16 v[88:91], a[28:31], v[52:55], v[88:91]
    v_mfma_f32_16x16x32_bf16 v[92:95], a[60:63], v[52:55], v[92:95]
    s_waitcnt lgkmcnt(0)
    v_mfma_f32_16x16x32_bf16 v[104:107], a[0:3], v[56:59], 0
    ds_read_b64_tr_b16 v[24:25], v20 offset:128
    ds_read_b64_tr_b16 v[26:27], v20 offset:1024
    v_mfma_f32_16x16x32_bf16 v[108:111], a[32:35], v[56:59], 0
    ds_read_b64_tr_b16 v[28:29], v20 offset:7296
    ds_read_b64_tr_b16 v[30:31], v20 offset:8192
    v_mfma_f32_16x16x32_bf16 v[104:107], a[4:7], v[60:63], v[104:107]
    ds_read_b64_tr_b16 v[32:33], v20 offset:14464
    ds_read_b64_tr_b16 v[34:35], v20 offset:15360
    v_mfma_f32_16x16x32_bf16 v[108:111], a[36:39], v[60:63], v[108:111]
    ds_read_b64_tr_b16 v[36:37], v20 offset:21632
    ds_read_b64_tr_b16 v[38:39], v20 offset:22528
    v_mfma_f32_16x16x32_bf16 v[104:107], a[8:11], v[64:67], v[104:107]
    ds_read_b64_tr_b16 v[40:41], v20 offset:28800
    ds_read_b64_tr_b16 v[42:43], v20 offset:29696
    v_mfma_f32_16x16x32_bf16 v[108:111], a[40:43], v[64:67], v[108:111]
    ds_read_b64_tr_b16 v[44:45], v20 offset:35968
    ds_read_b64_tr_b16 v[46:47], v20 offset:36864
    v_mfma_f32_16x16x32_bf16 v[104:107], a[12:15], v[68:71], v[104:107]
    ds_read_b64_tr_b16 v[48:49], v20 offset:43136
    ds_read_b64_tr_b16 v[50:51], v20 offset:44032
    v_mfma_f32_16x16x32_bf16 v[108:111], a[44:47], v[68:71], v[108:111]
    ds_read_b64_tr_b16 v[52:53], v20 offset:50304
    ds_read_b64_tr_b16 v[54:55], v20 offset:51200
    v_mfma_f32_16x16x32_bf16 v[104:107], a[16:19], v[72:75], v[104:107]
    v_cvt_pk_bf16_f32 v120, v88, v89
    v_cvt_pk_bf16_f32 v121, v92, v93
    v_mfma_f32_16x16x32_bf16 v[108:111], a[48:51], v[72:75], v[108:111]
    v_cvt_pk_bf16_f32 v122, v90, v91
    v_cvt_pk_bf16_f32 v123, v94, v95
    v_mfma_f32_16x16x32_bf16 v[104:107], a[20:23], v[76:79], v[104:107]
    buffer_store_dwordx4 v[120:123], v22, s[4:7], s85 offen offset:512 sc1
    v_mfma_f32_16x16x32_bf16 v[108:111], a[52:55], v[76:79], v[108:111]
    v_mfma_f32_16x16x32_bf16 v[104:107], a[24:27], v[80:83], v[104:107]
    v_mfma_f32_16x16x32_bf16 v[108:111], a[56:59], v[80:83], v[108:111]
    v_mfma_f32_16x16x32_bf16 v[104:107], a[28:31], v[84:87], v[104:107]
    v_mfma_f32_16x16x32_bf16 v[108:111], a[60:63], v[84:87], v[108:111]
    s_waitcnt lgkmcnt(0)
    v_mfma_f32_16x16x32_bf16 v[88:91], a[0:3], v[24:27], 0
    ds_read_b64_tr_b16 v[56:57], v20 offset:160
    ds_read_b64_tr_b16 v[58:59], v20 offset:1056
    v_mfma_f32_16x16x32_bf16 v[92:95], a[32:35], v[24:27], 0
    ds_read_b64_tr_b16 v[60:61], v20 offset:7328
    ds_read_b64_tr_b16 v[62:63], v20 offset:8224
    v_mfma_f32_16x16x32_bf16 v[88:91], a[4:7], v[28:31], v[88:91]
    ds_read_b64_tr_b16 v[64:65], v20 offset:14496
    ds_read_b64_tr_b16 v[66:67], v20 offset:15392
    v_mfma_f32_16x16x32_bf16 v[92:95], a[36:39], v[28:31], v[92:95]
    ds_read_b64_tr_b16 v[68:69], v20 offset:21664
    ds_read_b64_tr_b16 v[70:71], v20 offset:22560
    v_mfma_f32_16x16x32_bf16 v[88:91], a[8:11], v[32:35], v[88:91]
    ds_read_b64_tr_b16 v[72:73], v20 offset:28832
    ds_read_b64_tr_b16 v[74:75], v20 offset:29728
    v_mfma_f32_16x16x32_bf16 v[92:95], a[40:43], v[32:35], v[92:95]
    ds_read_b64_tr_b16 v[76:77], v20 offset:36000
    ds_read_b64_tr_b16 v[78:79], v20 offset:36896
    v_mfma_f32_16x16x32_bf16 v[88:91], a[12:15], v[36:39], v[88:91]
    ds_read_b64_tr_b16 v[80:81], v20 offset:43168
    ds_read_b64_tr_b16 v[82:83], v20 offset:44064
    v_mfma_f32_16x16x32_bf16 v[92:95], a[44:47], v[36:39], v[92:95]
    ds_read_b64_tr_b16 v[84:85], v20 offset:50336
    ds_read_b64_tr_b16 v[86:87], v20 offset:51232
    v_mfma_f32_16x16x32_bf16 v[88:91], a[16:19], v[40:43], v[88:91]
    v_cvt_pk_bf16_f32 v128, v104, v105
    v_cvt_pk_bf16_f32 v129, v108, v109
    v_mfma_f32_16x16x32_bf16 v[92:95], a[48:51], v[40:43], v[92:95]
    v_cvt_pk_bf16_f32 v130, v106, v107
    v_cvt_pk_bf16_f32 v131, v110, v111
    v_mfma_f32_16x16x32_bf16 v[88:91], a[20:23], v[44:47], v[88:91]
    buffer_store_dwordx4 v[128:131], v22, s[4:7], s85 offen offset:768 sc1
    v_mfma_f32_16x16x32_bf16 v[92:95], a[52:55], v[44:47], v[92:95]
    v_mfma_f32_16x16x32_bf16 v[88:91], a[24:27], v[48:51], v[88:91]
    v_mfma_f32_16x16x32_bf16 v[92:95], a[56:59], v[48:51], v[92:95]
    v_mfma_f32_16x16x32_bf16 v[88:91], a[28:31], v[52:55], v[88:91]
    v_mfma_f32_16x16x32_bf16 v[92:95], a[60:63], v[52:55], v[92:95]
    s_waitcnt lgkmcnt(0)
    v_mfma_f32_16x16x32_bf16 v[104:107], a[0:3], v[56:59], 0
    ds_read_b64_tr_b16 v[24:25], v20 offset:192
    ds_read_b64_tr_b16 v[26:27], v20 offset:1088
    v_mfma_f32_16x16x32_bf16 v[108:111], a[32:35], v[56:59], 0
    ds_read_b64_tr_b16 v[28:29], v20 offset:7360
    ds_read_b64_tr_b16 v[30:31], v20 offset:8256
    v_mfma_f32_16x16x32_bf16 v[104:107], a[4:7], v[60:63], v[104:107]
    ds_read_b64_tr_b16 v[32:33], v20 offset:14528
    ds_read_b64_tr_b16 v[34:35], v20 offset:15424
    v_mfma_f32_16x16x32_bf16 v[108:111], a[36:39], v[60:63], v[108:111]
    ds_read_b64_tr_b16 v[36:37], v20 offset:21696
    ds_read_b64_tr_b16 v[38:39], v20 offset:22592
    v_mfma_f32_16x16x32_bf16 v[104:107], a[8:11], v[64:67], v[104:107]
    ds_read_b64_tr_b16 v[40:41], v20 offset:28864
    ds_read_b64_tr_b16 v[42:43], v20 offset:29760
    v_mfma_f32_16x16x32_bf16 v[108:111], a[40:43], v[64:67], v[108:111]
    ds_read_b64_tr_b16 v[44:45], v20 offset:36032
    ds_read_b64_tr_b16 v[46:47], v20 offset:36928
    v_mfma_f32_16x16x32_bf16 v[104:107], a[12:15], v[68:71], v[104:107]
    ds_read_b64_tr_b16 v[48:49], v20 offset:43200
    ds_read_b64_tr_b16 v[50:51], v20 offset:44096
    v_mfma_f32_16x16x32_bf16 v[108:111], a[44:47], v[68:71], v[108:111]
    ds_read_b64_tr_b16 v[52:53], v20 offset:50368
    ds_read_b64_tr_b16 v[54:55], v20 offset:51264
    v_mfma_f32_16x16x32_bf16 v[104:107], a[16:19], v[72:75], v[104:107]
    v_cvt_pk_bf16_f32 v120, v88, v89
    v_cvt_pk_bf16_f32 v121, v92, v93
    v_mfma_f32_16x16x32_bf16 v[108:111], a[48:51], v[72:75], v[108:111]
    v_cvt_pk_bf16_f32 v122, v90, v91
    v_cvt_pk_bf16_f32 v123, v94, v95
    v_mfma_f32_16x16x32_bf16 v[104:107], a[20:23], v[76:79], v[104:107]
    buffer_store_dwordx4 v[120:123], v22, s[4:7], s85 offen offset:1024 sc1
    v_mfma_f32_16x16x32_bf16 v[108:111], a[52:55], v[76:79], v[108:111]
    v_mfma_f32_16x16x32_bf16 v[104:107], a[24:27], v[80:83], v[104:107]
    v_mfma_f32_16x16x32_bf16 v[108:111], a[56:59], v[80:83], v[108:111]
    v_mfma_f32_16x16x32_bf16 v[104:107], a[28:31], v[84:87], v[104:107]
    v_mfma_f32_16x16x32_bf16 v[108:111], a[60:63], v[84:87], v[108:111]
    s_waitcnt lgkmcnt(0)
    v_mfma_f32_16x16x32_bf16 v[88:91], a[0:3], v[24:27], 0
    s_nop 1
    s_nop 1
    v_mfma_f32_16x16x32_bf16 v[92:95], a[32:35], v[24:27], 0
    s_nop 1
    s_nop 1
    v_mfma_f32_16x16x32_bf16 v[88:91], a[4:7], v[28:31], v[88:91]
    s_nop 1
    s_nop 1
    v_mfma_f32_16x16x32_bf16 v[92:95], a[36:39], v[28:31], v[92:95]
    v_cvt_pk_bf16_f32 v128, v104, v105
    v_cvt_pk_bf16_f32 v129, v108, v109
    v_mfma_f32_16x16x32_bf16 v[88:91], a[8:11], v[32:35], v[88:91]
    v_cvt_pk_bf16_f32 v130, v106, v107
    v_cvt_pk_bf16_f32 v131, v110, v111
    v_mfma_f32_16x16x32_bf16 v[92:95], a[40:43], v[32:35], v[92:95]
    buffer_store_dwordx4 v[128:131], v22, s[4:7], s85 offen offset:1280 sc1
    v_mfma_f32_16x16x32_bf16 v[88:91], a[12:15], v[36:39], v[88:91]
    v_mfma_f32_16x16x32_bf16 v[92:95], a[44:47], v[36:39], v[92:95]
    v_mfma_f32_16x16x32_bf16 v[88:91], a[16:19], v[40:43], v[88:91]
    v_mfma_f32_16x16x32_bf16 v[92:95], a[48:51], v[40:43], v[92:95]
    v_mfma_f32_16x16x32_bf16 v[88:91], a[20:23], v[44:47], v[88:91]
    v_mfma_f32_16x16x32_bf16 v[92:95], a[52:55], v[44:47], v[92:95]
    v_mfma_f32_16x16x32_bf16 v[88:91], a[24:27], v[48:51], v[88:91]
    v_mfma_f32_16x16x32_bf16 v[92:95], a[56:59], v[48:51], v[92:95]
    v_mfma_f32_16x16x32_bf16 v[88:91], a[28:31], v[52:55], v[88:91]
    v_mfma_f32_16x16x32_bf16 v[92:95], a[60:63], v[52:55], v[92:95]
    s_nop 7
    v_cvt_pk_bf16_f32 v120, v88, v89
    v_cvt_pk_bf16_f32 v121, v92, v93
    v_cvt_pk_bf16_f32 v122, v90, v91
    v_cvt_pk_bf16_f32 v123, v94, v95
    buffer_store_dwordx4 v[120:123], v22, s[4:7], s85 offen offset:1536 sc1
    s_branch P0_t
.p2align 6
P0_g20:
    ds_read_b128 v[24:27], v16 offset:0
    ds_read_b128 v[28:31], v17 offset:0
    ds_read_b128 v[32:35], v18 offset:0
    ds_read_b128 v[36:39], v19 offset:0
    ds_read_b128 v[40:43], v16 offset:256
    ds_read_b128 v[44:47], v17 offset:256
    ds_read_b128 v[48:51], v18 offset:256
    ds_read_b128 v[52:55], v19 offset:256
    s_waitcnt lgkmcnt(0)
    v_mfma_f32_16x16x32_bf16 v[88:91], a[0:3], v[24:27], 0
    ds_read_b128 v[56:59], v16 offset:8192
    v_mfma_f32_16x16x32_bf16 v[92:95], a[32:35], v[24:27], 0
    ds_read_b128 v[60:63], v17 offset:8192
    v_mfma_f32_16x16x32_bf16 v[96:99], a[64:67], v[24:27], 0
    ds_read_b128 v[64:67], v18 offset:8192
    v_mfma_f32_16x16x32_bf16 v[100:103], a[96:99], v[24:27], 0
    ds_read_b128 v[68:71], v19 offset:8192
    v_mfma_f32_16x16x32_bf16 v[88:91], a[4:7], v[28:31], v[88:91]
    ds_read_b128 v[72:75], v16 offset:8448
    v_mfma_f32_16x16x32_bf16 v[92:95], a[36:39], v[28:31], v[92:95]
    ds_read_b128 v[76:79], v17 offset:8448
    v_mfma_f32_16x16x32_bf16 v[96:99], a[68:71], v[28:31], v[96:99]
    ds_read_b128 v[80:83], v18 offset:8448
    v_mfma_f32_16x16x32_bf16 v[100:103], a[100:103], v[28:31], v[100:103]
    ds_read_b128 v[84:87], v19 offset:8448
    v_mfma_f32_16x16x32_bf16 v[88:91], a[8:11], v[32:35], v[88:91]
    v_mfma_f32_16x16x32_bf16 v[92:95], a[40:43], v[32:35], v[92:95]
    v_mfma_f32_16x16x32_bf16 v[96:99], a[72:75], v[32:35], v[96:99]
    v_mfma_f32_16x16x32_bf16 v[100:103], a[104:107], v[32:35], v[100:103]
    v_mfma_f32_16x16x32_bf16 v[88:91], a[12:15], v[36:39], v[88:91]
    v_mfma_f32_16x16x32_bf16 v[92:95], a[44:47], v[36:39], v[92:95]
    v_mfma_f32_16x16x32_bf16 v[96:99], a[76:79], v[36:39], v[96:99]
    v_mfma_f32_16x16x32_bf16 v[100:103], a[108:111], v[36:39], v[100:103]
    v_mfma_f32_16x16x32_bf16 v[88:91], a[16:19], v[40:43], v[88:91]
    v_mfma_f32_16x16x32_bf16 v[92:95], a[48:51], v[40:43], v[92:95]
    v_mfma_f32_16x16x32_bf16 v[96:99], a[80:83], v[40:43], v[96:99]
    v_mfma_f32_16x16x32_bf16 v[100:103], a[112:115], v[40:43], v[100:103]
    v_mfma_f32_16x16x32_bf16 v[88:91], a[20:23], v[44:47], v[88:91]
    v_mfma_f32_16x16x32_bf16 v[92:95], a[52:55], v[44:47], v[92:95]
    v_mfma_f32_16x16x32_bf16 v[96:99], a[84:87], v[44:47], v[96:99]
    v_mfma_f32_16x16x32_bf16 v[100:103], a[116:119], v[44:47], v[100:103]
    v_mfma_f32_16x16x32_bf16 v[88:91], a[24:27], v[48:51], v[88:91]
    v_mfma_f32_16x16x32_bf16 v[92:95], a[56:59], v[48:51], v[92:95]
    v_mfma_f32_16x16x32_bf16 v[96:99], a[88:91], v[48:51], v[96:99]
    v_mfma_f32_16x16x32_bf16 v[100:103], a[120:123], v[48:51], v[100:103]
    v_mfma_f32_16x16x32_bf16 v[88:91], a[28:31], v[52:55], v[88:91]
    v_mfma_f32_16x16x32_bf16 v[92:95], a[60:63], v[52:55], v[92:95]
    v_mfma_f32_16x16x32_bf16 v[96:99], a[92:95], v[52:55], v[96:99]
    v_mfma_f32_16x16x32_bf16 v[100:103], a[124:127], v[52:55], v[100:103]
    s_waitcnt lgkmcnt(0)
    v_mfma_f32_16x16x32_bf16 v[104:107], a[0:3], v[56:59], 0
    ds_read_b128 v[24:27], v16 offset:16384
    ds_read_b128 v[28:31], v17 offset:16384
    v_mfma_f32_16x16x32_bf16 v[108:111], a[32:35], v[56:59], 0
    ds_read_b128 v[32:35], v18 offset:16384
    ds_read_b128 v[36:39], v19 offset:16384
    v_mfma_f32_16x16x32_bf16 v[112:115], a[64:67], v[56:59], 0
    ds_read_b128 v[40:43], v16 offset:16640
    v_mfma_f32_16x16x32_bf16 v[116:119], a[96:99], v[56:59], 0
    ds_read_b128 v[44:47], v17 offset:16640
    v_mfma_f32_16x16x32_bf16 v[104:107], a[4:7], v[60:63], v[104:107]
    ds_read_b128 v[48:51], v18 offset:16640
    v_mfma_f32_16x16x32_bf16 v[108:111], a[36:39], v[60:63], v[108:111]
    ds_read_b128 v[52:55], v19 offset:16640
    v_mfma_f32_16x16x32_bf16 v[112:115], a[68:71], v[60:63], v[112:115]
    v_mul_f32 v88, s87, v88
    v_mfma_f32_16x16x32_bf16 v[116:119], a[100:103], v[60:63], v[116:119]
    v_mul_f32 v89, s87, v89
    v_mfma_f32_16x16x32_bf16 v[104:107], a[8:11], v[64:67], v[104:107]
    v_mul_f32 v90, s87, v90
    v_mfma_f32_16x16x32_bf16 v[108:111], a[40:43], v[64:67], v[108:111]
    v_mul_f32 v91, s87, v91
    v_mfma_f32_16x16x32_bf16 v[112:115], a[72:75], v[64:67], v[112:115]
    v_mul_f32 v92, s87, v92
    v_mfma_f32_16x16x32_bf16 v[116:119], a[104:107], v[64:67], v[116:119]
    v_mul_f32 v93, s87, v93
    v_mfma_f32_16x16x32_bf16 v[104:107], a[12:15], v[68:71], v[104:107]
    v_mul_f32 v94, s87, v94
    v_mfma_f32_16x16x32_bf16 v[108:111], a[44:47], v[68:71], v[108:111]
    v_mul_f32 v95, s87, v95
    v_mfma_f32_16x16x32_bf16 v[112:115], a[76:79], v[68:71], v[112:115]
    v_cvt_pk_bf16_f32 v120, v88, v89
    v_mfma_f32_16x16x32_bf16 v[116:119], a[108:111], v[68:71], v[116:119]
    v_cvt_pk_bf16_f32 v121, v92, v93
    v_mfma_f32_16x16x32_bf16 v[104:107], a[16:19], v[72:75], v[104:107]
    v_cvt_pk_bf16_f32 v122, v90, v91
    v_mfma_f32_16x16x32_bf16 v[108:111], a[48:51], v[72:75], v[108:111]
    v_cvt_pk_bf16_f32 v123, v94, v95
    v_mfma_f32_16x16x32_bf16 v[112:115], a[80:83], v[72:75], v[112:115]
    buffer_store_dwordx4 v[120:123], v22, s[4:7], s85 offen offset:0 sc1
    v_mfma_f32_16x16x32_bf16 v[116:119], a[112:115], v[72:75], v[116:119]
    v_mul_f32 v96, s87, v96
    v_mfma_f32_16x16x32_bf16 v[104:107], a[20:23], v[76:79], v[104:107]
    v_mul_f32 v97, s87, v97
    v_mfma_f32_16x16x32_bf16 v[108:111], a[52:55], v[76:79], v[108:111]
    v_mul_f32 v98, s87, v98
    v_mfma_f32_16x16x32_bf16 v[112:115], a[84:87], v[76:79], v[112:115]
    v_mul_f32 v99, s87, v99
    v_mfma_f32_16x16x32_bf16 v[116:119], a[116:119], v[76:79], v[116:119]
    v_mul_f32 v100, s87, v100
    v_mfma_f32_16x16x32_bf16 v[104:107], a[24:27], v[80:83], v[104:107]
    v_mul_f32 v101, s87, v101
    v_mfma_f32_16x16x32_bf16 v[108:111], a[56:59], v[80:83], v[108:111]
    v_mul_f32 v102, s87, v102
    v_mfma_f32_16x16x32_bf16 v[112:115], a[88:91], v[80:83], v[112:115]
    v_mul_f32 v103, s87, v103
    v_mfma_f32_16x16x32_bf16 v[116:119], a[120:123], v[80:83], v[116:119]
    v_cvt_pk_bf16_f32 v124, v96, v97
    v_mfma_f32_16x16x32_bf16 v[104:107], a[28:31], v[84:87], v[104:107]
    v_cvt_pk_bf16_f32 v125, v100, v101
    v_mfma_f32_16x16x32_bf16 v[108:111], a[60:63], v[84:87], v[108:111]
    v_cvt_pk_bf16_f32 v126, v98, v99
    v_mfma_f32_16x16x32_bf16 v[112:115], a[92:95], v[84:87], v[112:115]
    v_cvt_pk_bf16_f32 v127, v102, v103
    v_mfma_f32_16x16x32_bf16 v[116:119], a[124:127], v[84:87], v[116:119]
    buffer_store_dwordx4 v[124:127], v22, s[4:7], s84 offen offset:0 sc1
    s_waitcnt lgkmcnt(0)
    v_mfma_f32_16x16x32_bf16 v[88:91], a[0:3], v[24:27], 0
    ds_read_b128 v[56:59], v16 offset:24576
    ds_read_b128 v[60:63], v17 offset:24576
    v_mfma_f32_16x16x32_bf16 v[92:95], a[32:35], v[24:27], 0
    ds_read_b128 v[64:67], v18 offset:24576
    ds_read_b128 v[68:71], v19 offset:24576
    v_mfma_f32_16x16x32_bf16 v[96:99], a[64:67], v[24:27], 0
    ds_read_b128 v[72:75], v16 offset:24832
    v_mfma_f32_16x16x32_bf16 v[100:103], a[96:99], v[24:27], 0
    ds_read_b128 v[76:79], v17 offset:24832
    v_mfma_f32_16x16x32_bf16 v[88:91], a[4:7], v[28:31], v[88:91]
    ds_read_b128 v[80:83], v18 offset:24832
    v_mfma_f32_16x16x32_bf16 v[92:95], a[36:39], v[28:31], v[92:95]
    ds_read_b128 v[84:87], v19 offset:24832
    v_mfma_f32_16x16x32_bf16 v[96:99], a[68:71], v[28:31], v[96:99]
    v_mul_f32 v104, s87, v104
    v_mfma_f32_16x16x32_bf16 v[100:103], a[100:103], v[28:31], v[100:103]
    v_mul_f32 v105, s87, v105
    v_mfma_f32_16x16x32_bf16 v[88:91], a[8:11], v[32:35], v[88:91]
    v_mul_f32 v106, s87, v106
    v_mfma_f32_16x16x32_bf16 v[92:95], a[40:43], v[32:35], v[92:95]
    v_mul_f32 v107, s87, v107
    v_mfma_f32_16x16x32_bf16 v[96:99], a[72:75], v[32:35], v[96:99]
    v_mul_f32 v108, s87, v108
    v_mfma_f32_16x16x32_bf16 v[100:103], a[104:107], v[32:35], v[100:103]
    v_mul_f32 v109, s87, v109
    v_mfma_f32_16x16x32_bf16 v[88:91], a[12:15], v[36:39], v[88:91]
    v_mul_f32 v110, s87, v110
    v_mfma_f32_16x16x32_bf16 v[92:95], a[44:47], v[36:39], v[92:95]
    v_mul_f32 v111, s87, v111
    v_mfma_f32_16x16x32_bf16 v[96:99], a[76:79], v[36:39], v[96:99]
    v_cvt_pk_bf16_f32 v128, v104, v105
    v_mfma_f32_16x16x32_bf16 v[100:103], a[108:111], v[36:39], v[100:103]
    v_cvt_pk_bf16_f32 v129, v108, v109
    v_mfma_f32_16x16x32_bf16 v[88:91], a[16:19], v[40:43], v[88:91]
    v_cvt_pk_bf16_f32 v130, v106, v107
    v_mfma_f32_16x16x32_bf16 v[92:95], a[48:51], v[40:43], v[92:95]
    v_cvt_pk_bf16_f32 v131, v110, v111
    v_mfma_f32_16x16x32_bf16 v[96:99], a[80:83], v[40:43], v[96:99]
    buffer_store_dwordx4 v[128:131], v22, s[4:7], s85 offen offset:256 sc1
    v_mfma_f32_16x16x32_bf16 v[100:103], a[112:115], v[40:43], v[100:103]
    v_mul_f32 v112, s87, v112
    v_mfma_f32_16x16x32_bf16 v[88:91], a[20:23], v[44:47], v[88:91]
    v_mul_f32 v113, s87, v113
    v_mfma_f32_16x16x32_bf16 v[92:95], a[52:55], v[44:47], v[92:95]
    v_mul_f32 v114, s87, v114
    v_mfma_f32_16x16x32_bf16 v[96:99], a[84:87], v[44:47], v[96:99]
    v_mul_f32 v115, s87, v115
    v_mfma_f32_16x16x32_bf16 v[100:103], a[116:119], v[44:47], v[100:103]
    v_mul_f32 v116, s87, v116
    v_mfma_f32_16x16x32_bf16 v[88:91], a[24:27], v[48:51], v[88:91]
    v_mul_f32 v117, s87, v117
    v_mfma_f32_16x16x32_bf16 v[92:95], a[56:59], v[48:51], v[92:95]
    v_mul_f32 v118, s87, v118
    v_mfma_f32_16x16x32_bf16 v[96:99], a[88:91], v[48:51], v[96:99]
    v_mul_f32 v119, s87, v119
    v_mfma_f32_16x16x32_bf16 v[100:103], a[120:123], v[48:51], v[100:103]
    v_cvt_pk_bf16_f32 v132, v112, v113
    v_mfma_f32_16x16x32_bf16 v[88:91], a[28:31], v[52:55], v[88:91]
    v_cvt_pk_bf16_f32 v133, v116, v117
    v_mfma_f32_16x16x32_bf16 v[92:95], a[60:63], v[52:55], v[92:95]
    v_cvt_pk_bf16_f32 v134, v114, v115
    v_mfma_f32_16x16x32_bf16 v[96:99], a[92:95], v[52:55], v[96:99]
    v_cvt_pk_bf16_f32 v135, v118, v119
    v_mfma_f32_16x16x32_bf16 v[100:103], a[124:127], v[52:55], v[100:103]
    buffer_store_dwordx4 v[132:135], v22, s[4:7], s84 offen offset:256 sc1
    s_waitcnt lgkmcnt(0)
    v_mfma_f32_16x16x32_bf16 v[104:107], a[0:3], v[56:59], 0
    ds_read_b128 v[24:27], v16 offset:32768
    ds_read_b128 v[28:31], v17 offset:32768
    v_mfma_f32_16x16x32_bf16 v[108:111], a[32:35], v[56:59], 0
    ds_read_b128 v[32:35], v18 offset:32768
    ds_read_b128 v[36:39], v19 offset:32768
    v_mfma_f32_16x16x32_bf16 v[112:115], a[64:67], v[56:59], 0
    ds_read_b128 v[40:43], v16 offset:33024
    v_mfma_f32_16x16x32_bf16 v[116:119], a[96:99], v[56:59], 0
    ds_read_b128 v[44:47], v17 offset:33024
    v_mfma_f32_16x16x32_bf16 v[104:107], a[4:7], v[60:63], v[104:107]
    ds_read_b128 v[48:51], v18 offset:33024
    v_mfma_f32_16x16x32_bf16 v[108:111], a[36:39], v[60:63], v[108:111]
    ds_read_b128 v[52:55], v19 offset:33024
    v_mfma_f32_16x16x32_bf16 v[112:115], a[68:71], v[60:63], v[112:115]
    v_mul_f32 v88, s87, v88
    v_mfma_f32_16x16x32_bf16 v[116:119], a[100:103], v[60:63], v[116:119]
    v_mul_f32 v89, s87, v89
    v_mfma_f32_16x16x32_bf16 v[104:107], a[8:11], v[64:67], v[104:107]
    v_mul_f32 v90, s87, v90
    v_mfma_f32_16x16x32_bf16 v[108:111], a[40:43], v[64:67], v[108:111]
    v_mul_f32 v91, s87, v91
    v_mfma_f32_16x16x32_bf16 v[112:115], a[72:75], v[64:67], v[112:115]
    v_mul_f32 v92, s87, v92
    v_mfma_f32_16x16x32_bf16 v[116:119], a[104:107], v[64:67], v[116:119]
    v_mul_f32 v93, s87, v93
    v_mfma_f32_16x16x32_bf16 v[104:107], a[12:15], v[68:71], v[104:107]
    v_mul_f32 v94, s87, v94
    v_mfma_f32_16x16x32_bf16 v[108:111], a[44:47], v[68:71], v[108:111]
    v_mul_f32 v95, s87, v95
    v_mfma_f32_16x16x32_bf16 v[112:115], a[76:79], v[68:71], v[112:115]
    v_cvt_pk_bf16_f32 v120, v88, v89
    v_mfma_f32_16x16x32_bf16 v[116:119], a[108:111], v[68:71], v[116:119]
    v_cvt_pk_bf16_f32 v121, v92, v93
    v_mfma_f32_16x16x32_bf16 v[104:107], a[16:19], v[72:75], v[104:107]
    v_cvt_pk_bf16_f32 v122, v90, v91
    v_mfma_f32_16x16x32_bf16 v[108:111], a[48:51], v[72:75], v[108:111]
    v_cvt_pk_bf16_f32 v123, v94, v95
    v_mfma_f32_16x16x32_bf16 v[112:115], a[80:83], v[72:75], v[112:115]
    buffer_store_dwordx4 v[120:123], v22, s[4:7], s85 offen offset:512 sc1
    v_mfma_f32_16x16x32_bf16 v[116:119], a[112:115], v[72:75], v[116:119]
    v_mul_f32 v96, s87, v96
    v_mfma_f32_16x16x32_bf16 v[104:107], a[20:23], v[76:79], v[104:107]
    v_mul_f32 v97, s87, v97
    v_mfma_f32_16x16x32_bf16 v[108:111], a[52:55], v[76:79], v[108:111]
    v_mul_f32 v98, s87, v98
    v_mfma_f32_16x16x32_bf16 v[112:115], a[84:87], v[76:79], v[112:115]
    v_mul_f32 v99, s87, v99
    v_mfma_f32_16x16x32_bf16 v[116:119], a[116:119], v[76:79], v[116:119]
    v_mul_f32 v100, s87, v100
    v_mfma_f32_16x16x32_bf16 v[104:107], a[24:27], v[80:83], v[104:107]
    v_mul_f32 v101, s87, v101
    v_mfma_f32_16x16x32_bf16 v[108:111], a[56:59], v[80:83], v[108:111]
    v_mul_f32 v102, s87, v102
    v_mfma_f32_16x16x32_bf16 v[112:115], a[88:91], v[80:83], v[112:115]
    v_mul_f32 v103, s87, v103
    v_mfma_f32_16x16x32_bf16 v[116:119], a[120:123], v[80:83], v[116:119]
    v_cvt_pk_bf16_f32 v124, v96, v97
    v_mfma_f32_16x16x32_bf16 v[104:107], a[28:31], v[84:87], v[104:107]
    v_cvt_pk_bf16_f32 v125, v100, v101
    v_mfma_f32_16x16x32_bf16 v[108:111], a[60:63], v[84:87], v[108:111]
    v_cvt_pk_bf16_f32 v126, v98, v99
    v_mfma_f32_16x16x32_bf16 v[112:115], a[92:95], v[84:87], v[112:115]
    v_cvt_pk_bf16_f32 v127, v102, v103
    v_mfma_f32_16x16x32_bf16 v[116:119], a[124:127], v[84:87], v[116:119]
    buffer_store_dwordx4 v[124:127], v22, s[4:7], s84 offen offset:512 sc1
    s_waitcnt lgkmcnt(0)
    v_mfma_f32_16x16x32_bf16 v[88:91], a[0:3], v[24:27], 0
    ds_read_b128 v[56:59], v16 offset:40960
    ds_read_b128 v[60:63], v17 offset:40960
    v_mfma_f32_16x16x32_bf16 v[92:95], a[32:35], v[24:27], 0
    ds_read_b128 v[64:67], v18 offset:40960
    ds_read_b128 v[68:71], v19 offset:40960
    v_mfma_f32_16x16x32_bf16 v[96:99], a[64:67], v[24:27], 0
    ds_read_b128 v[72:75], v16 offset:41216
    v_mfma_f32_16x16x32_bf16 v[100:103], a[96:99], v[24:27], 0
    ds_read_b128 v[76:79], v17 offset:41216
    v_mfma_f32_16x16x32_bf16 v[88:91], a[4:7], v[28:31], v[88:91]
    ds_read_b128 v[80:83], v18 offset:41216
    v_mfma_f32_16x16x32_bf16 v[92:95], a[36:39], v[28:31], v[92:95]
    ds_read_b128 v[84:87], v19 offset:41216
    v_mfma_f32_16x16x32_bf16 v[96:99], a[68:71], v[28:31], v[96:99]
    v_mul_f32 v104, s87, v104
    v_mfma_f32_16x16x32_bf16 v[100:103], a[100:103], v[28:31], v[100:103]
    v_mul_f32 v105, s87, v105
    v_mfma_f32_16x16x32_bf16 v[88:91], a[8:11], v[32:35], v[88:91]
    v_mul_f32 v106, s87, v106
    v_mfma_f32_16x16x32_bf16 v[92:95], a[40:43], v[32:35], v[92:95]
    v_mul_f32 v107, s87, v107
    v_mfma_f32_16x16x32_bf16 v[96:99], a[72:75], v[32:35], v[96:99]
    v_mul_f32 v108, s87, v108
    v_mfma_f32_16x16x32_bf16 v[100:103], a[104:107], v[32:35], v[100:103]
    v_mul_f32 v109, s87, v109
    v_mfma_f32_16x16x32_bf16 v[88:91], a[12:15], v[36:39], v[88:91]
    v_mul_f32 v110, s87, v110
    v_mfma_f32_16x16x32_bf16 v[92:95], a[44:47], v[36:39], v[92:95]
    v_mul_f32 v111, s87, v111
    v_mfma_f32_16x16x32_bf16 v[96:99], a[76:79], v[36:39], v[96:99]
    v_cvt_pk_bf16_f32 v128, v104, v105
    v_mfma_f32_16x16x32_bf16 v[100:103], a[108:111], v[36:39], v[100:103]
    v_cvt_pk_bf16_f32 v129, v108, v109
    v_mfma_f32_16x16x32_bf16 v[88:91], a[16:19], v[40:43], v[88:91]
    v_cvt_pk_bf16_f32 v130, v106, v107
    v_mfma_f32_16x16x32_bf16 v[92:95], a[48:51], v[40:43], v[92:95]
    v_cvt_pk_bf16_f32 v131, v110, v111
    v_mfma_f32_16x16x32_bf16 v[96:99], a[80:83], v[40:43], v[96:99]
    buffer_store_dwordx4 v[128:131], v22, s[4:7], s85 offen offset:768 sc1
    v_mfma_f32_16x16x32_bf16 v[100:103], a[112:115], v[40:43], v[100:103]
    v_mul_f32 v112, s87, v112
    v_mfma_f32_16x16x32_bf16 v[88:91], a[20:23], v[44:47], v[88:91]
    v_mul_f32 v113, s87, v113
    v_mfma_f32_16x16x32_bf16 v[92:95], a[52:55], v[44:47], v[92:95]
    v_mul_f32 v114, s87, v114
    v_mfma_f32_16x16x32_bf16 v[96:99], a[84:87], v[44:47], v[96:99]
    v_mul_f32 v115, s87, v115
    v_mfma_f32_16x16x32_bf16 v[100:103], a[116:119], v[44:47], v[100:103]
    v_mul_f32 v116, s87, v116
    v_mfma_f32_16x16x32_bf16 v[88:91], a[24:27], v[48:51], v[88:91]
    v_mul_f32 v117, s87, v117
    v_mfma_f32_16x16x32_bf16 v[92:95], a[56:59], v[48:51], v[92:95]
    v_mul_f32 v118, s87, v118
    v_mfma_f32_16x16x32_bf16 v[96:99], a[88:91], v[48:51], v[96:99]
    v_mul_f32 v119, s87, v119
    v_mfma_f32_16x16x32_bf16 v[100:103], a[120:123], v[48:51], v[100:103]
    v_cvt_pk_bf16_f32 v132, v112, v113
    v_mfma_f32_16x16x32_bf16 v[88:91], a[28:31], v[52:55], v[88:91]
    v_cvt_pk_bf16_f32 v133, v116, v117
    v_mfma_f32_16x16x32_bf16 v[92:95], a[60:63], v[52:55], v[92:95]
    v_cvt_pk_bf16_f32 v134, v114, v115
    v_mfma_f32_16x16x32_bf16 v[96:99], a[92:95], v[52:55], v[96:99]
    v_cvt_pk_bf16_f32 v135, v118, v119
    v_mfma_f32_16x16x32_bf16 v[100:103], a[124:127], v[52:55], v[100:103]
    buffer_store_dwordx4 v[132:135], v22, s[4:7], s84 offen offset:768 sc1
    s_waitcnt lgkmcnt(0)
    v_mfma_f32_16x16x32_bf16 v[104:107], a[0:3], v[56:59], 0
    ds_read_b128 v[24:27], v16 offset:49152
    ds_read_b128 v[28:31], v17 offset:49152
    v_mfma_f32_16x16x32_bf16 v[108:111], a[32:35], v[56:59], 0
    ds_read_b128 v[32:35], v18 offset:49152
    ds_read_b128 v[36:39], v19 offset:49152
    v_mfma_f32_16x16x32_bf16 v[112:115], a[64:67], v[56:59], 0
    ds_read_b128 v[40:43], v16 offset:49408
    v_mfma_f32_16x16x32_bf16 v[116:119], a[96:99], v[56:59], 0
    ds_read_b128 v[44:47], v17 offset:49408
    v_mfma_f32_16x16x32_bf16 v[104:107], a[4:7], v[60:63], v[104:107]
    ds_read_b128 v[48:51], v18 offset:49408
    v_mfma_f32_16x16x32_bf16 v[108:111], a[36:39], v[60:63], v[108:111]
    ds_read_b128 v[52:55], v19 offset:49408
    v_mfma_f32_16x16x32_bf16 v[112:115], a[68:71], v[60:63], v[112:115]
    v_mul_f32 v88, s87, v88
    v_mfma_f32_16x16x32_bf16 v[116:119], a[100:103], v[60:63], v[116:119]
    v_mul_f32 v89, s87, v89
    v_mfma_f32_16x16x32_bf16 v[104:107], a[8:11], v[64:67], v[104:107]
    v_mul_f32 v90, s87, v90
    v_mfma_f32_16x16x32_bf16 v[108:111], a[40:43], v[64:67], v[108:111]
    v_mul_f32 v91, s87, v91
    v_mfma_f32_16x16x32_bf16 v[112:115], a[72:75], v[64:67], v[112:115]
    v_mul_f32 v92, s87, v92
    v_mfma_f32_16x16x32_bf16 v[116:119], a[104:107], v[64:67], v[116:119]
    v_mul_f32 v93, s87, v93
    v_mfma_f32_16x16x32_bf16 v[104:107], a[12:15], v[68:71], v[104:107]
    v_mul_f32 v94, s87, v94
    v_mfma_f32_16x16x32_bf16 v[108:111], a[44:47], v[68:71], v[108:111]
    v_mul_f32 v95, s87, v95
    v_mfma_f32_16x16x32_bf16 v[112:115], a[76:79], v[68:71], v[112:115]
    v_cvt_pk_bf16_f32 v120, v88, v89
    v_mfma_f32_16x16x32_bf16 v[116:119], a[108:111], v[68:71], v[116:119]
    v_cvt_pk_bf16_f32 v121, v92, v93
    v_mfma_f32_16x16x32_bf16 v[104:107], a[16:19], v[72:75], v[104:107]
    v_cvt_pk_bf16_f32 v122, v90, v91
    v_mfma_f32_16x16x32_bf16 v[108:111], a[48:51], v[72:75], v[108:111]
    v_cvt_pk_bf16_f32 v123, v94, v95
    v_mfma_f32_16x16x32_bf16 v[112:115], a[80:83], v[72:75], v[112:115]
    buffer_store_dwordx4 v[120:123], v22, s[4:7], s85 offen offset:1024 sc1
    v_mfma_f32_16x16x32_bf16 v[116:119], a[112:115], v[72:75], v[116:119]
    v_mul_f32 v96, s87, v96
    v_mfma_f32_16x16x32_bf16 v[104:107], a[20:23], v[76:79], v[104:107]
    v_mul_f32 v97, s87, v97
    v_mfma_f32_16x16x32_bf16 v[108:111], a[52:55], v[76:79], v[108:111]
    v_mul_f32 v98, s87, v98
    v_mfma_f32_16x16x32_bf16 v[112:115], a[84:87], v[76:79], v[112:115]
    v_mul_f32 v99, s87, v99
    v_mfma_f32_16x16x32_bf16 v[116:119], a[116:119], v[76:79], v[116:119]
    v_mul_f32 v100, s87, v100
    v_mfma_f32_16x16x32_bf16 v[104:107], a[24:27], v[80:83], v[104:107]
    v_mul_f32 v101, s87, v101
    v_mfma_f32_16x16x32_bf16 v[108:111], a[56:59], v[80:83], v[108:111]
    v_mul_f32 v102, s87, v102
    v_mfma_f32_16x16x32_bf16 v[112:115], a[88:91], v[80:83], v[112:115]
    v_mul_f32 v103, s87, v103
    v_mfma_f32_16x16x32_bf16 v[116:119], a[120:123], v[80:83], v[116:119]
    v_cvt_pk_bf16_f32 v124, v96, v97
    v_mfma_f32_16x16x32_bf16 v[104:107], a[28:31], v[84:87], v[104:107]
    v_cvt_pk_bf16_f32 v125, v100, v101
    v_mfma_f32_16x16x32_bf16 v[108:111], a[60:63], v[84:87], v[108:111]
    v_cvt_pk_bf16_f32 v126, v98, v99
    v_mfma_f32_16x16x32_bf16 v[112:115], a[92:95], v[84:87], v[112:115]
    v_cvt_pk_bf16_f32 v127, v102, v103
    v_mfma_f32_16x16x32_bf16 v[116:119], a[124:127], v[84:87], v[116:119]
    buffer_store_dwordx4 v[124:127], v22, s[4:7], s84 offen offset:1024 sc1
    s_waitcnt lgkmcnt(0)
    v_mfma_f32_16x16x32_bf16 v[88:91], a[0:3], v[24:27], 0
    s_nop 1
    v_mfma_f32_16x16x32_bf16 v[92:95], a[32:35], v[24:27], 0
    s_nop 1
    v_mfma_f32_16x16x32_bf16 v[96:99], a[64:67], v[24:27], 0
    s_nop 1
    v_mfma_f32_16x16x32_bf16 v[100:103], a[96:99], v[24:27], 0
    s_nop 1
    v_mfma_f32_16x16x32_bf16 v[88:91], a[4:7], v[28:31], v[88:91]
    s_nop 1
    v_mfma_f32_16x16x32_bf16 v[92:95], a[36:39], v[28:31], v[92:95]
    s_nop 1
    v_mfma_f32_16x16x32_bf16 v[96:99], a[68:71], v[28:31], v[96:99]
    v_mul_f32 v104, s87, v104
    v_mfma_f32_16x16x32_bf16 v[100:103], a[100:103], v[28:31], v[100:103]
    v_mul_f32 v105, s87, v105
    v_mfma_f32_16x16x32_bf16 v[88:91], a[8:11], v[32:35], v[88:91]
    v_mul_f32 v106, s87, v106
    v_mfma_f32_16x16x32_bf16 v[92:95], a[40:43], v[32:35], v[92:95]
    v_mul_f32 v107, s87, v107
    v_mfma_f32_16x16x32_bf16 v[96:99], a[72:75], v[32:35], v[96:99]
    v_mul_f32 v108, s87, v108
    v_mfma_f32_16x16x32_bf16 v[100:103], a[104:107], v[32:35], v[100:103]
    v_mul_f32 v109, s87, v109
    v_mfma_f32_16x16x32_bf16 v[88:91], a[12:15], v[36:39], v[88:91]
    v_mul_f32 v110, s87, v110
    v_mfma_f32_16x16x32_bf16 v[92:95], a[44:47], v[36:39], v[92:95]
    v_mul_f32 v111, s87, v111
    v_mfma_f32_16x16x32_bf16 v[96:99], a[76:79], v[36:39], v[96:99]
    v_cvt_pk_bf16_f32 v128, v104, v105
    v_mfma_f32_16x16x32_bf16 v[100:103], a[108:111], v[36:39], v[100:103]
    v_cvt_pk_bf16_f32 v129, v108, v109
    v_mfma_f32_16x16x32_bf16 v[88:91], a[16:19], v[40:43], v[88:91]
    v_cvt_pk_bf16_f32 v130, v106, v107
    v_mfma_f32_16x16x32_bf16 v[92:95], a[48:51], v[40:43], v[92:95]
    v_cvt_pk_bf16_f32 v131, v110, v111
    v_mfma_f32_16x16x32_bf16 v[96:99], a[80:83], v[40:43], v[96:99]
    buffer_store_dwordx4 v[128:131], v22, s[4:7], s85 offen offset:1280 sc1
    v_mfma_f32_16x16x32_bf16 v[100:103], a[112:115], v[40:43], v[100:103]
    v_mul_f32 v112, s87, v112
    v_mfma_f32_16x16x32_bf16 v[88:91], a[20:23], v[44:47], v[88:91]
    v_mul_f32 v113, s87, v113
    v_mfma_f32_16x16x32_bf16 v[92:95], a[52:55], v[44:47], v[92:95]
    v_mul_f32 v114, s87, v114
    v_mfma_f32_16x16x32_bf16 v[96:99], a[84:87], v[44:47], v[96:99]
    v_mul_f32 v115, s87, v115
    v_mfma_f32_16x16x32_bf16 v[100:103], a[116:119], v[44:47], v[100:103]
    v_mul_f32 v116, s87, v116
    v_mfma_f32_16x16x32_bf16 v[88:91], a[24:27], v[48:51], v[88:91]
    v_mul_f32 v117, s87, v117
    v_mfma_f32_16x16x32_bf16 v[92:95], a[56:59], v[48:51], v[92:95]
    v_mul_f32 v118, s87, v118
    v_mfma_f32_16x16x32_bf16 v[96:99], a[88:91], v[48:51], v[96:99]
    v_mul_f32 v119, s87, v119
    v_mfma_f32_16x16x32_bf16 v[100:103], a[120:123], v[48:51], v[100:103]
    v_cvt_pk_bf16_f32 v132, v112, v113
    v_mfma_f32_16x16x32_bf16 v[88:91], a[28:31], v[52:55], v[88:91]
    v_cvt_pk_bf16_f32 v133, v116, v117
    v_mfma_f32_16x16x32_bf16 v[92:95], a[60:63], v[52:55], v[92:95]
    v_cvt_pk_bf16_f32 v134, v114, v115
    v_mfma_f32_16x16x32_bf16 v[96:99], a[92:95], v[52:55], v[96:99]
    v_cvt_pk_bf16_f32 v135, v118, v119
    v_mfma_f32_16x16x32_bf16 v[100:103], a[124:127], v[52:55], v[100:103]
    buffer_store_dwordx4 v[132:135], v22, s[4:7], s84 offen offset:1280 sc1
    s_nop 7
    v_mul_f32 v88, s87, v88
    v_mul_f32 v89, s87, v89
    v_mul_f32 v90, s87, v90
    v_mul_f32 v91, s87, v91
    v_mul_f32 v92, s87, v92
    v_mul_f32 v93, s87, v93
    v_mul_f32 v94, s87, v94
    v_mul_f32 v95, s87, v95
    v_cvt_pk_bf16_f32 v120, v88, v89
    v_cvt_pk_bf16_f32 v121, v92, v93
    v_cvt_pk_bf16_f32 v122, v90, v91
    v_cvt_pk_bf16_f32 v123, v94, v95
    buffer_store_dwordx4 v[120:123], v22, s[4:7], s85 offen offset:1536 sc1
    v_mul_f32 v96, s87, v96
    v_mul_f32 v97, s87, v97
    v_mul_f32 v98, s87, v98
    v_mul_f32 v99, s87, v99
    v_mul_f32 v100, s87, v100
    v_mul_f32 v101, s87, v101
    v_mul_f32 v102, s87, v102
    v_mul_f32 v103, s87, v103
    v_cvt_pk_bf16_f32 v124, v96, v97
    v_cvt_pk_bf16_f32 v125, v100, v101
    v_cvt_pk_bf16_f32 v126, v98, v99
    v_cvt_pk_bf16_f32 v127, v102, v103
    buffer_store_dwordx4 v[124:127], v22, s[4:7], s84 offen offset:1536 sc1
    s_branch P0_fin
.p2align 6
P0_g21:
    ds_read_b64_tr_b16 v[24:25], v20 offset:0
    ds_read_b64_tr_b16 v[26:27], v20 offset:896
    ds_read_b64_tr_b16 v[28:29], v20 offset:7168
    ds_read_b64_tr_b16 v[30:31], v20 offset:8064
    ds_read_b64_tr_b16 v[32:33], v20 offset:14336
    ds_read_b64_tr_b16 v[34:35], v20 offset:15232
    ds_read_b64_tr_b16 v[36:37], v20 offset:21504
    ds_read_b64_tr_b16 v[38:39], v20 offset:22400
    ds_read_b64_tr_b16 v[40:41], v20 offset:28672
    ds_read_b64_tr_b16 v[42:43], v20 offset:29568
    ds_read_b64_tr_b16 v[44:45], v20 offset:35840
    ds_read_b64_tr_b16 v[46:47], v20 offset:36736
    ds_read_b64_tr_b16 v[48:49], v20 offset:43008
    ds_read_b64_tr_b16 v[50:51], v20 offset:43904
    ds_read_b64_tr_b16 v[52:53], v20 offset:50176
    ds_read_b64_tr_b16 v[54:55], v20 offset:51072
    s_waitcnt lgkmcnt(0)
    v_mfma_f32_16x16x32_bf16 v[88:91], a[0:3], v[24:27], 0
    ds_read_b64_tr_b16 v[56:57], v20 offset:32
    v_mfma_f32_16x16x32_bf16 v[92:95], a[32:35], v[24:27], 0
    ds_read_b64_tr_b16 v[58:59], v20 offset:928
    v_mfma_f32_16x16x32_bf16 v[96:99], a[64:67], v[24:27], 0
    ds_read_b64_tr_b16 v[60:61], v20 offset:7200
    v_mfma_f32_16x16x32_bf16 v[100:103], a[96:99], v[24:27], 0
    ds_read_b64_tr_b16 v[62:63], v20 offset:8096
    v_mfma_f32_16x16x32_bf16 v[88:91], a[4:7], v[28:31], v[88:91]
    ds_read_b64_tr_b16 v[64:65], v20 offset:14368
    v_mfma_f32_16x16x32_bf16 v[92:95], a[36:39], v[28:31], v[92:95]
    ds_read_b64_tr_b16 v[66:67], v20 offset:15264
    v_mfma_f32_16x16x32_bf16 v[96:99], a[68:71], v[28:31], v[96:99]
    ds_read_b64_tr_b16 v[68:69], v20 offset:21536
    v_mfma_f32_16x16x32_bf16 v[100:103], a[100:103], v[28:31], v[100:103]
    ds_read_b64_tr_b16 v[70:71], v20 offset:22432
    v_mfma_f32_16x16x32_bf16 v[88:91], a[8:11], v[32:35], v[88:91]
    ds_read_b64_tr_b16 v[72:73], v20 offset:28704
    v_mfma_f32_16x16x32_bf16 v[92:95], a[40:43], v[32:35], v[92:95]
    ds_read_b64_tr_b16 v[74:75], v20 offset:29600
    v_mfma_f32_16x16x32_bf16 v[96:99], a[72:75], v[32:35], v[96:99]
    ds_read_b64_tr_b16 v[76:77], v20 offset:35872
    v_mfma_f32_16x16x32_bf16 v[100:103], a[104:107], v[32:35], v[100:103]
    ds_read_b64_tr_b16 v[78:79], v20 offset:36768
    v_mfma_f32_16x16x32_bf16 v[88:91], a[12:15], v[36:39], v[88:91]
    ds_read_b64_tr_b16 v[80:81], v20 offset:43040
    v_mfma_f32_16x16x32_bf16 v[92:95], a[44:47], v[36:39], v[92:95]
    ds_read_b64_tr_b16 v[82:83], v20 offset:43936
    v_mfma_f32_16x16x32_bf16 v[96:99], a[76:79], v[36:39], v[96:99]
    ds_read_b64_tr_b16 v[84:85], v20 offset:50208
    v_mfma_f32_16x16x32_bf16 v[100:103], a[108:111], v[36:39], v[100:103]
    ds_read_b64_tr_b16 v[86:87], v20 offset:51104
    v_mfma_f32_16x16x32_bf16 v[88:91], a[16:19], v[40:43], v[88:91]
    v_mfma_f32_16x16x32_bf16 v[92:95], a[48:51], v[40:43], v[92:95]
    v_mfma_f32_16x16x32_bf16 v[96:99], a[80:83], v[40:43], v[96:99]
    v_mfma_f32_16x16x32_bf16 v[100:103], a[112:115], v[40:43], v[100:103]
    v_mfma_f32_16x16x32_bf16 v[88:91], a[20:23], v[44:47], v[88:91]
    v_mfma_f32_16x16x32_bf16 v[92:95], a[52:55], v[44:47], v[92:95]
    v_mfma_f32_16x16x32_bf16 v[96:99], a[84:87], v[44:47], v[96:99]
    v_mfma_f32_16x16x32_bf16 v[100:103], a[116:119], v[44:47], v[100:103]
    v_mfma_f32_16x16x32_bf16 v[88:91], a[24:27], v[48:51], v[88:91]
    v_mfma_f32_16x16x32_bf16 v[92:95], a[56:59], v[48:51], v[92:95]
    v_mfma_f32_16x16x32_bf16 v[96:99], a[88:91], v[48:51], v[96:99]
    v_mfma_f32_16x16x32_bf16 v[100:103], a[120:123], v[48:51], v[100:103]
    v_mfma_f32_16x16x32_bf16 v[88:91], a[28:31], v[52:55], v[88:91]
    v_mfma_f32_16x16x32_bf16 v[92:95], a[60:63], v[52:55], v[92:95]
    v_mfma_f32_16x16x32_bf16 v[96:99], a[92:95], v[52:55], v[96:99]
    v_mfma_f32_16x16x32_bf16 v[100:103], a[124:127], v[52:55], v[100:103]
    s_waitcnt lgkmcnt(0)
    v_mfma_f32_16x16x32_bf16 v[104:107], a[0:3], v[56:59], 0
    ds_read_b64_tr_b16 v[24:25], v20 offset:64
    v_mfma_f32_16x16x32_bf16 v[108:111], a[32:35], v[56:59], 0
    ds_read_b64_tr_b16 v[26:27], v20 offset:960
    v_mfma_f32_16x16x32_bf16 v[112:115], a[64:67], v[56:59], 0
    ds_read_b64_tr_b16 v[28:29], v20 offset:7232
    v_mfma_f32_16x16x32_bf16 v[116:119], a[96:99], v[56:59], 0
    ds_read_b64_tr_b16 v[30:31], v20 offset:8128
    v_mfma_f32_16x16x32_bf16 v[104:107], a[4:7], v[60:63], v[104:107]
    ds_read_b64_tr_b16 v[32:33], v20 offset:14400
    v_mfma_f32_16x16x32_bf16 v[108:111], a[36:39], v[60:63], v[108:111]
    ds_read_b64_tr_b16 v[34:35], v20 offset:15296
    v_mfma_f32_16x16x32_bf16 v[112:115], a[68:71], v[60:63], v[112:115]
    ds_read_b64_tr_b16 v[36:37], v20 offset:21568
    v_mfma_f32_16x16x32_bf16 v[116:119], a[100:103], v[60:63], v[116:119]
    ds_read_b64_tr_b16 v[38:39], v20 offset:22464
    v_mfma_f32_16x16x32_bf16 v[104:107], a[8:11], v[64:67], v[104:107]
    ds_read_b64_tr_b16 v[40:41], v20 offset:28736
    v_mfma_f32_16x16x32_bf16 v[108:111], a[40:43], v[64:67], v[108:111]
    ds_read_b64_tr_b16 v[42:43], v20 offset:29632
    v_mfma_f32_16x16x32_bf16 v[112:115], a[72:75], v[64:67], v[112:115]
    ds_read_b64_tr_b16 v[44:45], v20 offset:35904
    v_mfma_f32_16x16x32_bf16 v[116:119], a[104:107], v[64:67], v[116:119]
    ds_read_b64_tr_b16 v[46:47], v20 offset:36800
    v_mfma_f32_16x16x32_bf16 v[104:107], a[12:15], v[68:71], v[104:107]
    ds_read_b64_tr_b16 v[48:49], v20 offset:43072
    v_mfma_f32_16x16x32_bf16 v[108:111], a[44:47], v[68:71], v[108:111]
    ds_read_b64_tr_b16 v[50:51], v20 offset:43968
    v_mfma_f32_16x16x32_bf16 v[112:115], a[76:79], v[68:71], v[112:115]
    ds_read_b64_tr_b16 v[52:53], v20 offset:50240
    v_mfma_f32_16x16x32_bf16 v[116:119], a[108:111], v[68:71], v[116:119]
    ds_read_b64_tr_b16 v[54:55], v20 offset:51136
    v_mfma_f32_16x16x32_bf16 v[104:107], a[16:19], v[72:75], v[104:107]
    v_cvt_pk_bf16_f32 v120, v88, v89
    v_mfma_f32_16x16x32_bf16 v[108:111], a[48:51], v[72:75], v[108:111]
    v_cvt_pk_bf16_f32 v121, v92, v93
    v_mfma_f32_16x16x32_bf16 v[112:115], a[80:83], v[72:75], v[112:115]
    v_cvt_pk_bf16_f32 v122, v90, v91
    v_mfma_f32_16x16x32_bf16 v[116:119], a[112:115], v[72:75], v[116:119]
    v_cvt_pk_bf16_f32 v123, v94, v95
    v_mfma_f32_16x16x32_bf16 v[104:107], a[20:23], v[76:79], v[104:107]
    buffer_store_dwordx4 v[120:123], v22, s[4:7], s85 offen offset:0 sc1
    v_mfma_f32_16x16x32_bf16 v[108:111], a[52:55], v[76:79], v[108:111]
    v_cvt_pk_bf16_f32 v124, v96, v97
    v_mfma_f32_16x16x32_bf16 v[112:115], a[84:87], v[76:79], v[112:115]
    v_cvt_pk_bf16_f32 v125, v100, v101
    v_mfma_f32_16x16x32_bf16 v[116:119], a[116:119], v[76:79], v[116:119]
    v_cvt_pk_bf16_f32 v126, v98, v99
    v_mfma_f32_16x16x32_bf16 v[104:107], a[24:27], v[80:83], v[104:107]
    v_cvt_pk_bf16_f32 v127, v102, v103
    v_mfma_f32_16x16x32_bf16 v[108:111], a[56:59], v[80:83], v[108:111]
    buffer_store_dwordx4 v[124:127], v22, s[4:7], s84 offen offset:0 sc1
    v_mfma_f32_16x16x32_bf16 v[112:115], a[88:91], v[80:83], v[112:115]
    v_mfma_f32_16x16x32_bf16 v[116:119], a[120:123], v[80:83], v[116:119]
    v_mfma_f32_16x16x32_bf16 v[104:107], a[28:31], v[84:87], v[104:107]
    v_mfma_f32_16x16x32_bf16 v[108:111], a[60:63], v[84:87], v[108:111]
    v_mfma_f32_16x16x32_bf16 v[112:115], a[92:95], v[84:87], v[112:115]
    v_mfma_f32_16x16x32_bf16 v[116:119], a[124:127], v[84:87], v[116:119]
    s_waitcnt lgkmcnt(0)
    v_mfma_f32_16x16x32_bf16 v[88:91], a[0:3], v[24:27], 0
    ds_read_b64_tr_b16 v[56:57], v20 offset:96
    v_mfma_f32_16x16x32_bf16 v[92:95], a[32:35], v[24:27], 0
    ds_read_b64_tr_b16 v[58:59], v20 offset:992
    v_mfma_f32_16x16x32_bf16 v[96:99], a[64:67], v[24:27], 0
    ds_read_b64_tr_b16 v[60:61], v20 offset:7264
    v_mfma_f32_16x16x32_bf16 v[100:103], a[96:99], v[24:27], 0
    ds_read_b64_tr_b16 v[62:63], v20 offset:8160
    v_mfma_f32_16x16x32_bf16 v[88:91], a[4:7], v[28:31], v[88:91]
    ds_read_b64_tr_b16 v[64:65], v20 offset:14432
    v_mfma_f32_16x16x32_bf16 v[92:95], a[36:39], v[28:31], v[92:95]
    ds_read_b64_tr_b16 v[66:67], v20 offset:15328
    v_mfma_f32_16x16x32_bf16 v[96:99], a[68:71], v[28:31], v[96:99]
    ds_read_b64_tr_b16 v[68:69], v20 offset:21600
    v_mfma_f32_16x16x32_bf16 v[100:103], a[100:103], v[28:31], v[100:103]
    ds_read_b64_tr_b16 v[70:71], v20 offset:22496
    v_mfma_f32_16x16x32_bf16 v[88:91], a[8:11], v[32:35], v[88:91]
    ds_read_b64_tr_b16 v[72:73], v20 offset:28768
    v_mfma_f32_16x16x32_bf16 v[92:95], a[40:43], v[32:35], v[92:95]
    ds_read_b64_tr_b16 v[74:75], v20 offset:29664
    v_mfma_f32_16x16x32_bf16 v[96:99], a[72:75], v[32:35], v[96:99]
    ds_read_b64_tr_b16 v[76:77], v20 offset:35936
    v_mfma_f32_16x16x32_bf16 v[100:103], a[104:107], v[32:35], v[100:103]
    ds_read_b64_tr_b16 v[78:79], v20 offset:36832
    v_mfma_f32_16x16x32_bf16 v[88:91], a[12:15], v[36:39], v[88:91]
    ds_read_b64_tr_b16 v[80:81], v20 offset:43104
    v_mfma_f32_16x16x32_bf16 v[92:95], a[44:47], v[36:39], v[92:95]
    ds_read_b64_tr_b16 v[82:83], v20 offset:44000
    v_mfma_f32_16x16x32_bf16 v[96:99], a[76:79], v[36:39], v[96:99]
    ds_read_b64_tr_b16 v[84:85], v20 offset:50272
    v_mfma_f32_16x16x32_bf16 v[100:103], a[108:111], v[36:39], v[100:103]
    ds_read_b64_tr_b16 v[86:87], v20 offset:51168
    v_mfma_f32_16x16x32_bf16 v[88:91], a[16:19], v[40:43], v[88:91]
    v_cvt_pk_bf16_f32 v128, v104, v105
    v_mfma_f32_16x16x32_bf16 v[92:95], a[48:51], v[40:43], v[92:95]
    v_cvt_pk_bf16_f32 v129, v108, v109
    v_mfma_f32_16x16x32_bf16 v[96:99], a[80:83], v[40:43], v[96:99]
    v_cvt_pk_bf16_f32 v130, v106, v107
    v_mfma_f32_16x16x32_bf16 v[100:103], a[112:115], v[40:43], v[100:103]
    v_cvt_pk_bf16_f32 v131, v110, v111
    v_mfma_f32_16x16x32_bf16 v[88:91], a[20:23], v[44:47], v[88:91]
    buffer_store_dwordx4 v[128:131], v22, s[4:7], s85 offen offset:256 sc1
    v_mfma_f32_16x16x32_bf16 v[92:95], a[52:55], v[44:47], v[92:95]
    v_cvt_pk_bf16_f32 v132, v112, v113
    v_mfma_f32_16x16x32_bf16 v[96:99], a[84:87], v[44:47], v[96:99]
    v_cvt_pk_bf16_f32 v133, v116, v117
    v_mfma_f32_16x16x32_bf16 v[100:103], a[116:119], v[44:47], v[100:103]
    v_cvt_pk_bf16_f32 v134, v114, v115
    v_mfma_f32_16x16x32_bf16 v[88:91], a[24:27], v[48:51], v[88:91]
    v_cvt_pk_bf16_f32 v135, v118, v119
    v_mfma_f32_16x16x32_bf16 v[92:95], a[56:59], v[48:51], v[92:95]
    buffer_store_dwordx4 v[132:135], v22, s[4:7], s84 offen offset:256 sc1
    v_mfma_f32_16x16x32_bf16 v[96:99], a[88:91], v[48:51], v[96:99]
    v_mfma_f32_16x16x32_bf16 v[100:103], a[120:123], v[48:51], v[100:103]
    v_mfma_f32_16x16x32_bf16 v[88:91], a[28:31], v[52:55], v[88:91]
    v_mfma_f32_16x16x32_bf16 v[92:95], a[60:63], v[52:55], v[92:95]
    v_mfma_f32_16x16x32_bf16 v[96:99], a[92:95], v[52:55], v[96:99]
    v_mfma_f32_16x16x32_bf16 v[100:103], a[124:127], v[52:55], v[100:103]
    s_waitcnt lgkmcnt(0)
    v_mfma_f32_16x16x32_bf16 v[104:107], a[0:3], v[56:59], 0
    ds_read_b64_tr_b16 v[24:25], v20 offset:128
    v_mfma_f32_16x16x32_bf16 v[108:111], a[32:35], v[56:59], 0
    ds_read_b64_tr_b16 v[26:27], v20 offset:1024
    v_mfma_f32_16x16x32_bf16 v[112:115], a[64:67], v[56:59], 0
    ds_read_b64_tr_b16 v[28:29], v20 offset:7296
    v_mfma_f32_16x16x32_bf16 v[116:119], a[96:99], v[56:59], 0
    ds_read_b64_tr_b16 v[30:31], v20 offset:8192
    v_mfma_f32_16x16x32_bf16 v[104:107], a[4:7], v[60:63], v[104:107]
    ds_read_b64_tr_b16 v[32:33], v20 offset:14464
    v_mfma_f32_16x16x32_bf16 v[108:111], a[36:39], v[60:63], v[108:111]
    ds_read_b64_tr_b16 v[34:35], v20 offset:15360
    v_mfma_f32_16x16x32_bf16 v[112:115], a[68:71], v[60:63], v[112:115]
    ds_read_b64_tr_b16 v[36:37], v20 offset:21632
    v_mfma_f32_16x16x32_bf16 v[116:119], a[100:103], v[60:63], v[116:119]
    ds_read_b64_tr_b16 v[38:39], v20 offset:22528
    v_mfma_f32_16x16x32_bf16 v[104:107], a[8:11], v[64:67], v[104:107]
    ds_read_b64_tr_b16 v[40:41], v20 offset:28800
    v_mfma_f32_16x16x32_bf16 v[108:111], a[40:43], v[64:67], v[108:111]
    ds_read_b64_tr_b16 v[42:43], v20 offset:29696
    v_mfma_f32_16x16x32_bf16 v[112:115], a[72:75], v[64:67], v[112:115]
    ds_read_b64_tr_b16 v[44:45], v20 offset:35968
    v_mfma_f32_16x16x32_bf16 v[116:119], a[104:107], v[64:67], v[116:119]
    ds_read_b64_tr_b16 v[46:47], v20 offset:36864
    v_mfma_f32_16x16x32_bf16 v[104:107], a[12:15], v[68:71], v[104:107]
    ds_read_b64_tr_b16 v[48:49], v20 offset:43136
    v_mfma_f32_16x16x32_bf16 v[108:111], a[44:47], v[68:71], v[108:111]
    ds_read_b64_tr_b16 v[50:51], v20 offset:44032
    v_mfma_f32_16x16x32_bf16 v[112:115], a[76:79], v[68:71], v[112:115]
    ds_read_b64_tr_b16 v[52:53], v20 offset:50304
    v_mfma_f32_16x16x32_bf16 v[116:119], a[108:111], v[68:71], v[116:119]
    ds_read_b64_tr_b16 v[54:55], v20 offset:51200
    v_mfma_f32_16x16x32_bf16 v[104:107], a[16:19], v[72:75], v[104:107]
    v_cvt_pk_bf16_f32 v120, v88, v89
    v_mfma_f32_16x16x32_bf16 v[108:111], a[48:51], v[72:75], v[108:111]
    v_cvt_pk_bf16_f32 v121, v92, v93
    v_mfma_f32_16x16x32_bf16 v[112:115], a[80:83], v[72:75], v[112:115]
    v_cvt_pk_bf16_f32 v122, v90, v91
    v_mfma_f32_16x16x32_bf16 v[116:119], a[112:115], v[72:75], v[116:119]
    v_cvt_pk_bf16_f32 v123, v94, v95
    v_mfma_f32_16x16x32_bf16 v[104:107], a[20:23], v[76:79], v[104:107]
    buffer_store_dwordx4 v[120:123], v22, s[4:7], s85 offen offset:512 sc1
    v_mfma_f32_16x16x32_bf16 v[108:111], a[52:55], v[76:79], v[108:111]
    v_cvt_pk_bf16_f32 v124, v96, v97
    v_mfma_f32_16x16x32_bf16 v[112:115], a[84:87], v[76:79], v[112:115]
    v_cvt_pk_bf16_f32 v125, v100, v101
    v_mfma_f32_16x16x32_bf16 v[116:119], a[116:119], v[76:79], v[116:119]
    v_cvt_pk_bf16_f32 v126, v98, v99
    v_mfma_f32_16x16x32_bf16 v[104:107], a[24:27], v[80:83], v[104:107]
    v_cvt_pk_bf16_f32 v127, v102, v103
    v_mfma_f32_16x16x32_bf16 v[108:111], a[56:59], v[80:83], v[108:111]
    buffer_store_dwordx4 v[124:127], v22, s[4:7], s84 offen offset:512 sc1
    v_mfma_f32_16x16x32_bf16 v[112:115], a[88:91], v[80:83], v[112:115]
    v_mfma_f32_16x16x32_bf16 v[116:119], a[120:123], v[80:83], v[116:119]
    v_mfma_f32_16x16x32_bf16 v[104:107], a[28:31], v[84:87], v[104:107]
    v_mfma_f32_16x16x32_bf16 v[108:111], a[60:63], v[84:87], v[108:111]
    v_mfma_f32_16x16x32_bf16 v[112:115], a[92:95], v[84:87], v[112:115]
    v_mfma_f32_16x16x32_bf16 v[116:119], a[124:127], v[84:87], v[116:119]
    s_waitcnt lgkmcnt(0)
    v_mfma_f32_16x16x32_bf16 v[88:91], a[0:3], v[24:27], 0
    ds_read_b64_tr_b16 v[56:57], v20 offset:160
    v_mfma_f32_16x16x32_bf16 v[92:95], a[32:35], v[24:27], 0
    ds_read_b64_tr_b16 v[58:59], v20 offset:1056
    v_mfma_f32_16x16x32_bf16 v[96:99], a[64:67], v[24:27], 0
    ds_read_b64_tr_b16 v[60:61], v20 offset:7328
    v_mfma_f32_16x16x32_bf16 v[100:103], a[96:99], v[24:27], 0
    ds_read_b64_tr_b16 v[62:63], v20 offset:8224
    v_mfma_f32_16x16x32_bf16 v[88:91], a[4:7], v[28:31], v[88:91]
    ds_read_b64_tr_b16 v[64:65], v20 offset:14496
    v_mfma_f32_16x16x32_bf16 v[92:95], a[36:39], v[28:31], v[92:95]
    ds_read_b64_tr_b16 v[66:67], v20 offset:15392
    v_mfma_f32_16x16x32_bf16 v[96:99], a[68:71], v[28:31], v[96:99]
    ds_read_b64_tr_b16 v[68:69], v20 offset:21664
    v_mfma_f32_16x16x32_bf16 v[100:103], a[100:103], v[28:31], v[100:103]
    ds_read_b64_tr_b16 v[70:71], v20 offset:22560
    v_mfma_f32_16x16x32_bf16 v[88:91], a[8:11], v[32:35], v[88:91]
    ds_read_b64_tr_b16 v[72:73], v20 offset:28832
    v_mfma_f32_16x16x32_bf16 v[92:95], a[40:43], v[32:35], v[92:95]
    ds_read_b64_tr_b16 v[74:75], v20 offset:29728
    v_mfma_f32_16x16x32_bf16 v[96:99], a[72:75], v[32:35], v[96:99]
    ds_read_b64_tr_b16 v[76:77], v20 offset:36000
    v_mfma_f32_16x16x32_bf16 v[100:103], a[104:107], v[32:35], v[100:103]
    ds_read_b64_tr_b16 v[78:79], v20 offset:36896
    v_mfma_f32_16x16x32_bf16 v[88:91], a[12:15], v[36:39], v[88:91]
    ds_read_b64_tr_b16 v[80:81], v20 offset:43168
    v_mfma_f32_16x16x32_bf16 v[92:95], a[44:47], v[36:39], v[92:95]
    ds_read_b64_tr_b16 v[82:83], v20 offset:44064
    v_mfma_f32_16x16x32_bf16 v[96:99], a[76:79], v[36:39], v[96:99]
    ds_read_b64_tr_b16 v[84:85], v20 offset:50336
    v_mfma_f32_16x16x32_bf16 v[100:103], a[108:111], v[36:39], v[100:103]
    ds_read_b64_tr_b16 v[86:87], v20 offset:51232
    v_mfma_f32_16x16x32_bf16 v[88:91], a[16:19], v[40:43], v[88:91]
    v_cvt_pk_bf16_f32 v128, v104, v105
    v_mfma_f32_16x16x32_bf16 v[92:95], a[48:51], v[40:43], v[92:95]
    v_cvt_pk_bf16_f32 v129, v108, v109
    v_mfma_f32_16x16x32_bf16 v[96:99], a[80:83], v[40:43], v[96:99]
    v_cvt_pk_bf16_f32 v130, v106, v107
    v_mfma_f32_16x16x32_bf16 v[100:103], a[112:115], v[40:43], v[100:103]
    v_cvt_pk_bf16_f32 v131, v110, v111
    v_mfma_f32_16x16x32_bf16 v[88:91], a[20:23], v[44:47], v[88:91]
    buffer_store_dwordx4 v[128:131], v22, s[4:7], s85 offen offset:768 sc1
    v_mfma_f32_16x16x32_bf16 v[92:95], a[52:55], v[44:47], v[92:95]
    v_cvt_pk_bf16_f32 v132, v112, v113
    v_mfma_f32_16x16x32_bf16 v[96:99], a[84:87], v[44:47], v[96:99]
    v_cvt_pk_bf16_f32 v133, v116, v117
    v_mfma_f32_16x16x32_bf16 v[100:103], a[116:119], v[44:47], v[100:103]
    v_cvt_pk_bf16_f32 v134, v114, v115
    v_mfma_f32_16x16x32_bf16 v[88:91], a[24:27], v[48:51], v[88:91]
    v_cvt_pk_bf16_f32 v135, v118, v119
    v_mfma_f32_16x16x32_bf16 v[92:95], a[56:59], v[48:51], v[92:95]
    buffer_store_dwordx4 v[132:135], v22, s[4:7], s84 offen offset:768 sc1
    v_mfma_f32_16x16x32_bf16 v[96:99], a[88:91], v[48:51], v[96:99]
    v_mfma_f32_16x16x32_bf16 v[100:103], a[120:123], v[48:51], v[100:103]
    v_mfma_f32_16x16x32_bf16 v[88:91], a[28:31], v[52:55], v[88:91]
    v_mfma_f32_16x16x32_bf16 v[92:95], a[60:63], v[52:55], v[92:95]
    v_mfma_f32_16x16x32_bf16 v[96:99], a[92:95], v[52:55], v[96:99]
    v_mfma_f32_16x16x32_bf16 v[100:103], a[124:127], v[52:55], v[100:103]
    s_waitcnt lgkmcnt(0)
    v_mfma_f32_16x16x32_bf16 v[104:107], a[0:3], v[56:59], 0
    ds_read_b64_tr_b16 v[24:25], v20 offset:192
    v_mfma_f32_16x16x32_bf16 v[108:111], a[32:35], v[56:59], 0
    ds_read_b64_tr_b16 v[26:27], v20 offset:1088
    v_mfma_f32_16x16x32_bf16 v[112:115], a[64:67], v[56:59], 0
    ds_read_b64_tr_b16 v[28:29], v20 offset:7360
    v_mfma_f32_16x16x32_bf16 v[116:119], a[96:99], v[56:59], 0
    ds_read_b64_tr_b16 v[30:31], v20 offset:8256
    v_mfma_f32_16x16x32_bf16 v[104:107], a[4:7], v[60:63], v[104:107]
    ds_read_b64_tr_b16 v[32:33], v20 offset:14528
    v_mfma_f32_16x16x32_bf16 v[108:111], a[36:39], v[60:63], v[108:111]
    ds_read_b64_tr_b16 v[34:35], v20 offset:15424
    v_mfma_f32_16x16x32_bf16 v[112:115], a[68:71], v[60:63], v[112:115]
    ds_read_b64_tr_b16 v[36:37], v20 offset:21696
    v_mfma_f32_16x16x32_bf16 v[116:119], a[100:103], v[60:63], v[116:119]
    ds_read_b64_tr_b16 v[38:39], v20 offset:22592
    v_mfma_f32_16x16x32_bf16 v[104:107], a[8:11], v[64:67], v[104:107]
    ds_read_b64_tr_b16 v[40:41], v20 offset:28864
    v_mfma_f32_16x16x32_bf16 v[108:111], a[40:43], v[64:67], v[108:111]
    ds_read_b64_tr_b16 v[42:43], v20 offset:29760
    v_mfma_f32_16x16x32_bf16 v[112:115], a[72:75], v[64:67], v[112:115]
    ds_read_b64_tr_b16 v[44:45], v20 offset:36032
    v_mfma_f32_16x16x32_bf16 v[116:119], a[104:107], v[64:67], v[116:119]
    ds_read_b64_tr_b16 v[46:47], v20 offset:36928
    v_mfma_f32_16x16x32_bf16 v[104:107], a[12:15], v[68:71], v[104:107]
    ds_read_b64_tr_b16 v[48:49], v20 offset:43200
    v_mfma_f32_16x16x32_bf16 v[108:111], a[44:47], v[68:71], v[108:111]
    ds_read_b64_tr_b16 v[50:51], v20 offset:44096
    v_mfma_f32_16x16x32_bf16 v[112:115], a[76:79], v[68:71], v[112:115]
    ds_read_b64_tr_b16 v[52:53], v20 offset:50368
    v_mfma_f32_16x16x32_bf16 v[116:119], a[108:111], v[68:71], v[116:119]
    ds_read_b64_tr_b16 v[54:55], v20 offset:51264
    v_mfma_f32_16x16x32_bf16 v[104:107], a[16:19], v[72:75], v[104:107]
    v_cvt_pk_bf16_f32 v120, v88, v89
    v_mfma_f32_16x16x32_bf16 v[108:111], a[48:51], v[72:75], v[108:111]
    v_cvt_pk_bf16_f32 v121, v92, v93
    v_mfma_f32_16x16x32_bf16 v[112:115], a[80:83], v[72:75], v[112:115]
    v_cvt_pk_bf16_f32 v122, v90, v91
    v_mfma_f32_16x16x32_bf16 v[116:119], a[112:115], v[72:75], v[116:119]
    v_cvt_pk_bf16_f32 v123, v94, v95
    v_mfma_f32_16x16x32_bf16 v[104:107], a[20:23], v[76:79], v[104:107]
    buffer_store_dwordx4 v[120:123], v22, s[4:7], s85 offen offset:1024 sc1
    v_mfma_f32_16x16x32_bf16 v[108:111], a[52:55], v[76:79], v[108:111]
    v_cvt_pk_bf16_f32 v124, v96, v97
    v_mfma_f32_16x16x32_bf16 v[112:115], a[84:87], v[76:79], v[112:115]
    v_cvt_pk_bf16_f32 v125, v100, v101
    v_mfma_f32_16x16x32_bf16 v[116:119], a[116:119], v[76:79], v[116:119]
    v_cvt_pk_bf16_f32 v126, v98, v99
    v_mfma_f32_16x16x32_bf16 v[104:107], a[24:27], v[80:83], v[104:107]
    v_cvt_pk_bf16_f32 v127, v102, v103
    v_mfma_f32_16x16x32_bf16 v[108:111], a[56:59], v[80:83], v[108:111]
    buffer_store_dwordx4 v[124:127], v22, s[4:7], s84 offen offset:1024 sc1
    v_mfma_f32_16x16x32_bf16 v[112:115], a[88:91], v[80:83], v[112:115]
    v_mfma_f32_16x16x32_bf16 v[116:119], a[120:123], v[80:83], v[116:119]
    v_mfma_f32_16x16x32_bf16 v[104:107], a[28:31], v[84:87], v[104:107]
    v_mfma_f32_16x16x32_bf16 v[108:111], a[60:63], v[84:87], v[108:111]
    v_mfma_f32_16x16x32_bf16 v[112:115], a[92:95], v[84:87], v[112:115]
    v_mfma_f32_16x16x32_bf16 v[116:119], a[124:127], v[84:87], v[116:119]
    s_waitcnt lgkmcnt(0)
    v_mfma_f32_16x16x32_bf16 v[88:91], a[0:3], v[24:27], 0
    s_nop 1
    v_mfma_f32_16x16x32_bf16 v[92:95], a[32:35], v[24:27], 0
    s_nop 1
    v_mfma_f32_16x16x32_bf16 v[96:99], a[64:67], v[24:27], 0
    s_nop 1
    v_mfma_f32_16x16x32_bf16 v[100:103], a[96:99], v[24:27], 0
    s_nop 1
    v_mfma_f32_16x16x32_bf16 v[88:91], a[4:7], v[28:31], v[88:91]
    s_nop 1
    v_mfma_f32_16x16x32_bf16 v[92:95], a[36:39], v[28:31], v[92:95]
    s_nop 1
    v_mfma_f32_16x16x32_bf16 v[96:99], a[68:71], v[28:31], v[96:99]
    v_cvt_pk_bf16_f32 v128, v104, v105
    v_mfma_f32_16x16x32_bf16 v[100:103], a[100:103], v[28:31], v[100:103]
    v_cvt_pk_bf16_f32 v129, v108, v109
    v_mfma_f32_16x16x32_bf16 v[88:91], a[8:11], v[32:35], v[88:91]
    v_cvt_pk_bf16_f32 v130, v106, v107
    v_mfma_f32_16x16x32_bf16 v[92:95], a[40:43], v[32:35], v[92:95]
    v_cvt_pk_bf16_f32 v131, v110, v111
    v_mfma_f32_16x16x32_bf16 v[96:99], a[72:75], v[32:35], v[96:99]
    buffer_store_dwordx4 v[128:131], v22, s[4:7], s85 offen offset:1280 sc1
    v_mfma_f32_16x16x32_bf16 v[100:103], a[104:107], v[32:35], v[100:103]
    v_cvt_pk_bf16_f32 v132, v112, v113
    v_mfma_f32_16x16x32_bf16 v[88:91], a[12:15], v[36:39], v[88:91]
    v_cvt_pk_bf16_f32 v133, v116, v117
    v_mfma_f32_16x16x32_bf16 v[92:95], a[44:47], v[36:39], v[92:95]
    v_cvt_pk_bf16_f32 v134, v114, v115
    v_mfma_f32_16x16x32_bf16 v[96:99], a[76:79], v[36:39], v[96:99]
    v_cvt_pk_bf16_f32 v135, v118, v119
    v_mfma_f32_16x16x32_bf16 v[100:103], a[108:111], v[36:39], v[100:103]
    buffer_store_dwordx4 v[132:135], v22, s[4:7], s84 offen offset:1280 sc1
    v_mfma_f32_16x16x32_bf16 v[88:91], a[16:19], v[40:43], v[88:91]
    v_mfma_f32_16x16x32_bf16 v[92:95], a[48:51], v[40:43], v[92:95]
    v_mfma_f32_16x16x32_bf16 v[96:99], a[80:83], v[40:43], v[96:99]
    v_mfma_f32_16x16x32_bf16 v[100:103], a[112:115], v[40:43], v[100:103]
    v_mfma_f32_16x16x32_bf16 v[88:91], a[20:23], v[44:47], v[88:91]
    v_mfma_f32_16x16x32_bf16 v[92:95], a[52:55], v[44:47], v[92:95]
    v_mfma_f32_16x16x32_bf16 v[96:99], a[84:87], v[44:47], v[96:99]
    v_mfma_f32_16x16x32_bf16 v[100:103], a[116:119], v[44:47], v[100:103]
    v_mfma_f32_16x16x32_bf16 v[88:91], a[24:27], v[48:51], v[88:91]
    v_mfma_f32_16x16x32_bf16 v[92:95], a[56:59], v[48:51], v[92:95]
    v_mfma_f32_16x16x32_bf16 v[96:99], a[88:91], v[48:51], v[96:99]
    v_mfma_f32_16x16x32_bf16 v[100:103], a[120:123], v[48:51], v[100:103]
    v_mfma_f32_16x16x32_bf16 v[88:91], a[28:31], v[52:55], v[88:91]
    v_mfma_f32_16x16x32_bf16 v[92:95], a[60:63], v[52:55], v[92:95]
    v_mfma_f32_16x16x32_bf16 v[96:99], a[92:95], v[52:55], v[96:99]
    v_mfma_f32_16x16x32_bf16 v[100:103], a[124:127], v[52:55], v[100:103]
    s_nop 7
    v_cvt_pk_bf16_f32 v120, v88, v89
    v_cvt_pk_bf16_f32 v121, v92, v93
    v_cvt_pk_bf16_f32 v122, v90, v91
    v_cvt_pk_bf16_f32 v123, v94, v95
    buffer_store_dwordx4 v[120:123], v22, s[4:7], s85 offen offset:1536 sc1
    v_cvt_pk_bf16_f32 v124, v96, v97
    v_cvt_pk_bf16_f32 v125, v100, v101
    v_cvt_pk_bf16_f32 v126, v98, v99
    v_cvt_pk_bf16_f32 v127, v102, v103
    buffer_store_dwordx4 v[124:127], v22, s[4:7], s84 offen offset:1536 sc1
    s_branch P0_fin
.p2align 3
P0_t:
    v_readfirstlane_b32 s86, v255
    s_mul_i32 s86, s86, 0x9e3779b1
    s_add_u32 s86, s86, 0x7f4a7c15
    s_and_b32 s86, s86, 0xfffffffe
    v_mov_b32 v5, 0
    s_mov_b32 s87, s26
    s_mov_b32 s29, 8
P0_ticket:
    v_readfirstlane_b32 s25, v254
    s_cmp_lt_u32 s25, 32
    s_cbranch_scc1 P0_got
    s_add_u32 s3, s3, 1
    s_and_b32 s3, s3, 7
    s_sub_u32 s29, s29, 1
    s_cmp_eq_u32 s29, 0
    s_cbranch_scc1 P0_none
    s_lshl_b32 s28, s3, 5
    v_mov_b32 v254, 1
    s_mov_b64 exec, 1
    buffer_atomic_add v254, v5, s[80:83], s28 offen sc0
    s_mov_b64 exec, -1
    s_waitcnt vmcnt(0)
    s_branch P0_ticket
P0_none:
    s_mov_b32 s3, 7
    s_mov_b32 s25, 31
P0_got:
    s_lshl_b32 s28, s3, 5
    s_add_u32 s25, s25, s28
    s_cmp_lg_u32 s87, 0
    s_cselect_b32 s28, 1, 0
    s_cmp_lt_u32 s25, 32
    s_cselect_b32 s28, s28, 0
    s_or_b32 s28, s28, s86
    v_mov_b32 v6, s28
    s_and_b32 s28, s2, 63
    s_lshl_b32 s28, s28, 7
    s_lshr_b32 s29, s2, 6
    s_lshl_b32 s29, s29, 2
    s_add_u32 s28, s28, s29
    s_add_u32 s28, s28, 72941568
    v_mov_b32 v8, s25
    v_mov_b32 v9, s86
    ds_write_b64 v21, v[8:9]
P0_fin:
    s_waitcnt vmcnt(0) lgkmcnt(0)
    s_barrier
    v_mov_b32 v5, 0
    s_cmp_lg_u32 s24, 3
    s_cbranch_scc1 P0_nosl
    s_mov_b64 exec, 1
    buffer_store_dword v6, v5, s[4:7], s28 offen sc1
    s_mov_b64 exec, -1
P0_nosl:
    ds_read_b64 v[8:9], v21
    s_mov_b32 s49, 72941568
    s_waitcnt lgkmcnt(0)
    v_readfirstlane_b32 s25, v8
    v_readfirstlane_b32 s48, v9
    s_and_b32 s25, s25, 0xff
    s_mov_b32 s93, s25
    s_cmp_lt_u32 s25, 16
    s_cbranch_scc1 K2_A
    s_cmp_lt_u32 s25, 32
    s_cbranch_scc1 K2_B
    s_sub_u32 s25, s25, 32
    s_cmp_ge_u32 s25, 192
    s_cbranch_scc1 K2_E
    s_cmp_ge_u32 s25, 168
    s_cbranch_scc1 K2_W2
    s_cmp_ge_u32 s25, 144
    s_cbranch_scc1 K2_W1
    s_mul_hi_u32 s30, s25, 477218589
    s_mul_i32 s31, s30, 9
    s_sub_u32 s31, s25, s31
    s_cmp_lt_u32 s31, 5
    s_cbranch_scc1 K2_V
    s_branch K2_T
K2_A:
    s_lshr_b32 s28, s25, 2
    s_xor_b32 s28, s28, 4
    s_and_b32 s29, s25, 3
    s_lshl_b32 s29, s29, 3
    s_or_b32 s28, s28, s29
    s_lshl_b32 s28, s28, 7
    v_and_b32 v12, 1, v1
    v_lshlrev_b32 v12, 12, v12
    v_add_u32 v12, s28, v12
    v_and_b32 v13, 7, v1
    v_lshlrev_b32 v13, 10, v13
    s_and_b32 s28, s2, 7
    s_lshl_b32 s28, s28, 7
    v_add_u32 v13, s28, v13
    v_cmp_le_u32 vcc, 32, v1
    s_nop 1
    v_cndmask_b32 v12, v12, v13, vcc
    s_cmp_lg_u32 s24, 0
    s_cbranch_scc1 Lmw_3
Lsw_4:
    buffer_load_dwordx4 v[8:11], v12, s[4:7], s49 offen sc1
Lse_6:
    s_waitcnt vmcnt(0)
    v_xor_b32 v8, s48, v8
    v_xor_b32 v9, s48, v9
    v_xor_b32 v10, s48, v10
    v_xor_b32 v11, s48, v11
    v_or3_b32 v8, v8, v9, v10
    v_or_b32 v8, v8, v11
    v_cmp_lt_u32 vcc, 1, v8
    s_cbranch_vccz Lsd_5
    s_sleep 1
    s_sub_u32 s27, s27, 1
    s_cbranch_scc1 K2_end
    s_branch Lsw_4
Lsd_5:
Lmw_3:
    s_barrier
    s_mul_i32 s50, s25, 401408
    s_lshl_b32 s51, s24, 8
    s_add_u32 s50, s50, s51
    s_add_u32 s50, s50, 2097152
    v_mul_u32_u24 v7, 7168, v3
    v_lshl_add_u32 v64, v2, 4, v7
    v_add_u32 v65, 4096, v64
    buffer_load_dwordx4 a[0:3], v64, s[4:7], s50 offen offset:0
    buffer_load_dwordx4 a[56:59], v64, s[4:7], s50 offen offset:1024
    buffer_load_dwordx4 a[112:115], v64, s[4:7], s50 offen offset:2048
    buffer_load_dwordx4 a[168:171], v64, s[4:7], s50 offen offset:3072
    buffer_load_dwordx4 a[224:227], v65, s[4:7], s50 offen offset:0
    buffer_load_dwordx4 v[144:147], v65, s[4:7], s50 offen offset:1024
    buffer_load_dwordx4 v[200:203], v65, s[4:7], s50 offen offset:2048
    s_add_u32 s50, s50, 28672
    buffer_load_dwordx4 a[4:7], v64, s[4:7], s50 offen offset:0
    buffer_load_dwordx4 a[60:63], v64, s[4:7], s50 offen offset:1024
    buffer_load_dwordx4 a[116:119], v64, s[4:7], s50 offen offset:2048
    buffer_load_dwordx4 a[172:175], v64, s[4:7], s50 offen offset:3072
    buffer_load_dwordx4 a[228:231], v65, s[4:7], s50 offen offset:0
    buffer_load_dwordx4 v[148:151], v65, s[4:7], s50 offen offset:1024
    buffer_load_dwordx4 v[204:207], v65, s[4:7], s50 offen offset:2048
    s_add_u32 s50, s50, 28672
    buffer_load_dwordx4 a[8:11], v64, s[4:7], s50 offen offset:0
    buffer_load_dwordx4 a[64:67], v64, s[4:7], s50 offen offset:1024
    buffer_load_dwordx4 a[120:123], v64, s[4:7], s50 offen offset:2048
    buffer_load_dwordx4 a[176:179], v64, s[4:7], s50 offen offset:3072
    buffer_load_dwordx4 a[232:235], v65, s[4:7], s50 offen offset:0
    buffer_load_dwordx4 v[152:155], v65, s[4:7], s50 offen offset:1024
    buffer_load_dwordx4 v[208:211], v65, s[4:7], s50 offen offset:2048
    s_add_u32 s50, s50, 28672
    buffer_load_dwordx4 a[12:15], v64, s[4:7], s50 offen offset:0
    buffer_load_dwordx4 a[68:71], v64, s[4:7], s50 offen offset:1024
    buffer_load_dwordx4 a[124:127], v64, s[4:7], s50 offen offset:2048
    buffer_load_dwordx4 a[180:183], v64, s[4:7], s50 offen offset:3072
    buffer_load_dwordx4 a[236:239], v65, s[4:7], s50 offen offset:0
    buffer_load_dwordx4 v[156:159], v65, s[4:7], s50 offen offset:1024
    buffer_load_dwordx4 v[212:215], v65, s[4:7], s50 offen offset:2048
    s_add_u32 s50, s50, 28672
    buffer_load_dwordx4 a[16:19], v64, s[4:7], s50 offen offset:0
    buffer_load_dwordx4 a[72:75], v64, s[4:7], s50 offen offset:1024
    buffer_load_dwordx4 a[128:131], v64, s[4:7], s50 offen offset:2048
    buffer_load_dwordx4 a[184:187], v64, s[4:7], s50 offen offset:3072
    buffer_load_dwordx4 a[240:243], v65, s[4:7], s50 offen offset:0
    buffer_load_dwordx4 v[160:163], v65, s[4:7], s50 offen offset:1024
    buffer_load_dwordx4 v[216:219], v65, s[4:7], s50 offen offset:2048
    s_add_u32 s50, s50, 28672
    buffer_load_dwordx4 a[20:23], v64, s[4:7], s50 offen offset:0
    buffer_load_dwordx4 a[76:79], v64, s[4:7], s50 offen offset:1024
    buffer_load_dwordx4 a[132:135], v64, s[4:7], s50 offen offset:2048
    buffer_load_dwordx4 a[188:191], v64, s[4:7], s50 offen offset:3072
    buffer_load_dwordx4 a[244:247], v65, s[4:7], s50 offen offset:0
    buffer_load_dwordx4 v[164:167], v65, s[4:7], s50 offen offset:1024
    buffer_load_dwordx4 v[220:223], v65, s[4:7], s50 offen offset:2048
    s_add_u32 s50, s50, 28672
    buffer_load_dwordx4 a[24:27], v64, s[4:7], s50 offen offset:0
    buffer_load_dwordx4 a[80:83], v64, s[4:7], s50 offen offset:1024
    buffer_load_dwordx4 a[136:139], v64, s[4:7], s50 offen offset:2048
    buffer_load_dwordx4 a[192:195], v64, s[4:7], s50 offen offset:3072
    buffer_load_dwordx4 a[248:251], v65, s[4:7], s50 offen offset:0
    buffer_load_dwordx4 v[168:171], v65, s[4:7], s50 offen offset:1024
    buffer_load_dwordx4 v[224:227], v65, s[4:7], s50 offen offset:2048
    s_add_u32 s50, s50, 28672
    v_lshlrev_b32 v12, 7, v1
    s_waitcnt vmcnt(24)
    buffer_load_dwordx4 v[8:11], v12, s[4:7], s49 offen sc1
    buffer_load_dwordx4 a[28:31], v64, s[4:7], s50 offen offset:0
    buffer_load_dwordx4 a[84:87], v64, s[4:7], s50 offen offset:1024
    buffer_load_dwordx4 a[140:143], v64, s[4:7], s50 offen offset:2048
    buffer_load_dwordx4 a[196:199], v64, s[4:7], s50 offen offset:3072
    buffer_load_dwordx4 a[252:255], v65, s[4:7], s50 offen offset:0
    buffer_load_dwordx4 v[172:175], v65, s[4:7], s50 offen offset:1024
    buffer_load_dwordx4 v[228:231], v65, s[4:7], s50 offen offset:2048
    s_add_u32 s50, s50, 28672
    buffer_load_dwordx4 a[32:35], v64, s[4:7], s50 offen offset:0
    buffer_load_dwordx4 a[88:91], v64, s[4:7], s50 offen offset:1024
    buffer_load_dwordx4 a[144:147], v64, s[4:7], s50 offen offset:2048
    buffer_load_dwordx4 a[200:203], v64, s[4:7], s50 offen offset:3072
    buffer_load_dwordx4 v[120:123], v65, s[4:7], s50 offen offset:0
    buffer_load_dwordx4 v[176:179], v65, s[4:7], s50 offen offset:1024
    buffer_load_dwordx4 v[232:235], v65, s[4:7], s50 offen offset:2048
    s_add_u32 s50, s50, 28672
    buffer_load_dwordx4 a[36:39], v64, s[4:7], s50 offen offset:0
    buffer_load_dwordx4 a[92:95], v64, s[4:7], s50 offen offset:1024
    buffer_load_dwordx4 a[148:151], v64, s[4:7], s50 offen offset:2048
    buffer_load_dwordx4 a[204:207], v64, s[4:7], s50 offen offset:3072
    buffer_load_dwordx4 v[124:127], v65, s[4:7], s50 offen offset:0
    buffer_load_dwordx4 v[180:183], v65, s[4:7], s50 offen offset:1024
    buffer_load_dwordx4 v[236:239], v65, s[4:7], s50 offen offset:2048
    s_add_u32 s50, s50, 28672
    buffer_load_dwordx4 a[40:43], v64, s[4:7], s50 offen offset:0
    buffer_load_dwordx4 a[96:99], v64, s[4:7], s50 offen offset:1024
    buffer_load_dwordx4 a[152:155], v64, s[4:7], s50 offen offset:2048
    buffer_load_dwordx4 a[208:211], v64, s[4:7], s50 offen offset:3072
    buffer_load_dwordx4 v[128:131], v65, s[4:7], s50 offen offset:0
    buffer_load_dwordx4 v[184:187], v65, s[4:7], s50 offen offset:1024
    buffer_load_dwordx4 v[240:243], v65, s[4:7], s50 offen offset:2048
    s_add_u32 s50, s50, 28672
    buffer_load_dwordx4 a[44:47], v64, s[4:7], s50 offen offset:0
    buffer_load_dwordx4 a[100:103], v64, s[4:7], s50 offen offset:1024
    buffer_load_dwordx4 a[156:159], v64, s[4:7], s50 offen offset:2048
    buffer_load_dwordx4 a[212:215], v64, s[4:7], s50 offen offset:3072
    buffer_load_dwordx4 v[132:135], v65, s[4:7], s50 offen offset:0
    buffer_load_dwordx4 v[188:191], v65, s[4:7], s50 offen offset:1024
    buffer_load_dwordx4 v[244:247], v65, s[4:7], s50 offen offset:2048
    s_add_u32 s50, s50, 28672
    buffer_load_dwordx4 a[48:51], v64, s[4:7], s50 offen offset:0
    buffer_load_dwordx4 a[104:107], v64, s[4:7], s50 offen offset:1024
    buffer_load_dwordx4 a[160:163], v64, s[4:7], s50 offen offset:2048
    buffer_load_dwordx4 a[216:219], v64, s[4:7], s50 offen offset:3072
    buffer_load_dwordx4 v[136:139], v65, s[4:7], s50 offen offset:0
    buffer_load_dwordx4 v[192:195], v65, s[4:7], s50 offen offset:1024
    buffer_load_dwordx4 v[248:251], v65, s[4:7], s50 offen offset:2048
    s_add_u32 s50, s50, 28672
    buffer_load_dwordx4 a[52:55], v64, s[4:7], s50 offen offset:0
    buffer_load_dwordx4 a[108:111], v64, s[4:7], s50 offen offset:1024
    buffer_load_dwordx4 a[164:167], v64, s[4:7], s50 offen offset:2048
    buffer_load_dwordx4 a[220:223], v64, s[4:7], s50 offen offset:3072
    buffer_load_dwordx4 v[140:143], v65, s[4:7], s50 offen offset:0
    buffer_load_dwordx4 v[196:199], v65, s[4:7], s50 offen offset:1024
    buffer_load_dwordx4 v[252:255], v65, s[4:7], s50 offen offset:2048
    s_add_u32 s50, s50, 28672
    v_mov_b32 v6, 0x4444
    v_mov_b32 v7, 0xeeee
    v_and_b32 v5, 2, v2
    v_cmp_ne_u32 vcc, 0, v5
    s_nop 1
    v_cndmask_b32 v6, v6, v7, vcc
    v_and_b32 v7, 7, v2
    v_lshlrev_b32 v116, 5, v7
    v_lshl_add_u32 v116, v3, 3, v116
    v_lshrrev_b32 v66, 3, v2
    v_lshl_add_u32 v116, v66, 2, v116
    v_add_u32 v116, s51, v116
    s_and_b32 s28, s24, 1
    s_mul_i32 s66, s28, 14336
    s_add_u32 s66, s66, 28672
    s_mul_i32 s69, s28, 14352
    s_add_u32 s69, s69, 32768
    s_lshl_b32 s70, s25, 9
    s_add_u32 s70, s70, 69238784
    s_mov_b32 s26, 1
    s_mov_b32 s60, 0x100000
    s_mov_b32 s61, 0xfffffffe
    s_waitcnt vmcnt(49)
    v_xor_b32 v8, s48, v8
    v_xor_b32 v9, s48, v9
    v_xor_b32 v10, s48, v10
    v_xor_b32 v11, s48, v11
    v_or3_b32 v8, v8, v9, v10
    v_or_b32 v8, v8, v11
    v_cmp_lt_u32 vcc, 1, v8
    s_cbranch_vccz Lok_7
Lsw_8:
    buffer_load_dwordx4 v[8:11], v12, s[4:7], s49 offen sc1
Lse_10:
    s_waitcnt vmcnt(0)
    v_xor_b32 v8, s48, v8
    v_xor_b32 v9, s48, v9
    v_xor_b32 v10, s48, v10
    v_xor_b32 v11, s48, v11
    v_or3_b32 v8, v8, v9, v10
    v_or_b32 v8, v8, v11
    v_cmp_lt_u32 vcc, 1, v8
    s_cbranch_vccz Lsd_9
    s_sleep 1
    s_sub_u32 s27, s27, 1
    s_cbranch_scc1 K2_end
    s_branch Lsw_8
Lsd_9:
Lok_7:
    v_cmp_eq_u32 vcc, 1, v8
    s_cmp_lg_u64 vcc, 0
    s_cselect_b32 s59, 1, 0
    s_getpc_b64 s[28:29]
Lpc_11:
    s_add_u32 s28, s28, K2_A_w0-Lpc_11
    s_addc_u32 s29, s29, 0
    v_lshlrev_b32 v14, 3, v4
    v_mov_b32 v15, s29
    v_add_co_u32 v14, vcc, s28, v14
    s_nop 1
    v_addc_co_u32 v15, vcc, 0, v15, vcc
    s_waitcnt vmcnt(45)
    global_load_dword v13, v[14:15], off
    s_cmp_lg_u32 s59, 0
    s_mov_b32 s56, 69255168
    s_cselect_b32 s56, 70261760, s56
    s_mov_b32 s34, 32768
    s_cselect_b32 s34, 7168, s34
    s_cselect_b32 s35, -1, 4294836223
    s_add_u32 s57, s56, 4096
    v_lshrrev_b32 v67, 3, v1
    v_cmp_eq_u32 vcc, s25, v67
    v_mov_b32 v67, 0x7ffffff0
    s_mov_b32 s71, 70706176
    s_mov_b32 s72, 70710272
    v_cndmask_b32 v64, v67, v4, vcc
    s_cmp_ge_u32 s24, 2
    s_cbranch_scc1 K2_A_setupC
    v_lshlrev_b32 v117, 8, v3
    v_lshl_add_u32 v117, v2, 3, v117
    v_bfe_u32 v67, v2, 2, 1
    v_lshlrev_b32 v118, 8, v67
    v_lshl_add_u32 v118, v3, 6, v118
    v_lshl_add_u32 v118, v66, 5, v118
    v_and_b32 v68, 3, v2
    v_lshl_add_u32 v118, v68, 2, v118
    s_lshl_b32 s28, s24, 4
    v_add_u32 v118, s28, v118
    v_lshlrev_b32 v119, 6, v3
    v_lshl_add_u32 v119, v66, 5, v119
    v_lshl_add_u32 v119, v67, 2, v119
    s_lshr_b32 s29, s25, 1
    s_lshl_b32 s29, s29, 8
    s_add_u32 s28, s28, s29
    s_and_b32 s29, s25, 1
    s_lshl_b32 s29, s29, 3
    s_add_u32 s28, s28, s29
    s_lshl_b32 s29, s25, 9
    s_sub_u32 s28, s28, s29
    s_add_u32 s28, s28, 8192
    v_add_u32 v119, s28, v119
    v_cmp_eq_u32 vcc, 0, v68
    v_mov_b32 v69, 0x7ffffff0
    v_mul_u32_u24 v0, 14352, v66
    v_cndmask_b32 v119, v69, v119, vcc
    v_lshl_add_u32 v0, v3, 8, v0
    v_lshl_add_u32 v0, v7, 5, v0
    v_add_u32 v0, 32768, v0
    v_and_b32 v7, 2, v2
    v_cmp_eq_u32 s[52:53], 0, v7
    v_mov_b32 v1, 0xff800000
    s_mov_b32 s58, 0x42c80000
    s_cmp_eq_u32 s59, 0
    s_cselect_b32 s54, s70, 69468160
    s_cselect_b32 s55, 32768, 0
    v_cndmask_b32 v1, v1, 0, s[52:53]
    v_mov_b32 v2, v64
    s_cmp_eq_u32 s24, 0
    s_cbranch_scc1 K2_A_w0
    s_branch K2_A_w1
K2_A_setupC:
    s_mul_i32 s28, s25, 384
    s_sub_u32 s28, 7680, s28
    v_add_u32 v104, s28, v4
    v_cmp_gt_u32 vcc, 32, v1
    v_mov_b32 v100, -1
    v_mov_b32 v101, -1
    v_cndmask_b32 v104, v104, v4, vcc
    v_cmp_gt_u32 vcc, 40, v1
    v_mov_b32 v102, -1
    v_mov_b32 v103, -1
    v_cndmask_b32 v104, v67, v104, vcc
    s_mov_b32 s54, 70261760
    s_lshl_b32 s28, s25, 9
    v_lshlrev_b32 v96, 3, v1
    v_add_u32 v96, s28, v96
    s_cmp_lt_u32 s25, 14
    s_cselect_b32 s28, 0, 0x7ff00000
    v_add_u32 v97, s28, v96
    v_min_u32 v0, 55, v1
    v_lshlrev_b32 v0, 7, v0
    s_and_b32 s74, s24, 1
    s_mul_i32 s74, s74, 14336
    s_mul_i32 s28, s25, 28672
    s_add_u32 s74, s74, s28
    s_add_u32 s74, s74, 20250624
    s_lshl_b32 s75, s25, 7
    s_add_u32 s75, s75, 72376320
    s_add_u32 s30, s74, 27066368
    s_add_u32 s31, s75, 483328
    v_min_u32 v7, 13, v1
    s_mul_i32 s28, s25, 14
    v_add_u32 v2, s28, v7
    v_lshlrev_b32 v2, 7, v2
    v_add_u32 v2, 57344, v2
    v_lshlrev_b32 v7, 7, v1
    s_lshl_b32 s28, s25, 13
    s_add_u32 s28, s28, 69206016
    v_and_b32 v1, 3, v1
    v_lshlrev_b32 v1, 2, v1
    s_waitcnt vmcnt(14)
    buffer_load_dword v7, v7, s[4:7], s28 offen sc1
    v_subrev_u32 v5, 28672, v2
    buffer_load_dword v7, v5, s[4:7], 0 offen sc1
    buffer_load_dword v7, v2, s[4:7], 0 offen sc1
    v_add_u32 v2, 28672, v2
    buffer_load_dword v5, v1, s[4:7], s75 offen sc1
    s_waitcnt vmcnt(0)
    s_cmp_eq_u32 s24, 2
    s_cbranch_scc1 K2_A_w2
    s_branch K2_A_w3
.p2align 6
K2_A_w0:
    v_mov_b32 v36, 0
    v_mov_b32 v37, 0
    v_mov_b32 v38, 0
    v_mov_b32 v39, 0
    v_mov_b32 v40, 0
    v_mov_b32 v41, 0
    v_mov_b32 v42, 0
    v_mov_b32 v43, 0
    v_mov_b32 v44, 0
    v_mov_b32 v45, 0
    v_mov_b32 v46, 0
    v_mov_b32 v47, 0
    v_mov_b32 v48, 0
    v_mov_b32 v49, 0
    v_mov_b32 v50, 0
    v_mov_b32 v51, 0
    s_add_u32 m0, s69, 0
    s_add_u32 s67, s66, 0
    buffer_load_dwordx4 v4, s[4:7], s67 offen offset:0 lds
    buffer_load_dwordx4 v4, s[4:7], s67 offen offset:1024 lds
    buffer_load_dwordx4 v4, s[4:7], s67 offen offset:2048 lds
    buffer_load_dwordx4 v4, s[4:7], s67 offen offset:3072 lds
    s_add_u32 m0, s69, 4096
    s_add_u32 s67, s66, 4096
    buffer_load_dwordx4 v4, s[4:7], s67 offen offset:0 lds
    buffer_load_dwordx4 v4, s[4:7], s67 offen offset:1024 lds
    buffer_load_dwordx4 v4, s[4:7], s67 offen offset:2048 lds
    s_add_u32 s66, s66, 28672
    s_xor_b32 s69, s69, 98304
    v_mov_b32 v52, 0
    v_mov_b32 v53, 0
    v_mov_b32 v54, 0
    v_mov_b32 v55, 0
    v_mov_b32 v56, 0
    v_mov_b32 v57, 0
    v_mov_b32 v58, 0
    v_mov_b32 v59, 0
    v_mov_b32 v60, 0
    v_mov_b32 v61, 0
    v_mov_b32 v62, 0
    v_mov_b32 v63, 0
    v_mov_b32 v96, 0
    v_mov_b32 v97, 0
    v_mov_b32 v98, 0
    v_mov_b32 v99, 0
    v_mov_b32 v100, 0
    v_mov_b32 v101, 0
    v_mov_b32 v102, 0
    v_mov_b32 v103, 0
    v_mov_b32 v104, v1
    v_mov_b32 v105, 0
    v_mov_b32 v106, 0
    v_mov_b32 v107, 0
    s_waitcnt vmcnt(7)
    v_mov_b32 v8, -1
    v_mov_b32 v9, -1
    v_mov_b32 v10, -1
    v_mov_b32 v11, -1
    v_mov_b32 v12, -1
    v_mov_b32 v13, -1
    v_mov_b32 v14, -1
    v_mov_b32 v15, -1
    buffer_load_dwordx4 v[8:11], v4, s[4:7], s56 offen offset:0 sc1
    buffer_load_dwordx4 v[12:15], v4, s[4:7], s56 offen offset:1024 sc1
    s_sleep 2
Lrp_12:
    buffer_load_dwordx4 v[8:11], v4, s[4:7], s56 offen offset:0 sc1
    buffer_load_dwordx4 v[12:15], v4, s[4:7], s56 offen offset:1024 sc1
    s_sub_u32 s60, s60, 1
    s_addc_u32 s61, s61, 0
    s_nop 4
    v_mov_b32 v36, 0
    v_mov_b32 v37, 0
    v_mov_b32 v38, 0
    v_mov_b32 v39, 0
    v_mov_b32 v40, 0
    v_mov_b32 v41, 0
    v_mov_b32 v42, 0
    v_mov_b32 v43, 0
    s_waitcnt vmcnt(2)
    v_max3_u32 v16, v8, v9, v10
    v_max3_u32 v20, v11, v12, v13
    v_max3_u32 v16, v16, v14, v15
    v_max_u32 v16, v16, v20
    v_cmp_lt_u32 vcc, s61, v16
    v_smfmac_f32_16x16x64_bf16 v[36:39], v[8:11], a[0:7], v6
    v_smfmac_f32_16x16x64_bf16 v[40:43], v[8:11], a[56:63], v6
    s_cbranch_vccnz Lrp_12
Lrg_13:
    ds_write_b128 v4, v[8:11] offset:0
    v_smfmac_f32_16x16x64_bf16 v[44:47], v[8:11], a[112:119], v6
    ds_write_b128 v4, v[12:15] offset:1024
    v_smfmac_f32_16x16x64_bf16 v[48:51], v[8:11], a[168:175], v6
    s_add_u32 s56, s56, s34
    s_and_b32 s56, s56, s35
    s_add_u32 s57, s56, 4096
    v_smfmac_f32_16x16x64_bf16 v[52:55], v[8:11], a[224:231], v6
    v_smfmac_f32_16x16x64_bf16 v[56:59], v[8:11], v[144:151], v6
    v_smfmac_f32_16x16x64_bf16 v[60:63], v[8:11], v[200:207], v6
    v_smfmac_f32_16x16x64_bf16 v[36:39], v[12:15], a[8:15], v6
    v_smfmac_f32_16x16x64_bf16 v[40:43], v[12:15], a[64:71], v6
    s_waitcnt lgkmcnt(0)
    s_barrier
    ds_read_b128 v[16:19], v4 offset:2048
    v_smfmac_f32_16x16x64_bf16 v[44:47], v[12:15], a[120:127], v6
    ds_read_b128 v[20:23], v4 offset:3072
    v_smfmac_f32_16x16x64_bf16 v[48:51], v[12:15], a[176:183], v6
    ds_read_b128 v[24:27], v4 offset:4096
    v_smfmac_f32_16x16x64_bf16 v[52:55], v[12:15], a[232:239], v6
    ds_read_b128 v[28:31], v4 offset:5120
    v_smfmac_f32_16x16x64_bf16 v[56:59], v[12:15], v[152:159], v6
    ds_read_b128 v[32:35], v4 offset:6144
    v_smfmac_f32_16x16x64_bf16 v[60:63], v[12:15], v[208:215], v6
    s_waitcnt lgkmcnt(4)
    ds_read_b128 v[64:67], v0 offset:0
    v_smfmac_f32_16x16x64_bf16 v[36:39], v[16:19], a[16:23], v6
    s_waitcnt lgkmcnt(4)
    ds_read_b128 v[68:71], v0 offset:1024
    v_smfmac_f32_16x16x64_bf16 v[36:39], v[20:23], a[24:31], v6
    s_waitcnt lgkmcnt(4)
    ds_read_b128 v[72:75], v0 offset:16
    v_smfmac_f32_16x16x64_bf16 v[36:39], v[24:27], a[32:39], v6
    s_waitcnt lgkmcnt(4)
    ds_read_b128 v[76:79], v0 offset:1040
    v_smfmac_f32_16x16x64_bf16 v[36:39], v[28:31], a[40:47], v6
    s_waitcnt lgkmcnt(4)
    ds_read_b128 v[80:83], v0 offset:2048
    v_smfmac_f32_16x16x64_bf16 v[36:39], v[32:35], a[48:55], v6
    ds_read_b128 v[84:87], v0 offset:3072
    v_smfmac_f32_16x16x64_bf16 v[40:43], v[16:19], a[72:79], v6
    ds_read_b128 v[88:91], v0 offset:2064
    v_smfmac_f32_16x16x64_bf16 v[40:43], v[20:23], a[80:87], v6
    s_nop 1
    ds_read_b128 v[92:95], v0 offset:3088
    v_smfmac_f32_16x16x64_bf16 v[40:43], v[24:27], a[88:95], v6
    v_add_f32 v36, v36, v38
    v_smfmac_f32_16x16x64_bf16 v[40:43], v[28:31], a[96:103], v6
    v_add_f32 v37, v37, v39
    v_smfmac_f32_16x16x64_bf16 v[40:43], v[32:35], a[104:111], v6
    v_cvt_pk_bf16_f32 v36, v36, v37
    v_smfmac_f32_16x16x64_bf16 v[44:47], v[16:19], a[128:135], v6
    ds_write_b32 v116, v36 offset:8192
    v_smfmac_f32_16x16x64_bf16 v[44:47], v[20:23], a[136:143], v6
    s_nop 1
    ds_read_b128 v[36:39], v0 offset:4096
    v_smfmac_f32_16x16x64_bf16 v[44:47], v[24:27], a[144:151], v6
    v_add_f32 v40, v40, v42
    v_smfmac_f32_16x16x64_bf16 v[44:47], v[28:31], a[152:159], v6
    v_add_f32 v41, v41, v43
    v_smfmac_f32_16x16x64_bf16 v[44:47], v[32:35], a[160:167], v6
    v_cvt_pk_bf16_f32 v40, v40, v41
    v_smfmac_f32_16x16x64_bf16 v[48:51], v[16:19], a[184:191], v6
    ds_write_b32 v116, v40 offset:9216
    v_smfmac_f32_16x16x64_bf16 v[48:51], v[20:23], a[192:199], v6
    s_nop 1
    ds_read_b128 v[40:43], v0 offset:5120
    v_smfmac_f32_16x16x64_bf16 v[48:51], v[24:27], a[200:207], v6
    v_add_f32 v44, v44, v46
    v_smfmac_f32_16x16x64_bf16 v[48:51], v[28:31], a[208:215], v6
    v_add_f32 v45, v45, v47
    v_smfmac_f32_16x16x64_bf16 v[48:51], v[32:35], a[216:223], v6
    v_cvt_pk_bf16_f32 v44, v44, v45
    v_smfmac_f32_16x16x64_bf16 v[52:55], v[16:19], a[240:247], v6
    ds_write_b32 v116, v44 offset:10240
    v_smfmac_f32_16x16x64_bf16 v[52:55], v[20:23], a[248:255], v6
    s_nop 1
    ds_read_b128 v[44:47], v0 offset:4112
    v_smfmac_f32_16x16x64_bf16 v[52:55], v[24:27], v[120:127], v6
    v_add_f32 v48, v48, v50
    v_smfmac_f32_16x16x64_bf16 v[52:55], v[28:31], v[128:135], v6
    v_add_f32 v49, v49, v51
    v_smfmac_f32_16x16x64_bf16 v[52:55], v[32:35], v[136:143], v6
    v_cvt_pk_bf16_f32 v48, v48, v49
    v_smfmac_f32_16x16x64_bf16 v[56:59], v[16:19], v[160:167], v6
    ds_write_b32 v116, v48 offset:11264
    v_smfmac_f32_16x16x64_bf16 v[56:59], v[20:23], v[168:175], v6
    s_nop 1
    ds_read_b128 v[48:51], v0 offset:5136
    v_smfmac_f32_16x16x64_bf16 v[56:59], v[24:27], v[176:183], v6
    v_add_f32 v52, v52, v54
    v_smfmac_f32_16x16x64_bf16 v[56:59], v[28:31], v[184:191], v6
    v_add_f32 v53, v53, v55
    v_smfmac_f32_16x16x64_bf16 v[56:59], v[32:35], v[192:199], v6
    s_waitcnt lgkmcnt(1)
    s_barrier
    ds_read_b64_tr_b16 v[108:109], v117 offset:8192
    ds_read_b64_tr_b16 v[110:111], v117 offset:8320
    v_cvt_pk_bf16_f32 v52, v52, v53
    v_smfmac_f32_16x16x64_bf16 v[60:63], v[16:19], v[216:223], v6
    ds_write_b32 v116, v52 offset:12288
    v_smfmac_f32_16x16x64_bf16 v[60:63], v[20:23], v[224:231], v6
    ds_read_b64_tr_b16 v[112:113], v117 offset:9216
    v_smfmac_f32_16x16x64_bf16 v[60:63], v[24:27], v[232:239], v6
    ds_read_b64_tr_b16 v[114:115], v117 offset:9344
    v_add_f32 v56, v56, v58
    v_smfmac_f32_16x16x64_bf16 v[60:63], v[28:31], v[240:247], v6
    ds_read_b64_tr_b16 v[52:53], v117 offset:10240
    v_add_f32 v57, v57, v59
    v_smfmac_f32_16x16x64_bf16 v[60:63], v[32:35], v[248:255], v6
    s_waitcnt lgkmcnt(4)
    ds_read_b64_tr_b16 v[54:55], v117 offset:10368
    v_cvt_pk_bf16_f32 v56, v56, v57
    v_smfmac_f32_16x16x64_bf16 v[96:99], v[108:111], v[64:71], v6
    ds_read_b128 v[64:67], v0 offset:6144
    ds_write_b32 v116, v56 offset:13312
    v_smfmac_f32_16x16x64_bf16 v[100:103], v[108:111], v[72:79], v6
    ds_read_b128 v[68:71], v0 offset:7168
    ds_read_b128 v[72:75], v0 offset:6160
    v_mfma_f32_16x16x32_bf16 v[104:107], v[108:111], v[8:11], v[104:107]
    s_waitcnt lgkmcnt(6)
    ds_read_b128 v[76:79], v0 offset:7184
    v_add_f32 v60, v60, v62
    v_add_f32 v61, v61, v63
    v_smfmac_f32_16x16x64_bf16 v[96:99], v[112:115], v[80:87], v6
    ds_read_b64_tr_b16 v[56:57], v117 offset:11264
    v_cvt_pk_bf16_f32 v60, v60, v61
    ds_write_b32 v116, v60 offset:14336
    v_smfmac_f32_16x16x64_bf16 v[100:103], v[112:115], v[88:95], v6
    s_barrier
    ds_read_b64_tr_b16 v[58:59], v117 offset:11392
    ds_read_b128 v[80:83], v0 offset:8192
    v_mfma_f32_16x16x32_bf16 v[104:107], v[112:115], v[12:15], v[104:107]
    s_waitcnt lgkmcnt(9)
    ds_read_b128 v[84:87], v0 offset:9216
    ds_read_b128 v[88:91], v0 offset:8208
    v_smfmac_f32_16x16x64_bf16 v[96:99], v[52:55], v[36:43], v6
    ds_read_b128 v[92:95], v0 offset:9232
    ds_read_b64_tr_b16 v[108:109], v117 offset:12288
    v_smfmac_f32_16x16x64_bf16 v[100:103], v[52:55], v[44:51], v6
    ds_read_b64_tr_b16 v[110:111], v117 offset:12416
    ds_read_b128 v[36:39], v0 offset:10240
    v_mfma_f32_16x16x32_bf16 v[104:107], v[52:55], v[16:19], v[104:107]
    s_waitcnt lgkmcnt(7)
    ds_read_b128 v[40:43], v0 offset:11264
    ds_read_b128 v[44:47], v0 offset:10256
    v_smfmac_f32_16x16x64_bf16 v[96:99], v[56:59], v[64:71], v6
    s_barrier
    ds_read_b128 v[48:51], v0 offset:11280
    ds_read_b64_tr_b16 v[112:113], v117 offset:13312
    v_smfmac_f32_16x16x64_bf16 v[100:103], v[56:59], v[72:79], v6
    ds_read_b64_tr_b16 v[114:115], v117 offset:13440
    ds_read_b128 v[64:67], v0 offset:12288
    v_mfma_f32_16x16x32_bf16 v[104:107], v[56:59], v[20:23], v[104:107]
    s_waitcnt lgkmcnt(7)
    ds_read_b128 v[68:71], v0 offset:13312
    ds_read_b128 v[72:75], v0 offset:12304
    v_smfmac_f32_16x16x64_bf16 v[96:99], v[108:111], v[80:87], v6
    ds_read_b128 v[76:79], v0 offset:13328
    ds_read_b64_tr_b16 v[52:53], v117 offset:14336
    v_smfmac_f32_16x16x64_bf16 v[100:103], v[108:111], v[88:95], v6
    ds_read_b64_tr_b16 v[54:55], v117 offset:14464
    v_mfma_f32_16x16x32_bf16 v[104:107], v[108:111], v[24:27], v[104:107]
    s_waitcnt lgkmcnt(6)
    v_smfmac_f32_16x16x64_bf16 v[96:99], v[112:115], v[36:43], v6
    v_smfmac_f32_16x16x64_bf16 v[100:103], v[112:115], v[44:51], v6
    v_mfma_f32_16x16x32_bf16 v[104:107], v[112:115], v[28:31], v[104:107]
    s_waitcnt lgkmcnt(0)
    v_mfma_f32_16x16x32_bf16 v[104:107], v[52:55], v[32:35], v[104:107]
    s_nop 2
    v_smfmac_f32_16x16x64_bf16 v[96:99], v[52:55], v[64:71], v6
    s_nop 2
    v_smfmac_f32_16x16x64_bf16 v[100:103], v[52:55], v[72:79], v6
    v_add_f32_dpp v104, v106, v104 quad_perm:[2,3,0,1] row_mask:0xf bank_mask:0xf
    v_exp_f32 v82, v104
    s_nop 0
    v_cndmask_b32 v86, 0, v104, s[52:53]
    v_add_f32 v96, v96, v98
    v_exp_f32 v80, v96
    v_max_f32 v85, |v96|, |v86|
    v_add_f32 v84, v80, v82
    v_add_f32 v100, v100, v102
    v_exp_f32 v81, v100
    v_max_f32 v85, v85, |v100|
    v_add_f32 v84, v84, v81
    v_cmp_ngt_f32 vcc, s58, v85
    s_nop 0
K2_A_back0:
    v_add_f32_dpp v84, v84, v84 row_ror:8 row_mask:0xf bank_mask:0xf
    s_nop 1
    v_add_f32_dpp v84, v84, v84 row_ror:4 row_mask:0xf bank_mask:0xf
    s_cmp_eq_u64 vcc, 0
    s_cselect_b32 s28, s54, 69468160
    v_add_f32_dpp v84, v84, v84 row_ror:2 row_mask:0xf bank_mask:0xf
    s_nop 1
    v_add_f32_dpp v84, v84, v84 row_ror:1 row_mask:0xf bank_mask:0xf
    v_rcp_f32 v84, v84
    s_nop 0
    v_mul_f32 v85, v80, v84
    v_mul_f32 v86, v81, v84
    v_mul_f32 v87, v82, v84
    v_cvt_pk_bf16_f32 v85, v85, v86
    v_mul_f32_dpp v88, v82, v84 quad_perm:[1,0,3,2] row_mask:0xf bank_mask:0xf
    buffer_store_dword v85, v118, s[4:7], s28 offen
    v_cvt_pk_bf16_f32 v87, v87, v88
    buffer_store_dword v87, v119, s[4:7], s28 offen
    s_cbranch_scc0 K2_A_slow0
    s_cmp_lg_u32 s59, 0
    s_cbranch_scc1 K2_A_y0
K2_A_noy0:
    s_add_u32 s54, s54, s55
    s_and_b32 s54, s54, 4294836223
    v_xor_b32 v0, 98304, v0
    s_barrier
    s_add_u32 s70, s70, 32768
    s_and_b32 s70, s70, 4294836223
    s_add_u32 s26, s26, 1
    s_cmp_lt_u32 s26, 63
    s_cbranch_scc1 K2_A_w0
    s_waitcnt vmcnt(0)
    v_mov_b32 v8, -1
    v_mov_b32 v9, -1
    v_mov_b32 v10, -1
    v_mov_b32 v11, -1
    v_mov_b32 v12, -1
    v_mov_b32 v13, -1
    v_mov_b32 v14, -1
    v_mov_b32 v15, -1
    buffer_load_dwordx4 v[8:11], v4, s[4:7], s56 offen offset:0 sc1
    buffer_load_dwordx4 v[12:15], v4, s[4:7], s56 offen offset:1024 sc1
Lrp_14:
    buffer_load_dwordx4 v[8:11], v4, s[4:7], s56 offen offset:0 sc1
    buffer_load_dwordx4 v[12:15], v4, s[4:7], s56 offen offset:1024 sc1
    s_sub_u32 s60, s60, 1
    s_addc_u32 s61, s61, 0
    s_waitcnt vmcnt(2)
    v_max3_u32 v16, v8, v9, v10
    v_max3_u32 v20, v11, v12, v13
    v_max3_u32 v16, v16, v14, v15
    v_max_u32 v16, v16, v20
    v_cmp_lt_u32 vcc, s61, v16
    s_cbranch_vccnz Lrp_14
Lrg_15:
    buffer_store_dwordx4 v[8:11], v2, s[4:7], s71 offen offset:0 sc1
    buffer_store_dwordx4 v[12:15], v2, s[4:7], s71 offen offset:1024 sc1
    s_branch K2_end
K2_A_y0:
    buffer_store_dword v87, v119, s[4:7], s70 offen sc1
    buffer_store_dword v85, v118, s[4:7], s70 offen sc1
    s_branch K2_A_noy0
K2_A_slow0:
    v_max3_f32 v84, v96, v100, v104
    s_nop 1
    v_max_f32_dpp v84, v84, v84 row_ror:8 row_mask:0xf bank_mask:0xf
    s_nop 1
    v_max_f32_dpp v84, v84, v84 row_ror:4 row_mask:0xf bank_mask:0xf
    s_nop 1
    v_max_f32_dpp v84, v84, v84 row_ror:2 row_mask:0xf bank_mask:0xf
    s_nop 1
    v_max_f32_dpp v84, v84, v84 row_ror:1 row_mask:0xf bank_mask:0xf
    v_sub_f32 v96, v96, v84
    v_sub_f32 v100, v100, v84
    v_sub_f32 v104, v104, v84
    v_exp_f32 v80, v96
    v_exp_f32 v81, v100
    v_exp_f32 v82, v104
    v_add_f32 v84, v80, v81
    v_add_f32 v84, v84, v82
    s_mov_b64 vcc, 0
    s_nop 0
    s_branch K2_A_back0
.p2align 6
K2_A_w1:
    v_mov_b32 v36, 0
    v_mov_b32 v37, 0
    v_mov_b32 v38, 0
    v_mov_b32 v39, 0
    v_mov_b32 v40, 0
    v_mov_b32 v41, 0
    v_mov_b32 v42, 0
    v_mov_b32 v43, 0
    v_mov_b32 v44, 0
    v_mov_b32 v45, 0
    v_mov_b32 v46, 0
    v_mov_b32 v47, 0
    v_mov_b32 v48, 0
    v_mov_b32 v49, 0
    v_mov_b32 v50, 0
    v_mov_b32 v51, 0
    s_add_u32 m0, s69, 0
    s_add_u32 s67, s66, 0
    buffer_load_dwordx4 v4, s[4:7], s67 offen offset:0 lds
    buffer_load_dwordx4 v4, s[4:7], s67 offen offset:1024 lds
    buffer_load_dwordx4 v4, s[4:7], s67 offen offset:2048 lds
    buffer_load_dwordx4 v4, s[4:7], s67 offen offset:3072 lds
    s_add_u32 m0, s69, 4096
    s_add_u32 s67, s66, 4096
    buffer_load_dwordx4 v4, s[4:7], s67 offen offset:0 lds
    buffer_load_dwordx4 v4, s[4:7], s67 offen offset:1024 lds
    buffer_load_dwordx4 v4, s[4:7], s67 offen offset:2048 lds
    s_add_u32 s66, s66, 28672
    s_xor_b32 s69, s69, 98304
    v_mov_b32 v52, 0
    v_mov_b32 v53, 0
    v_mov_b32 v54, 0
    v_mov_b32 v55, 0
    v_mov_b32 v56, 0
    v_mov_b32 v57, 0
    v_mov_b32 v58, 0
    v_mov_b32 v59, 0
    v_mov_b32 v60, 0
    v_mov_b32 v61, 0
    v_mov_b32 v62, 0
    v_mov_b32 v63, 0
    v_mov_b32 v96, 0
    v_mov_b32 v97, 0
    v_mov_b32 v98, 0
    v_mov_b32 v99, 0
    v_mov_b32 v100, 0
    v_mov_b32 v101, 0
    v_mov_b32 v102, 0
    v_mov_b32 v103, 0
    v_mov_b32 v104, 0
    v_mov_b32 v105, v1
    v_mov_b32 v106, 0
    v_mov_b32 v107, 0
    s_waitcnt vmcnt(7)
    v_mov_b32 v16, -1
    v_mov_b32 v17, -1
    v_mov_b32 v18, -1
    v_mov_b32 v19, -1
    v_mov_b32 v20, -1
    v_mov_b32 v21, -1
    v_mov_b32 v22, -1
    v_mov_b32 v23, -1
    buffer_load_dwordx4 v[16:19], v4, s[4:7], s56 offen offset:2048 sc1
    buffer_load_dwordx4 v[20:23], v4, s[4:7], s56 offen offset:3072 sc1
    s_sleep 2
Lrp_16:
    buffer_load_dwordx4 v[16:19], v4, s[4:7], s56 offen offset:2048 sc1
    buffer_load_dwordx4 v[20:23], v4, s[4:7], s56 offen offset:3072 sc1
    s_sub_u32 s60, s60, 1
    s_addc_u32 s61, s61, 0
    s_nop 4
    v_mov_b32 v36, 0
    v_mov_b32 v37, 0
    v_mov_b32 v38, 0
    v_mov_b32 v39, 0
    v_mov_b32 v40, 0
    v_mov_b32 v41, 0
    v_mov_b32 v42, 0
    v_mov_b32 v43, 0
    s_waitcnt vmcnt(2)
    v_max3_u32 v8, v16, v17, v18
    v_max3_u32 v12, v19, v20, v21
    v_max3_u32 v8, v8, v22, v23
    v_max_u32 v8, v8, v12
    v_cmp_lt_u32 vcc, s61, v8
    v_smfmac_f32_16x16x64_bf16 v[36:39], v[16:19], a[16:23], v6
    v_smfmac_f32_16x16x64_bf16 v[40:43], v[16:19], a[72:79], v6
    s_cbranch_vccnz Lrp_16
Lrg_17:
    ds_write_b128 v4, v[16:19] offset:2048
    v_smfmac_f32_16x16x64_bf16 v[44:47], v[16:19], a[128:135], v6
    ds_write_b128 v4, v[20:23] offset:3072
    v_smfmac_f32_16x16x64_bf16 v[48:51], v[16:19], a[184:191], v6
    s_add_u32 s56, s56, s34
    s_and_b32 s56, s56, s35
    s_add_u32 s57, s56, 4096
    v_smfmac_f32_16x16x64_bf16 v[52:55], v[16:19], a[240:247], v6
    v_smfmac_f32_16x16x64_bf16 v[56:59], v[16:19], v[160:167], v6
    v_smfmac_f32_16x16x64_bf16 v[60:63], v[16:19], v[216:223], v6
    v_smfmac_f32_16x16x64_bf16 v[36:39], v[20:23], a[24:31], v6
    v_smfmac_f32_16x16x64_bf16 v[40:43], v[20:23], a[80:87], v6
    s_waitcnt lgkmcnt(0)
    s_barrier
    ds_read_b128 v[24:27], v4 offset:4096
    v_smfmac_f32_16x16x64_bf16 v[44:47], v[20:23], a[136:143], v6
    ds_read_b128 v[28:31], v4 offset:5120
    v_smfmac_f32_16x16x64_bf16 v[48:51], v[20:23], a[192:199], v6
    ds_read_b128 v[32:35], v4 offset:6144
    v_smfmac_f32_16x16x64_bf16 v[52:55], v[20:23], a[248:255], v6
    ds_read_b128 v[8:11], v4 offset:0
    v_smfmac_f32_16x16x64_bf16 v[56:59], v[20:23], v[168:175], v6
    ds_read_b128 v[12:15], v4 offset:1024
    v_smfmac_f32_16x16x64_bf16 v[60:63], v[20:23], v[224:231], v6
    s_waitcnt lgkmcnt(4)
    ds_read_b128 v[64:67], v0 offset:0
    v_smfmac_f32_16x16x64_bf16 v[36:39], v[24:27], a[32:39], v6
    s_waitcnt lgkmcnt(4)
    ds_read_b128 v[68:71], v0 offset:1024
    v_smfmac_f32_16x16x64_bf16 v[36:39], v[28:31], a[40:47], v6
    s_waitcnt lgkmcnt(4)
    ds_read_b128 v[72:75], v0 offset:16
    v_smfmac_f32_16x16x64_bf16 v[36:39], v[32:35], a[48:55], v6
    s_waitcnt lgkmcnt(4)
    ds_read_b128 v[76:79], v0 offset:1040
    v_smfmac_f32_16x16x64_bf16 v[36:39], v[8:11], a[0:7], v6
    s_waitcnt lgkmcnt(4)
    ds_read_b128 v[80:83], v0 offset:2048
    v_smfmac_f32_16x16x64_bf16 v[36:39], v[12:15], a[8:15], v6
    ds_read_b128 v[84:87], v0 offset:3072
    v_smfmac_f32_16x16x64_bf16 v[40:43], v[24:27], a[88:95], v6
    ds_read_b128 v[88:91], v0 offset:2064
    v_smfmac_f32_16x16x64_bf16 v[40:43], v[28:31], a[96:103], v6
    s_nop 1
    ds_read_b128 v[92:95], v0 offset:3088
    v_smfmac_f32_16x16x64_bf16 v[40:43], v[32:35], a[104:111], v6
    v_add_f32 v36, v36, v38
    v_smfmac_f32_16x16x64_bf16 v[40:43], v[8:11], a[56:63], v6
    v_add_f32 v37, v37, v39
    v_smfmac_f32_16x16x64_bf16 v[40:43], v[12:15], a[64:71], v6
    v_cvt_pk_bf16_f32 v36, v36, v37
    v_smfmac_f32_16x16x64_bf16 v[44:47], v[24:27], a[144:151], v6
    ds_write_b32 v116, v36 offset:8192
    v_smfmac_f32_16x16x64_bf16 v[44:47], v[28:31], a[152:159], v6
    s_nop 1
    ds_read_b128 v[36:39], v0 offset:4096
    v_smfmac_f32_16x16x64_bf16 v[44:47], v[32:35], a[160:167], v6
    v_add_f32 v40, v40, v42
    v_smfmac_f32_16x16x64_bf16 v[44:47], v[8:11], a[112:119], v6
    v_add_f32 v41, v41, v43
    v_smfmac_f32_16x16x64_bf16 v[44:47], v[12:15], a[120:127], v6
    v_cvt_pk_bf16_f32 v40, v40, v41
    v_smfmac_f32_16x16x64_bf16 v[48:51], v[24:27], a[200:207], v6
    ds_write_b32 v116, v40 offset:9216
    v_smfmac_f32_16x16x64_bf16 v[48:51], v[28:31], a[208:215], v6
    s_nop 1
    ds_read_b128 v[40:43], v0 offset:5120
    v_smfmac_f32_16x16x64_bf16 v[48:51], v[32:35], a[216:223], v6
    v_add_f32 v44, v44, v46
    v_smfmac_f32_16x16x64_bf16 v[48:51], v[8:11], a[168:175], v6
    v_add_f32 v45, v45, v47
    v_smfmac_f32_16x16x64_bf16 v[48:51], v[12:15], a[176:183], v6
    v_cvt_pk_bf16_f32 v44, v44, v45
    v_smfmac_f32_16x16x64_bf16 v[52:55], v[24:27], v[120:127], v6
    ds_write_b32 v116, v44 offset:10240
    v_smfmac_f32_16x16x64_bf16 v[52:55], v[28:31], v[128:135], v6
    s_nop 1
    ds_read_b128 v[44:47], v0 offset:4112
    v_smfmac_f32_16x16x64_bf16 v[52:55], v[32:35], v[136:143], v6
    v_add_f32 v48, v48, v50
    v_smfmac_f32_16x16x64_bf16 v[52:55], v[8:11], a[224:231], v6
    v_add_f32 v49, v49, v51
    v_smfmac_f32_16x16x64_bf16 v[52:55], v[12:15], a[232:239], v6
    v_cvt_pk_bf16_f32 v48, v48, v49
    v_smfmac_f32_16x16x64_bf16 v[56:59], v[24:27], v[176:183], v6
    ds_write_b32 v116, v48 offset:11264
    v_smfmac_f32_16x16x64_bf16 v[56:59], v[28:31], v[184:191], v6
    s_nop 1
    ds_read_b128 v[48:51], v0 offset:5136
    v_smfmac_f32_16x16x64_bf16 v[56:59], v[32:35], v[192:199], v6
    v_add_f32 v52, v52, v54
    v_smfmac_f32_16x16x64_bf16 v[56:59], v[8:11], v[144:151], v6
    v_add_f32 v53, v53, v55
    v_smfmac_f32_16x16x64_bf16 v[56:59], v[12:15], v[152:159], v6
    s_waitcnt lgkmcnt(1)
    s_barrier
    ds_read_b64_tr_b16 v[108:109], v117 offset:8192
    ds_read_b64_tr_b16 v[110:111], v117 offset:8320
    v_cvt_pk_bf16_f32 v52, v52, v53
    v_smfmac_f32_16x16x64_bf16 v[60:63], v[24:27], v[232:239], v6
    ds_write_b32 v116, v52 offset:12288
    v_smfmac_f32_16x16x64_bf16 v[60:63], v[28:31], v[240:247], v6
    ds_read_b64_tr_b16 v[112:113], v117 offset:9216
    v_smfmac_f32_16x16x64_bf16 v[60:63], v[32:35], v[248:255], v6
    ds_read_b64_tr_b16 v[114:115], v117 offset:9344
    v_add_f32 v56, v56, v58
    v_smfmac_f32_16x16x64_bf16 v[60:63], v[8:11], v[200:207], v6
    ds_read_b64_tr_b16 v[52:53], v117 offset:10240
    v_add_f32 v57, v57, v59
    v_smfmac_f32_16x16x64_bf16 v[60:63], v[12:15], v[208:215], v6
    s_waitcnt lgkmcnt(4)
    ds_read_b64_tr_b16 v[54:55], v117 offset:10368
    v_cvt_pk_bf16_f32 v56, v56, v57
    v_smfmac_f32_16x16x64_bf16 v[96:99], v[108:111], v[64:71], v6
    ds_read_b128 v[64:67], v0 offset:6144
    ds_write_b32 v116, v56 offset:13312
    v_smfmac_f32_16x16x64_bf16 v[100:103], v[108:111], v[72:79], v6
    ds_read_b128 v[68:71], v0 offset:7168
    ds_read_b128 v[72:75], v0 offset:6160
    v_mfma_f32_16x16x32_bf16 v[104:107], v[108:111], v[8:11], v[104:107]
    s_waitcnt lgkmcnt(6)
    ds_read_b128 v[76:79], v0 offset:7184
    v_add_f32 v60, v60, v62
    v_add_f32 v61, v61, v63
    v_smfmac_f32_16x16x64_bf16 v[96:99], v[112:115], v[80:87], v6
    ds_read_b64_tr_b16 v[56:57], v117 offset:11264
    v_cvt_pk_bf16_f32 v60, v60, v61
    ds_write_b32 v116, v60 offset:14336
    v_smfmac_f32_16x16x64_bf16 v[100:103], v[112:115], v[88:95], v6
    s_barrier
    ds_read_b64_tr_b16 v[58:59], v117 offset:11392
    ds_read_b128 v[80:83], v0 offset:8192
    v_mfma_f32_16x16x32_bf16 v[104:107], v[112:115], v[12:15], v[104:107]
    s_waitcnt lgkmcnt(9)
    ds_read_b128 v[84:87], v0 offset:9216
    ds_read_b128 v[88:91], v0 offset:8208
    v_smfmac_f32_16x16x64_bf16 v[96:99], v[52:55], v[36:43], v6
    ds_read_b128 v[92:95], v0 offset:9232
    ds_read_b64_tr_b16 v[108:109], v117 offset:12288
    v_smfmac_f32_16x16x64_bf16 v[100:103], v[52:55], v[44:51], v6
    ds_read_b64_tr_b16 v[110:111], v117 offset:12416
    ds_read_b128 v[36:39], v0 offset:10240
    v_mfma_f32_16x16x32_bf16 v[104:107], v[52:55], v[16:19], v[104:107]
    s_waitcnt lgkmcnt(7)
    ds_read_b128 v[40:43], v0 offset:11264
    ds_read_b128 v[44:47], v0 offset:10256
    v_smfmac_f32_16x16x64_bf16 v[96:99], v[56:59], v[64:71], v6
    s_barrier
    ds_read_b128 v[48:51], v0 offset:11280
    ds_read_b64_tr_b16 v[112:113], v117 offset:13312
    v_smfmac_f32_16x16x64_bf16 v[100:103], v[56:59], v[72:79], v6
    ds_read_b64_tr_b16 v[114:115], v117 offset:13440
    ds_read_b128 v[64:67], v0 offset:12288
    v_mfma_f32_16x16x32_bf16 v[104:107], v[56:59], v[20:23], v[104:107]
    s_waitcnt lgkmcnt(7)
    ds_read_b128 v[68:71], v0 offset:13312
    ds_read_b128 v[72:75], v0 offset:12304
    v_smfmac_f32_16x16x64_bf16 v[96:99], v[108:111], v[80:87], v6
    ds_read_b128 v[76:79], v0 offset:13328
    ds_read_b64_tr_b16 v[52:53], v117 offset:14336
    v_smfmac_f32_16x16x64_bf16 v[100:103], v[108:111], v[88:95], v6
    ds_read_b64_tr_b16 v[54:55], v117 offset:14464
    v_mfma_f32_16x16x32_bf16 v[104:107], v[108:111], v[24:27], v[104:107]
    s_waitcnt lgkmcnt(6)
    v_smfmac_f32_16x16x64_bf16 v[96:99], v[112:115], v[36:43], v6
    v_smfmac_f32_16x16x64_bf16 v[100:103], v[112:115], v[44:51], v6
    v_mfma_f32_16x16x32_bf16 v[104:107], v[112:115], v[28:31], v[104:107]
    s_waitcnt lgkmcnt(0)
    v_mfma_f32_16x16x32_bf16 v[104:107], v[52:55], v[32:35], v[104:107]
    s_nop 2
    v_smfmac_f32_16x16x64_bf16 v[96:99], v[52:55], v[64:71], v6
    s_nop 2
    v_smfmac_f32_16x16x64_bf16 v[100:103], v[52:55], v[72:79], v6
    v_add_f32_dpp v105, v107, v105 quad_perm:[2,3,0,1] row_mask:0xf bank_mask:0xf
    v_exp_f32 v82, v105
    s_nop 0
    v_cndmask_b32 v86, 0, v105, s[52:53]
    v_add_f32 v97, v97, v99
    v_exp_f32 v80, v97
    v_max_f32 v85, |v97|, |v86|
    v_add_f32 v84, v80, v82
    v_add_f32 v101, v101, v103
    v_exp_f32 v81, v101
    v_max_f32 v85, v85, |v101|
    v_add_f32 v84, v84, v81
    v_cmp_ngt_f32 vcc, s58, v85
    s_nop 0
K2_A_back1:
    v_add_f32_dpp v84, v84, v84 row_ror:8 row_mask:0xf bank_mask:0xf
    s_nop 1
    v_add_f32_dpp v84, v84, v84 row_ror:4 row_mask:0xf bank_mask:0xf
    s_cmp_eq_u64 vcc, 0
    s_cselect_b32 s28, s54, 69468160
    v_add_f32_dpp v84, v84, v84 row_ror:2 row_mask:0xf bank_mask:0xf
    s_nop 1
    v_add_f32_dpp v84, v84, v84 row_ror:1 row_mask:0xf bank_mask:0xf
    v_rcp_f32 v84, v84
    s_nop 0
    v_mul_f32 v85, v80, v84
    v_mul_f32 v86, v81, v84
    v_mul_f32 v87, v82, v84
    v_cvt_pk_bf16_f32 v85, v85, v86
    v_mul_f32_dpp v88, v82, v84 quad_perm:[1,0,3,2] row_mask:0xf bank_mask:0xf
    buffer_store_dword v85, v118, s[4:7], s28 offen
    v_cvt_pk_bf16_f32 v87, v87, v88
    buffer_store_dword v87, v119, s[4:7], s28 offen
    s_cbranch_scc0 K2_A_slow1
    s_cmp_lg_u32 s59, 0
    s_cbranch_scc1 K2_A_y1
K2_A_noy1:
    s_add_u32 s54, s54, s55
    s_and_b32 s54, s54, 4294836223
    v_xor_b32 v0, 98304, v0
    s_barrier
    s_add_u32 s70, s70, 32768
    s_and_b32 s70, s70, 4294836223
    s_add_u32 s26, s26, 1
    s_cmp_lt_u32 s26, 63
    s_cbranch_scc1 K2_A_w1
    s_waitcnt vmcnt(0)
    v_mov_b32 v16, -1
    v_mov_b32 v17, -1
    v_mov_b32 v18, -1
    v_mov_b32 v19, -1
    v_mov_b32 v20, -1
    v_mov_b32 v21, -1
    v_mov_b32 v22, -1
    v_mov_b32 v23, -1
    buffer_load_dwordx4 v[16:19], v4, s[4:7], s56 offen offset:2048 sc1
    buffer_load_dwordx4 v[20:23], v4, s[4:7], s56 offen offset:3072 sc1
Lrp_18:
    buffer_load_dwordx4 v[16:19], v4, s[4:7], s56 offen offset:2048 sc1
    buffer_load_dwordx4 v[20:23], v4, s[4:7], s56 offen offset:3072 sc1
    s_sub_u32 s60, s60, 1
    s_addc_u32 s61, s61, 0
    s_waitcnt vmcnt(2)
    v_max3_u32 v8, v16, v17, v18
    v_max3_u32 v12, v19, v20, v21
    v_max3_u32 v8, v8, v22, v23
    v_max_u32 v8, v8, v12
    v_cmp_lt_u32 vcc, s61, v8
    s_cbranch_vccnz Lrp_18
Lrg_19:
    buffer_store_dwordx4 v[16:19], v2, s[4:7], s71 offen offset:2048 sc1
    buffer_store_dwordx4 v[20:23], v2, s[4:7], s71 offen offset:3072 sc1
    s_branch K2_end
K2_A_y1:
    buffer_store_dword v87, v119, s[4:7], s70 offen sc1
    buffer_store_dword v85, v118, s[4:7], s70 offen sc1
    s_branch K2_A_noy1
K2_A_slow1:
    v_max3_f32 v84, v97, v101, v105
    s_nop 1
    v_max_f32_dpp v84, v84, v84 row_ror:8 row_mask:0xf bank_mask:0xf
    s_nop 1
    v_max_f32_dpp v84, v84, v84 row_ror:4 row_mask:0xf bank_mask:0xf
    s_nop 1
    v_max_f32_dpp v84, v84, v84 row_ror:2 row_mask:0xf bank_mask:0xf
    s_nop 1
    v_max_f32_dpp v84, v84, v84 row_ror:1 row_mask:0xf bank_mask:0xf
    v_sub_f32 v97, v97, v84
    v_sub_f32 v101, v101, v84
    v_sub_f32 v105, v105, v84
    v_exp_f32 v80, v97
    v_exp_f32 v81, v101
    v_exp_f32 v82, v105
    v_add_f32 v84, v80, v81
    v_add_f32 v84, v84, v82
    s_mov_b64 vcc, 0
    s_nop 0
    s_branch K2_A_back1
.p2align 6
K2_A_w2:
    v_mov_b32 v36, 0
    v_mov_b32 v37, 0
    v_mov_b32 v38, 0
    v_mov_b32 v39, 0
    v_mov_b32 v40, 0
    v_mov_b32 v41, 0
    v_mov_b32 v42, 0
    v_mov_b32 v43, 0
    v_mov_b32 v44, 0
    v_mov_b32 v45, 0
    v_mov_b32 v46, 0
    v_mov_b32 v47, 0
    v_mov_b32 v48, 0
    v_mov_b32 v49, 0
    v_mov_b32 v50, 0
    v_mov_b32 v51, 0
    s_add_u32 m0, s69, 4096
    s_add_u32 s67, s66, 4096
    buffer_load_dwordx4 v4, s[4:7], s67 offen offset:3072 lds
    s_add_u32 m0, s69, 8192
    s_add_u32 s67, s66, 8192
    buffer_load_dwordx4 v4, s[4:7], s67 offen offset:0 lds
    buffer_load_dwordx4 v4, s[4:7], s67 offen offset:1024 lds
    buffer_load_dwordx4 v4, s[4:7], s67 offen offset:2048 lds
    buffer_load_dwordx4 v4, s[4:7], s67 offen offset:3072 lds
    s_add_u32 m0, s69, 12288
    s_add_u32 s67, s66, 12288
    buffer_load_dwordx4 v4, s[4:7], s67 offen offset:0 lds
    buffer_load_dwordx4 v4, s[4:7], s67 offen offset:1024 lds
    s_add_u32 s66, s66, 28672
    s_xor_b32 s69, s69, 98304
    v_mov_b32 v52, 0
    v_mov_b32 v53, 0
    v_mov_b32 v54, 0
    v_mov_b32 v55, 0
    v_mov_b32 v56, 0
    v_mov_b32 v57, 0
    v_mov_b32 v58, 0
    v_mov_b32 v59, 0
    v_mov_b32 v60, 0
    v_mov_b32 v61, 0
    v_mov_b32 v62, 0
    v_mov_b32 v63, 0
    s_waitcnt vmcnt(7)
    v_cmp_ne_u32 vcc, s48, v5
    s_cbranch_vccnz K2_A_fwait2
K2_A_fok2:
    v_mov_b32 v24, -1
    v_mov_b32 v25, -1
    v_mov_b32 v26, -1
    v_mov_b32 v27, -1
    v_mov_b32 v28, -1
    v_mov_b32 v29, -1
    v_mov_b32 v30, -1
    v_mov_b32 v31, -1
    buffer_load_dwordx4 v[24:27], v4, s[4:7], s57 offen offset:0 sc1
    buffer_load_dwordx4 v[28:31], v4, s[4:7], s57 offen offset:1024 sc1
    s_sleep 2
Lrp_20:
    buffer_load_dwordx4 v[24:27], v4, s[4:7], s57 offen offset:0 sc1
    buffer_load_dwordx4 v[28:31], v4, s[4:7], s57 offen offset:1024 sc1
    s_sub_u32 s60, s60, 1
    s_addc_u32 s61, s61, 0
    s_nop 4
    v_mov_b32 v36, 0
    v_mov_b32 v37, 0
    v_mov_b32 v38, 0
    v_mov_b32 v39, 0
    v_mov_b32 v40, 0
    v_mov_b32 v41, 0
    v_mov_b32 v42, 0
    v_mov_b32 v43, 0
    s_waitcnt vmcnt(2)
    v_max3_u32 v8, v24, v25, v26
    v_max3_u32 v12, v27, v28, v29
    v_max3_u32 v8, v8, v30, v31
    v_max_u32 v8, v8, v12
    v_cmp_lt_u32 vcc, s61, v8
    v_smfmac_f32_16x16x64_bf16 v[36:39], v[24:27], a[32:39], v6
    v_smfmac_f32_16x16x64_bf16 v[40:43], v[24:27], a[88:95], v6
    s_cbranch_vccnz Lrp_20
Lrg_21:
    s_add_u32 s73, s74, 7168
    s_add_u32 s75, s75, 8192
    s_min_u32 s75, s75, s31
    ds_write_b128 v4, v[24:27] offset:4096
    v_smfmac_f32_16x16x64_bf16 v[44:47], v[24:27], a[144:151], v6
    buffer_load_dword v5, v1, s[4:7], s75 offen sc1
    ds_write_b128 v4, v[28:31] offset:5120
    v_smfmac_f32_16x16x64_bf16 v[48:51], v[24:27], a[200:207], v6
    s_add_u32 s56, s56, s34
    s_and_b32 s56, s56, s35
    s_add_u32 s57, s56, 4096
    v_smfmac_f32_16x16x64_bf16 v[52:55], v[24:27], v[120:127], v6
    v_smfmac_f32_16x16x64_bf16 v[56:59], v[24:27], v[176:183], v6
    buffer_load_dword v7, v0, s[4:7], s74 offen
    v_smfmac_f32_16x16x64_bf16 v[60:63], v[24:27], v[232:239], v6
    v_smfmac_f32_16x16x64_bf16 v[36:39], v[28:31], a[40:47], v6
    v_smfmac_f32_16x16x64_bf16 v[40:43], v[28:31], a[96:103], v6
    s_waitcnt lgkmcnt(0)
    s_barrier
    ds_read_b128 v[32:35], v4 offset:6144
    v_smfmac_f32_16x16x64_bf16 v[44:47], v[28:31], a[152:159], v6
    ds_read_b128 v[8:11], v4 offset:0
    v_smfmac_f32_16x16x64_bf16 v[48:51], v[28:31], a[208:215], v6
    ds_read_b128 v[12:15], v4 offset:1024
    v_smfmac_f32_16x16x64_bf16 v[52:55], v[28:31], v[128:135], v6
    ds_read_b128 v[16:19], v4 offset:2048
    v_smfmac_f32_16x16x64_bf16 v[56:59], v[28:31], v[184:191], v6
    ds_read_b128 v[20:23], v4 offset:3072
    v_smfmac_f32_16x16x64_bf16 v[60:63], v[28:31], v[240:247], v6
    s_waitcnt lgkmcnt(4)
    v_smfmac_f32_16x16x64_bf16 v[36:39], v[32:35], a[48:55], v6
    s_waitcnt lgkmcnt(3)
    v_smfmac_f32_16x16x64_bf16 v[36:39], v[8:11], a[0:7], v6
    s_waitcnt lgkmcnt(2)
    v_smfmac_f32_16x16x64_bf16 v[36:39], v[12:15], a[8:15], v6
    s_waitcnt lgkmcnt(1)
    v_smfmac_f32_16x16x64_bf16 v[36:39], v[16:19], a[16:23], v6
    s_waitcnt lgkmcnt(0)
    buffer_load_dword v7, v0, s[4:7], s73 offen
    v_smfmac_f32_16x16x64_bf16 v[36:39], v[20:23], a[24:31], v6
    v_smfmac_f32_16x16x64_bf16 v[40:43], v[32:35], a[104:111], v6
    s_nop 1
    v_smfmac_f32_16x16x64_bf16 v[40:43], v[8:11], a[56:63], v6
    s_nop 2
    v_smfmac_f32_16x16x64_bf16 v[40:43], v[12:15], a[64:71], v6
    v_add_f32 v36, v36, v38
    v_smfmac_f32_16x16x64_bf16 v[40:43], v[16:19], a[72:79], v6
    v_add_f32 v37, v37, v39
    v_smfmac_f32_16x16x64_bf16 v[40:43], v[20:23], a[80:87], v6
    v_cvt_pk_bf16_f32 v36, v36, v37
    v_smfmac_f32_16x16x64_bf16 v[44:47], v[32:35], a[160:167], v6
    ds_write_b32 v116, v36 offset:8192
    v_smfmac_f32_16x16x64_bf16 v[44:47], v[8:11], a[112:119], v6
    s_nop 2
    v_smfmac_f32_16x16x64_bf16 v[44:47], v[12:15], a[120:127], v6
    v_add_f32 v40, v40, v42
    v_smfmac_f32_16x16x64_bf16 v[44:47], v[16:19], a[128:135], v6
    v_add_f32 v41, v41, v43
    v_smfmac_f32_16x16x64_bf16 v[44:47], v[20:23], a[136:143], v6
    v_cvt_pk_bf16_f32 v40, v40, v41
    v_smfmac_f32_16x16x64_bf16 v[48:51], v[32:35], a[216:223], v6
    ds_write_b32 v116, v40 offset:9216
    v_smfmac_f32_16x16x64_bf16 v[48:51], v[8:11], a[168:175], v6
    s_nop 2
    v_smfmac_f32_16x16x64_bf16 v[48:51], v[12:15], a[176:183], v6
    v_add_f32 v44, v44, v46
    v_smfmac_f32_16x16x64_bf16 v[48:51], v[16:19], a[184:191], v6
    v_add_f32 v45, v45, v47
    v_smfmac_f32_16x16x64_bf16 v[48:51], v[20:23], a[192:199], v6
    v_cvt_pk_bf16_f32 v44, v44, v45
    v_smfmac_f32_16x16x64_bf16 v[52:55], v[32:35], v[136:143], v6
    ds_write_b32 v116, v44 offset:10240
    v_smfmac_f32_16x16x64_bf16 v[52:55], v[8:11], a[224:231], v6
    s_nop 2
    v_smfmac_f32_16x16x64_bf16 v[52:55], v[12:15], a[232:239], v6
    v_add_f32 v48, v48, v50
    v_smfmac_f32_16x16x64_bf16 v[52:55], v[16:19], a[240:247], v6
    v_add_f32 v49, v49, v51
    v_smfmac_f32_16x16x64_bf16 v[52:55], v[20:23], a[248:255], v6
    v_cvt_pk_bf16_f32 v48, v48, v49
    v_smfmac_f32_16x16x64_bf16 v[56:59], v[32:35], v[192:199], v6
    ds_write_b32 v116, v48 offset:11264
    v_smfmac_f32_16x16x64_bf16 v[56:59], v[8:11], v[144:151], v6
    s_nop 2
    v_smfmac_f32_16x16x64_bf16 v[56:59], v[12:15], v[152:159], v6
    v_add_f32 v52, v52, v54
    v_smfmac_f32_16x16x64_bf16 v[56:59], v[16:19], v[160:167], v6
    v_add_f32 v53, v53, v55
    v_smfmac_f32_16x16x64_bf16 v[56:59], v[20:23], v[168:175], v6
    s_waitcnt lgkmcnt(0)
    s_barrier
    v_cvt_pk_bf16_f32 v52, v52, v53
    v_smfmac_f32_16x16x64_bf16 v[60:63], v[32:35], v[248:255], v6
    ds_write_b32 v116, v52 offset:12288
    v_smfmac_f32_16x16x64_bf16 v[60:63], v[8:11], v[200:207], v6
    s_nop 0
    v_smfmac_f32_16x16x64_bf16 v[60:63], v[12:15], v[208:215], v6
    v_add_f32 v56, v56, v58
    v_smfmac_f32_16x16x64_bf16 v[60:63], v[16:19], v[216:223], v6
    s_add_u32 s74, s74, 458752
    s_min_u32 s74, s74, s30
    v_add_f32 v57, v57, v59
    v_smfmac_f32_16x16x64_bf16 v[60:63], v[20:23], v[224:231], v6
    v_cvt_pk_bf16_f32 v56, v56, v57
    ds_write_b32 v116, v56 offset:13312
    s_nop 5
    v_add_f32 v60, v60, v62
    v_add_f32 v61, v61, v63
    v_cvt_pk_bf16_f32 v60, v60, v61
    ds_write_b32 v116, v60 offset:14336
    s_waitcnt lgkmcnt(2)
    s_barrier
    s_waitcnt lgkmcnt(0)
    s_barrier
    s_xor_b32 s28, s70, 65536
    s_cmp_lg_u32 s59, 0
    s_cbranch_scc1 K2_A_ry
    buffer_store_dwordx4 v[100:103], v104, s[4:7], s28 offen
    s_branch K2_A_rd
K2_A_ry:
    buffer_store_dwordx4 v[100:103], v104, s[4:7], s28 offen sc1
K2_A_rd:
    s_barrier
    s_add_u32 s70, s70, 32768
    s_and_b32 s70, s70, 4294836223
    s_add_u32 s26, s26, 1
    s_cmp_lt_u32 s26, 63
    s_cbranch_scc1 K2_A_w2
    s_waitcnt vmcnt(0)
    v_mov_b32 v24, -1
    v_mov_b32 v25, -1
    v_mov_b32 v26, -1
    v_mov_b32 v27, -1
    v_mov_b32 v28, -1
    v_mov_b32 v29, -1
    v_mov_b32 v30, -1
    v_mov_b32 v31, -1
    buffer_load_dwordx4 v[24:27], v4, s[4:7], s57 offen offset:0 sc1
    buffer_load_dwordx4 v[28:31], v4, s[4:7], s57 offen offset:1024 sc1
Lrp_22:
    buffer_load_dwordx4 v[24:27], v4, s[4:7], s57 offen offset:0 sc1
    buffer_load_dwordx4 v[28:31], v4, s[4:7], s57 offen offset:1024 sc1
    s_sub_u32 s60, s60, 1
    s_addc_u32 s61, s61, 0
    s_waitcnt vmcnt(2)
    v_max3_u32 v8, v24, v25, v26
    v_max3_u32 v12, v27, v28, v29
    v_max3_u32 v8, v8, v30, v31
    v_max_u32 v8, v8, v12
    v_cmp_lt_u32 vcc, s61, v8
    s_cbranch_vccnz Lrp_22
Lrg_23:
    buffer_store_dwordx4 v[24:27], v64, s[4:7], s72 offen offset:0 sc1
    buffer_store_dwordx4 v[28:31], v64, s[4:7], s72 offen offset:1024 sc1
    s_branch K2_end
K2_A_fwait2:
Lwf_24:
    buffer_load_dword v7, v1, s[4:7], s75 offen sc1
    s_waitcnt vmcnt(0)
    v_cmp_ne_u32 vcc, s48, v7
    s_cbranch_vccz Lwd_25
    s_sleep 1
    s_sub_u32 s27, s27, 1
    s_cbranch_scc1 K2_end
    s_branch Lwf_24
Lwd_25:
    s_branch K2_A_fok2
.p2align 6
K2_A_w3:
    v_mov_b32 v36, 0
    v_mov_b32 v37, 0
    v_mov_b32 v38, 0
    v_mov_b32 v39, 0
    v_mov_b32 v40, 0
    v_mov_b32 v41, 0
    v_mov_b32 v42, 0
    v_mov_b32 v43, 0
    v_mov_b32 v44, 0
    v_mov_b32 v45, 0
    v_mov_b32 v46, 0
    v_mov_b32 v47, 0
    v_mov_b32 v48, 0
    v_mov_b32 v49, 0
    v_mov_b32 v50, 0
    v_mov_b32 v51, 0
    s_add_u32 m0, s69, 4096
    s_add_u32 s67, s66, 4096
    buffer_load_dwordx4 v4, s[4:7], s67 offen offset:3072 lds
    s_add_u32 m0, s69, 8192
    s_add_u32 s67, s66, 8192
    buffer_load_dwordx4 v4, s[4:7], s67 offen offset:0 lds
    buffer_load_dwordx4 v4, s[4:7], s67 offen offset:1024 lds
    buffer_load_dwordx4 v4, s[4:7], s67 offen offset:2048 lds
    buffer_load_dwordx4 v4, s[4:7], s67 offen offset:3072 lds
    s_add_u32 m0, s69, 12288
    s_add_u32 s67, s66, 12288
    buffer_load_dwordx4 v4, s[4:7], s67 offen offset:0 lds
    buffer_load_dwordx4 v4, s[4:7], s67 offen offset:1024 lds
    s_add_u32 s66, s66, 28672
    s_xor_b32 s69, s69, 98304
    v_mov_b32 v52, 0
    v_mov_b32 v53, 0
    v_mov_b32 v54, 0
    v_mov_b32 v55, 0
    v_mov_b32 v56, 0
    v_mov_b32 v57, 0
    v_mov_b32 v58, 0
    v_mov_b32 v59, 0
    v_mov_b32 v60, 0
    v_mov_b32 v61, 0
    v_mov_b32 v62, 0
    v_mov_b32 v63, 0
    s_waitcnt vmcnt(7)
    v_cmp_ne_u32 vcc, s48, v5
    s_cbranch_vccnz K2_A_fwait3
K2_A_fok3:
    v_mov_b32 v32, -1
    v_mov_b32 v33, -1
    v_mov_b32 v34, -1
    v_mov_b32 v35, -1
    v_mov_b32 v8, -1
    v_mov_b32 v9, -1
    v_mov_b32 v10, -1
    v_mov_b32 v11, -1
    buffer_load_dwordx4 v[32:35], v4, s[4:7], s57 offen offset:2048 sc1
    buffer_load_dwordx4 v[8:11], v4, s[4:7], s56 offen offset:0 sc1
    s_sleep 2
Lrp_26:
    buffer_load_dwordx4 v[32:35], v4, s[4:7], s57 offen offset:2048 sc1
    buffer_load_dwordx4 v[8:11], v4, s[4:7], s56 offen offset:0 sc1
    s_sub_u32 s60, s60, 1
    s_addc_u32 s61, s61, 0
    s_nop 4
    v_mov_b32 v36, 0
    v_mov_b32 v37, 0
    v_mov_b32 v38, 0
    v_mov_b32 v39, 0
    v_mov_b32 v40, 0
    v_mov_b32 v41, 0
    v_mov_b32 v42, 0
    v_mov_b32 v43, 0
    s_waitcnt vmcnt(2)
    v_max3_u32 v12, v32, v33, v34
    v_max3_u32 v16, v35, v8, v9
    v_max3_u32 v12, v12, v10, v11
    v_max_u32 v12, v12, v16
    v_cmp_lt_u32 vcc, s61, v12
    v_smfmac_f32_16x16x64_bf16 v[36:39], v[32:35], a[48:55], v6
    v_smfmac_f32_16x16x64_bf16 v[40:43], v[32:35], a[104:111], v6
    s_cbranch_vccnz Lrp_26
Lrg_27:
    s_add_u32 s73, s74, 7168
    s_add_u32 s75, s75, 8192
    s_min_u32 s75, s75, s31
    ds_write_b128 v4, v[32:35] offset:6144
    v_smfmac_f32_16x16x64_bf16 v[44:47], v[32:35], a[160:167], v6
    buffer_load_dword v5, v1, s[4:7], s75 offen sc1
    v_smfmac_f32_16x16x64_bf16 v[48:51], v[32:35], a[216:223], v6
    s_add_u32 s56, s56, s34
    s_and_b32 s56, s56, s35
    s_add_u32 s57, s56, 4096
    v_smfmac_f32_16x16x64_bf16 v[52:55], v[32:35], v[136:143], v6
    buffer_load_dword v7, v2, s[4:7], 0 offen sc1
    v_smfmac_f32_16x16x64_bf16 v[56:59], v[32:35], v[192:199], v6
    v_smfmac_f32_16x16x64_bf16 v[60:63], v[32:35], v[248:255], v6
    v_smfmac_f32_16x16x64_bf16 v[36:39], v[8:11], a[0:7], v6
    v_smfmac_f32_16x16x64_bf16 v[40:43], v[8:11], a[56:63], v6
    s_waitcnt lgkmcnt(0)
    s_barrier
    ds_read_b128 v[12:15], v4 offset:1024
    v_smfmac_f32_16x16x64_bf16 v[44:47], v[8:11], a[112:119], v6
    ds_read_b128 v[16:19], v4 offset:2048
    v_smfmac_f32_16x16x64_bf16 v[48:51], v[8:11], a[168:175], v6
    ds_read_b128 v[20:23], v4 offset:3072
    v_smfmac_f32_16x16x64_bf16 v[52:55], v[8:11], a[224:231], v6
    ds_read_b128 v[24:27], v4 offset:4096
    buffer_load_dword v7, v0, s[4:7], s74 offen
    v_smfmac_f32_16x16x64_bf16 v[56:59], v[8:11], v[144:151], v6
    ds_read_b128 v[28:31], v4 offset:5120
    ds_read_b64 v[98:99], v96 offset:0
    v_smfmac_f32_16x16x64_bf16 v[60:63], v[8:11], v[200:207], v6
    s_waitcnt lgkmcnt(5)
    v_smfmac_f32_16x16x64_bf16 v[36:39], v[12:15], a[8:15], v6
    s_waitcnt lgkmcnt(4)
    v_smfmac_f32_16x16x64_bf16 v[36:39], v[16:19], a[16:23], v6
    s_waitcnt lgkmcnt(3)
    v_smfmac_f32_16x16x64_bf16 v[36:39], v[20:23], a[24:31], v6
    s_waitcnt lgkmcnt(2)
    v_smfmac_f32_16x16x64_bf16 v[36:39], v[24:27], a[32:39], v6
    s_waitcnt lgkmcnt(1)
    v_smfmac_f32_16x16x64_bf16 v[36:39], v[28:31], a[40:47], v6
    v_smfmac_f32_16x16x64_bf16 v[40:43], v[12:15], a[64:71], v6
    s_waitcnt lgkmcnt(0)
    buffer_store_dwordx2 v[98:99], v97, s[4:7], s54 offen sc1
    v_smfmac_f32_16x16x64_bf16 v[40:43], v[16:19], a[72:79], v6
    s_nop 2
    v_smfmac_f32_16x16x64_bf16 v[40:43], v[20:23], a[80:87], v6
    v_add_f32 v36, v36, v38
    v_smfmac_f32_16x16x64_bf16 v[40:43], v[24:27], a[88:95], v6
    v_add_f32 v37, v37, v39
    v_smfmac_f32_16x16x64_bf16 v[40:43], v[28:31], a[96:103], v6
    buffer_load_dword v7, v0, s[4:7], s73 offen
    v_cvt_pk_bf16_f32 v36, v36, v37
    v_smfmac_f32_16x16x64_bf16 v[44:47], v[12:15], a[120:127], v6
    ds_write_b32 v116, v36 offset:8192
    v_smfmac_f32_16x16x64_bf16 v[44:47], v[16:19], a[128:135], v6
    s_nop 1
    v_smfmac_f32_16x16x64_bf16 v[44:47], v[20:23], a[136:143], v6
    v_add_f32 v40, v40, v42
    v_smfmac_f32_16x16x64_bf16 v[44:47], v[24:27], a[144:151], v6
    v_add_f32 v41, v41, v43
    v_smfmac_f32_16x16x64_bf16 v[44:47], v[28:31], a[152:159], v6
    v_cvt_pk_bf16_f32 v40, v40, v41
    v_smfmac_f32_16x16x64_bf16 v[48:51], v[12:15], a[176:183], v6
    ds_write_b32 v116, v40 offset:9216
    v_smfmac_f32_16x16x64_bf16 v[48:51], v[16:19], a[184:191], v6
    s_nop 2
    v_smfmac_f32_16x16x64_bf16 v[48:51], v[20:23], a[192:199], v6
    v_add_f32 v44, v44, v46
    v_smfmac_f32_16x16x64_bf16 v[48:51], v[24:27], a[200:207], v6
    v_add_f32 v45, v45, v47
    v_smfmac_f32_16x16x64_bf16 v[48:51], v[28:31], a[208:215], v6
    v_cvt_pk_bf16_f32 v44, v44, v45
    v_smfmac_f32_16x16x64_bf16 v[52:55], v[12:15], a[232:239], v6
    ds_write_b32 v116, v44 offset:10240
    v_smfmac_f32_16x16x64_bf16 v[52:55], v[16:19], a[240:247], v6
    s_nop 2
    v_smfmac_f32_16x16x64_bf16 v[52:55], v[20:23], a[248:255], v6
    v_add_f32 v48, v48, v50
    v_smfmac_f32_16x16x64_bf16 v[52:55], v[24:27], v[120:127], v6
    v_add_f32 v49, v49, v51
    v_smfmac_f32_16x16x64_bf16 v[52:55], v[28:31], v[128:135], v6
    v_cvt_pk_bf16_f32 v48, v48, v49
    v_smfmac_f32_16x16x64_bf16 v[56:59], v[12:15], v[152:159], v6
    ds_write_b32 v116, v48 offset:11264
    v_smfmac_f32_16x16x64_bf16 v[56:59], v[16:19], v[160:167], v6
    s_nop 2
    v_smfmac_f32_16x16x64_bf16 v[56:59], v[20:23], v[168:175], v6
    v_add_f32 v52, v52, v54
    v_smfmac_f32_16x16x64_bf16 v[56:59], v[24:27], v[176:183], v6
    v_add_f32 v53, v53, v55
    v_smfmac_f32_16x16x64_bf16 v[56:59], v[28:31], v[184:191], v6
    s_waitcnt lgkmcnt(0)
    s_barrier
    v_cvt_pk_bf16_f32 v52, v52, v53
    v_smfmac_f32_16x16x64_bf16 v[60:63], v[12:15], v[208:215], v6
    ds_write_b32 v116, v52 offset:12288
    v_smfmac_f32_16x16x64_bf16 v[60:63], v[16:19], v[216:223], v6
    v_add_u32 v2, 28672, v2
    v_smfmac_f32_16x16x64_bf16 v[60:63], v[20:23], v[224:231], v6
    s_add_u32 s54, s54, 7168
    v_add_f32 v56, v56, v58
    v_smfmac_f32_16x16x64_bf16 v[60:63], v[24:27], v[232:239], v6
    s_add_u32 s74, s74, 458752
    s_min_u32 s74, s74, s30
    v_add_f32 v57, v57, v59
    v_smfmac_f32_16x16x64_bf16 v[60:63], v[28:31], v[240:247], v6
    v_cvt_pk_bf16_f32 v56, v56, v57
    ds_write_b32 v116, v56 offset:13312
    s_nop 5
    v_add_f32 v60, v60, v62
    v_add_f32 v61, v61, v63
    v_cvt_pk_bf16_f32 v60, v60, v61
    ds_write_b32 v116, v60 offset:14336
    s_waitcnt lgkmcnt(2)
    s_barrier
    s_waitcnt lgkmcnt(0)
    s_barrier
    s_barrier
    s_add_u32 s70, s70, 32768
    s_and_b32 s70, s70, 4294836223
    s_add_u32 s26, s26, 1
    s_cmp_lt_u32 s26, 63
    s_cbranch_scc1 K2_A_w3
    s_waitcnt vmcnt(0)
    v_mov_b32 v32, -1
    v_mov_b32 v33, -1
    v_mov_b32 v34, -1
    v_mov_b32 v35, -1
    v_mov_b32 v8, -1
    v_mov_b32 v9, -1
    v_mov_b32 v10, -1
    v_mov_b32 v11, -1
    buffer_load_dwordx4 v[32:35], v4, s[4:7], s57 offen offset:2048 sc1
    buffer_load_dwordx4 v[8:11], v4, s[4:7], s56 offen offset:0 sc1
Lrp_28:
    buffer_load_dwordx4 v[32:35], v4, s[4:7], s57 offen offset:2048 sc1
    buffer_load_dwordx4 v[8:11], v4, s[4:7], s56 offen offset:0 sc1
    s_sub_u32 s60, s60, 1
    s_addc_u32 s61, s61, 0
    s_waitcnt vmcnt(2)
    v_max3_u32 v12, v32, v33, v34
    v_max3_u32 v16, v35, v8, v9
    v_max3_u32 v12, v12, v10, v11
    v_max_u32 v12, v12, v16
    v_cmp_lt_u32 vcc, s61, v12
    s_cbranch_vccnz Lrp_28
Lrg_29:
    buffer_store_dwordx4 v[32:35], v64, s[4:7], s72 offen offset:2048 sc1
    s_branch K2_end
K2_A_fwait3:
Lwf_30:
    buffer_load_dword v7, v1, s[4:7], s75 offen sc1
    s_waitcnt vmcnt(0)
    v_cmp_ne_u32 vcc, s48, v7
    s_cbranch_vccz Lwd_31
    s_sleep 1
    s_sub_u32 s27, s27, 1
    s_cbranch_scc1 K2_end
    s_branch Lwf_30
Lwd_31:
    s_branch K2_A_fok3
.p2align 6
K2_B:
    v_and_b32 v12, 7, v1
    v_lshlrev_b32 v12, 10, v12
    s_add_u32 s28, s24, 0
    s_lshl_b32 s28, s28, 7
    v_add_u32 v12, s28, v12
    s_cmp_lg_u32 s24, 0
    s_cbranch_scc1 K2_B_nb
    v_and_b32 v13, 7, v1
    v_lshlrev_b32 v13, 10, v13
    s_and_b32 s28, s2, 7
    s_lshl_b32 s28, s28, 7
    v_add_u32 v13, s28, v13
    v_cmp_le_u32 vcc, 32, v1
    s_nop 1
    v_cndmask_b32 v12, v12, v13, vcc
Lsw_32:
    buffer_load_dwordx4 v[8:11], v13, s[4:7], s49 offen sc1
Lse_34:
    s_waitcnt vmcnt(0)
    v_xor_b32 v8, s48, v8
    v_xor_b32 v9, s48, v9
    v_xor_b32 v10, s48, v10
    v_xor_b32 v11, s48, v11
    v_or3_b32 v8, v8, v9, v10
    v_or_b32 v8, v8, v11
    v_cmp_lt_u32 vcc, 1, v8
    s_cbranch_vccz Lsd_33
    s_sleep 1
    s_sub_u32 s27, s27, 1
    s_cbranch_scc1 K2_end
    s_branch Lsw_32
Lsd_33:
K2_B_nb:
    s_barrier
Lsw_35:
    buffer_load_dwordx4 v[8:11], v12, s[4:7], s49 offen sc1
Lse_37:
    s_waitcnt vmcnt(0)
    v_xor_b32 v8, s48, v8
    v_xor_b32 v9, s48, v9
    v_xor_b32 v10, s48, v10
    v_xor_b32 v11, s48, v11
    v_or3_b32 v8, v8, v9, v10
    v_or_b32 v8, v8, v11
    v_cmp_lt_u32 vcc, 1, v8
    s_cbranch_vccz Lsd_36
    s_sleep 1
    s_sub_u32 s27, s27, 1
    s_cbranch_scc1 K2_end
    s_branch Lsw_35
Lsd_36:
    s_sub_u32 s25, s25, 16
    s_lshl_b32 s50, s24, 2
    s_add_u32 s50, s50, 16
    s_mul_i32 s50, s50, 401408
    s_mul_i32 s51, s25, 448
    s_add_u32 s50, s50, s51
    s_add_u32 s50, s50, 2097152
    v_mul_u32_u24 v7, 7168, v3
    s_mov_b32 s28, 0x924924a
    s_mov_b32 s29, 400960
    v_add_u32 v64, 0, v2
    v_mul_hi_u32 v72, s28, v64
    v_mul_lo_u32 v72, s29, v72
    v_lshl_add_u32 v64, v64, 4, v72
    v_add_u32 v64, v64, v7
    v_add_u32 v65, 16, v2
    v_mul_hi_u32 v72, s28, v65
    v_mul_lo_u32 v72, s29, v72
    v_lshl_add_u32 v65, v65, 4, v72
    v_add_u32 v65, v65, v7
    v_add_u32 v66, 32, v2
    v_mul_hi_u32 v72, s28, v66
    v_mul_lo_u32 v72, s29, v72
    v_lshl_add_u32 v66, v66, 4, v72
    v_add_u32 v66, v66, v7
    v_add_u32 v67, 48, v2
    v_mul_hi_u32 v72, s28, v67
    v_mul_lo_u32 v72, s29, v72
    v_lshl_add_u32 v67, v67, 4, v72
    v_add_u32 v67, v67, v7
    v_add_u32 v68, 64, v2
    v_mul_hi_u32 v72, s28, v68
    v_mul_lo_u32 v72, s29, v72
    v_lshl_add_u32 v68, v68, 4, v72
    v_add_u32 v68, v68, v7
    v_add_u32 v69, 80, v2
    v_mul_hi_u32 v72, s28, v69
    v_mul_lo_u32 v72, s29, v72
    v_lshl_add_u32 v69, v69, 4, v72
    v_add_u32 v69, v69, v7
    v_add_u32 v70, 96, v2
    v_mul_hi_u32 v72, s28, v70
    v_mul_lo_u32 v72, s29, v72
    v_lshl_add_u32 v70, v70, 4, v72
    v_add_u32 v70, v70, v7
    buffer_load_dwordx4 a[0:3], v64, s[4:7], s50 offen offset:0
    buffer_load_dwordx4 a[56:59], v65, s[4:7], s50 offen offset:0
    buffer_load_dwordx4 a[112:115], v66, s[4:7], s50 offen offset:0
    buffer_load_dwordx4 a[168:171], v67, s[4:7], s50 offen offset:0
    buffer_load_dwordx4 a[224:227], v68, s[4:7], s50 offen offset:0
    buffer_load_dwordx4 v[144:147], v69, s[4:7], s50 offen offset:0
    buffer_load_dwordx4 v[200:203], v70, s[4:7], s50 offen offset:0
    s_add_u32 s50, s50, 28672
    buffer_load_dwordx4 a[4:7], v64, s[4:7], s50 offen offset:0
    buffer_load_dwordx4 a[60:63], v65, s[4:7], s50 offen offset:0
    buffer_load_dwordx4 a[116:119], v66, s[4:7], s50 offen offset:0
    buffer_load_dwordx4 a[172:175], v67, s[4:7], s50 offen offset:0
    buffer_load_dwordx4 a[228:231], v68, s[4:7], s50 offen offset:0
    buffer_load_dwordx4 v[148:151], v69, s[4:7], s50 offen offset:0
    buffer_load_dwordx4 v[204:207], v70, s[4:7], s50 offen offset:0
    s_add_u32 s50, s50, 28672
    buffer_load_dwordx4 a[8:11], v64, s[4:7], s50 offen offset:0
    buffer_load_dwordx4 a[64:67], v65, s[4:7], s50 offen offset:0
    buffer_load_dwordx4 a[120:123], v66, s[4:7], s50 offen offset:0
    buffer_load_dwordx4 a[176:179], v67, s[4:7], s50 offen offset:0
    buffer_load_dwordx4 a[232:235], v68, s[4:7], s50 offen offset:0
    buffer_load_dwordx4 v[152:155], v69, s[4:7], s50 offen offset:0
    buffer_load_dwordx4 v[208:211], v70, s[4:7], s50 offen offset:0
    s_add_u32 s50, s50, 28672
    buffer_load_dwordx4 a[12:15], v64, s[4:7], s50 offen offset:0
    buffer_load_dwordx4 a[68:71], v65, s[4:7], s50 offen offset:0
    buffer_load_dwordx4 a[124:127], v66, s[4:7], s50 offen offset:0
    buffer_load_dwordx4 a[180:183], v67, s[4:7], s50 offen offset:0
    buffer_load_dwordx4 a[236:239], v68, s[4:7], s50 offen offset:0
    buffer_load_dwordx4 v[156:159], v69, s[4:7], s50 offen offset:0
    buffer_load_dwordx4 v[212:215], v70, s[4:7], s50 offen offset:0
    s_add_u32 s50, s50, 28672
    buffer_load_dwordx4 a[16:19], v64, s[4:7], s50 offen offset:0
    buffer_load_dwordx4 a[72:75], v65, s[4:7], s50 offen offset:0
    buffer_load_dwordx4 a[128:131], v66, s[4:7], s50 offen offset:0
    buffer_load_dwordx4 a[184:187], v67, s[4:7], s50 offen offset:0
    buffer_load_dwordx4 a[240:243], v68, s[4:7], s50 offen offset:0
    buffer_load_dwordx4 v[160:163], v69, s[4:7], s50 offen offset:0
    buffer_load_dwordx4 v[216:219], v70, s[4:7], s50 offen offset:0
    s_add_u32 s50, s50, 28672
    buffer_load_dwordx4 a[20:23], v64, s[4:7], s50 offen offset:0
    buffer_load_dwordx4 a[76:79], v65, s[4:7], s50 offen offset:0
    buffer_load_dwordx4 a[132:135], v66, s[4:7], s50 offen offset:0
    buffer_load_dwordx4 a[188:191], v67, s[4:7], s50 offen offset:0
    buffer_load_dwordx4 a[244:247], v68, s[4:7], s50 offen offset:0
    buffer_load_dwordx4 v[164:167], v69, s[4:7], s50 offen offset:0
    buffer_load_dwordx4 v[220:223], v70, s[4:7], s50 offen offset:0
    s_add_u32 s50, s50, 28672
    buffer_load_dwordx4 a[24:27], v64, s[4:7], s50 offen offset:0
    buffer_load_dwordx4 a[80:83], v65, s[4:7], s50 offen offset:0
    buffer_load_dwordx4 a[136:139], v66, s[4:7], s50 offen offset:0
    buffer_load_dwordx4 a[192:195], v67, s[4:7], s50 offen offset:0
    buffer_load_dwordx4 a[248:251], v68, s[4:7], s50 offen offset:0
    buffer_load_dwordx4 v[168:171], v69, s[4:7], s50 offen offset:0
    buffer_load_dwordx4 v[224:227], v70, s[4:7], s50 offen offset:0
    s_add_u32 s50, s50, 28672
    v_lshlrev_b32 v12, 7, v1
    s_waitcnt vmcnt(24)
    buffer_load_dwordx4 v[8:11], v12, s[4:7], s49 offen sc1
    buffer_load_dwordx4 a[28:31], v64, s[4:7], s50 offen offset:0
    buffer_load_dwordx4 a[84:87], v65, s[4:7], s50 offen offset:0
    buffer_load_dwordx4 a[140:143], v66, s[4:7], s50 offen offset:0
    buffer_load_dwordx4 a[196:199], v67, s[4:7], s50 offen offset:0
    buffer_load_dwordx4 a[252:255], v68, s[4:7], s50 offen offset:0
    buffer_load_dwordx4 v[172:175], v69, s[4:7], s50 offen offset:0
    buffer_load_dwordx4 v[228:231], v70, s[4:7], s50 offen offset:0
    s_add_u32 s50, s50, 28672
    buffer_load_dwordx4 a[32:35], v64, s[4:7], s50 offen offset:0
    buffer_load_dwordx4 a[88:91], v65, s[4:7], s50 offen offset:0
    buffer_load_dwordx4 a[144:147], v66, s[4:7], s50 offen offset:0
    buffer_load_dwordx4 a[200:203], v67, s[4:7], s50 offen offset:0
    buffer_load_dwordx4 v[120:123], v68, s[4:7], s50 offen offset:0
    buffer_load_dwordx4 v[176:179], v69, s[4:7], s50 offen offset:0
    buffer_load_dwordx4 v[232:235], v70, s[4:7], s50 offen offset:0
    s_add_u32 s50, s50, 28672
    buffer_load_dwordx4 a[36:39], v64, s[4:7], s50 offen offset:0
    buffer_load_dwordx4 a[92:95], v65, s[4:7], s50 offen offset:0
    buffer_load_dwordx4 a[148:151], v66, s[4:7], s50 offen offset:0
    buffer_load_dwordx4 a[204:207], v67, s[4:7], s50 offen offset:0
    buffer_load_dwordx4 v[124:127], v68, s[4:7], s50 offen offset:0
    buffer_load_dwordx4 v[180:183], v69, s[4:7], s50 offen offset:0
    buffer_load_dwordx4 v[236:239], v70, s[4:7], s50 offen offset:0
    s_add_u32 s50, s50, 28672
    buffer_load_dwordx4 a[40:43], v64, s[4:7], s50 offen offset:0
    buffer_load_dwordx4 a[96:99], v65, s[4:7], s50 offen offset:0
    buffer_load_dwordx4 a[152:155], v66, s[4:7], s50 offen offset:0
    buffer_load_dwordx4 a[208:211], v67, s[4:7], s50 offen offset:0
    buffer_load_dwordx4 v[128:131], v68, s[4:7], s50 offen offset:0
    buffer_load_dwordx4 v[184:187], v69, s[4:7], s50 offen offset:0
    buffer_load_dwordx4 v[240:243], v70, s[4:7], s50 offen offset:0
    s_add_u32 s50, s50, 28672
    buffer_load_dwordx4 a[44:47], v64, s[4:7], s50 offen offset:0
    buffer_load_dwordx4 a[100:103], v65, s[4:7], s50 offen offset:0
    buffer_load_dwordx4 a[156:159], v66, s[4:7], s50 offen offset:0
    buffer_load_dwordx4 a[212:215], v67, s[4:7], s50 offen offset:0
    buffer_load_dwordx4 v[132:135], v68, s[4:7], s50 offen offset:0
    buffer_load_dwordx4 v[188:191], v69, s[4:7], s50 offen offset:0
    buffer_load_dwordx4 v[244:247], v70, s[4:7], s50 offen offset:0
    s_add_u32 s50, s50, 28672
    buffer_load_dwordx4 a[48:51], v64, s[4:7], s50 offen offset:0
    buffer_load_dwordx4 a[104:107], v65, s[4:7], s50 offen offset:0
    buffer_load_dwordx4 a[160:163], v66, s[4:7], s50 offen offset:0
    buffer_load_dwordx4 a[216:219], v67, s[4:7], s50 offen offset:0
    buffer_load_dwordx4 v[136:139], v68, s[4:7], s50 offen offset:0
    buffer_load_dwordx4 v[192:195], v69, s[4:7], s50 offen offset:0
    buffer_load_dwordx4 v[248:251], v70, s[4:7], s50 offen offset:0
    s_add_u32 s50, s50, 28672
    buffer_load_dwordx4 a[52:55], v64, s[4:7], s50 offen offset:0
    buffer_load_dwordx4 a[108:111], v65, s[4:7], s50 offen offset:0
    buffer_load_dwordx4 a[164:167], v66, s[4:7], s50 offen offset:0
    buffer_load_dwordx4 a[220:223], v67, s[4:7], s50 offen offset:0
    buffer_load_dwordx4 v[140:143], v68, s[4:7], s50 offen offset:0
    buffer_load_dwordx4 v[196:199], v69, s[4:7], s50 offen offset:0
    buffer_load_dwordx4 v[252:255], v70, s[4:7], s50 offen offset:0
    s_add_u32 s50, s50, 28672
    v_mov_b32 v6, 0x4444
    v_mov_b32 v7, 0xeeee
    v_and_b32 v5, 2, v2
    v_cmp_ne_u32 vcc, 0, v5
    s_nop 1
    v_cndmask_b32 v6, v6, v7, vcc
    s_lshl_b32 s54, s24, 11
    v_lshrrev_b32 v72, 1, v3
    v_and_b32 v73, 1, v3
    v_lshlrev_b32 v118, 4, v2
    v_lshl_add_u32 v118, v72, 2, v118
    v_lshl_add_u32 v118, v73, 3, v118
    v_add_u32 v118, s54, v118
    v_mul_u32_u24 v119, 448, v3
    v_lshl_add_u32 v119, v2, 4, v119
    v_add_u32 v119, s54, v119
    s_lshr_b32 s28, s24, 1
    s_lshl_b32 s28, s28, 4
    v_and_b32 v76, 14, v2
    v_add_u32 v76, s28, v76
    v_cmp_gt_u32 vcc, 28, v76
    v_and_b32 v75, 1, v2
    v_cmp_eq_u32 s[64:65], 0, v75
    s_mul_i32 s28, s25, 28
    v_add_u32 v76, s28, v76
    v_lshrrev_b32 v77, 4, v76
    v_lshlrev_b32 v77, 8, v77
    v_lshl_add_u32 v77, v3, 6, v77
    v_bfe_u32 v78, v76, 3, 1
    v_lshl_add_u32 v77, v78, 5, v77
    v_and_b32 v78, 7, v76
    v_lshl_add_u32 v77, v78, 1, v77
    v_lshl_add_u32 v77, v75, 4, v77
    v_mov_b32 v78, 0x7ffffff0
    v_cndmask_b32 v5, v78, v77, vcc
    v_and_b32 v74, 62, v1
    v_lshlrev_b32 v74, 2, v74
    v_lshl_add_u32 v74, v75, 10, v74
    v_and_b32 v79, 3, v2
    v_lshlrev_b32 v79, 2, v79
    v_lshrrev_b32 v78, 2, v2
    v_lshl_add_u32 v79, v78, 7, v79
    v_and_b32 v78, 1, v3
    v_lshl_add_u32 v79, v78, 13, v79
    v_lshlrev_b32 v80, 2, v1
    v_mul_u32_u24 v73, 7168, v3
    v_lshl_add_u32 v0, v2, 4, v73
    v_min_u32 v72, 11, v2
    v_lshl_add_u32 v1, v72, 4, v73
    s_mul_i32 s66, s24, 114688
    s_mul_i32 s28, s25, 448
    s_add_u32 s66, s66, s28
    s_add_u32 s66, s66, 19333120
    s_lshl_b32 s68, s24, 11
    s_add_u32 s68, s68, 69238784
    s_lshl_b32 s69, s24, 9
    s_add_u32 s69, s69, 72359936
    s_mov_b32 s73, 69287936
    s_mov_b32 s74, 70268928
    v_mov_b32 v116, -1
    v_mov_b32 v117, -1
    v_min_u32 v3, 220, v80
    v_lshlrev_b32 v3, 1, v3
    s_mul_i32 s28, s25, 448
    v_add_u32 v3, s28, v3
    v_mov_b32 v2, v74
    s_mov_b32 s61, 0xfffffffe
    s_mov_b32 s60, 0x100000
    s_mov_b32 s26, 1
    s_waitcnt vmcnt(49)
    v_xor_b32 v8, s48, v8
    v_xor_b32 v9, s48, v9
    v_xor_b32 v10, s48, v10
    v_xor_b32 v11, s48, v11
    v_or3_b32 v8, v8, v9, v10
    v_or_b32 v8, v8, v11
    v_cmp_lt_u32 vcc, 1, v8
    s_cbranch_vccz Lok_38
Lsw_39:
    buffer_load_dwordx4 v[8:11], v12, s[4:7], s49 offen sc1
Lse_41:
    s_waitcnt vmcnt(0)
    v_xor_b32 v8, s48, v8
    v_xor_b32 v9, s48, v9
    v_xor_b32 v10, s48, v10
    v_xor_b32 v11, s48, v11
    v_or3_b32 v8, v8, v9, v10
    v_or_b32 v8, v8, v11
    v_cmp_lt_u32 vcc, 1, v8
    s_cbranch_vccz Lsd_40
    s_sleep 1
    s_sub_u32 s27, s27, 1
    s_cbranch_scc1 K2_end
    s_branch Lsw_39
Lsd_40:
Lok_38:
    v_cmp_eq_u32 vcc, 1, v8
    s_cmp_lg_u64 vcc, 0
    s_cselect_b32 s59, 1, 0
    s_getpc_b64 s[28:29]
Lpc_42:
    s_add_u32 s28, s28, K2_B_w0-Lpc_42
    s_addc_u32 s29, s29, 0
    v_lshlrev_b32 v14, 3, v4
    v_mov_b32 v15, s29
    v_add_co_u32 v14, vcc, s28, v14
    s_nop 1
    v_addc_co_u32 v15, vcc, 0, v15, vcc
    s_waitcnt vmcnt(45)
    global_load_dword v13, v[14:15], off
    s_waitcnt vmcnt(16)
    buffer_load_dword v72, v79, s[4:7], s69 offen sc1
    s_waitcnt vmcnt(0)
    s_cmp_lg_u32 s59, 0
    s_mov_b32 s56, 69255168
    s_cselect_b32 s56, 70261760, s56
    s_mov_b32 s34, 32768
    s_cselect_b32 s34, 7168, s34
    s_cselect_b32 s35, -1, 4294836223
    s_add_u32 s57, s56, 4096
    v_cmp_ne_u32 vcc, s48, v72
    s_cbranch_vccz K2_B_fok
Lwf_43:
    buffer_load_dword v72, v79, s[4:7], s69 offen sc1
    s_waitcnt vmcnt(0)
    v_cmp_ne_u32 vcc, s48, v72
    s_cbranch_vccz Lwd_44
    s_sleep 1
    s_sub_u32 s27, s27, 1
    s_cbranch_scc1 K2_end
    s_branch Lwf_43
Lwd_44:
K2_B_fok:
    v_mov_b32 v7, v80
    s_cmp_eq_u32 s24, 1
    s_cbranch_scc1 K2_B_w1
    s_cmp_eq_u32 s24, 2
    s_cbranch_scc1 K2_B_w2
    s_cmp_eq_u32 s24, 3
    s_cbranch_scc1 K2_B_w3
    s_branch K2_B_w0
.p2align 6
K2_B_w0:
    v_mov_b32 v8, -1
    v_mov_b32 v9, -1
    v_mov_b32 v10, -1
    v_mov_b32 v11, -1
    v_mov_b32 v12, -1
    v_mov_b32 v13, -1
    v_mov_b32 v14, -1
    v_mov_b32 v15, -1
    v_mov_b32 v36, 0
    v_mov_b32 v37, 0
    v_mov_b32 v38, 0
    v_mov_b32 v39, 0
    v_mov_b32 v40, 0
    v_mov_b32 v41, 0
    v_mov_b32 v42, 0
    v_mov_b32 v43, 0
    v_mov_b32 v44, 0
    v_mov_b32 v45, 0
    v_mov_b32 v46, 0
    v_mov_b32 v47, 0
    v_mov_b32 v48, 0
    v_mov_b32 v49, 0
    v_mov_b32 v50, 0
    v_mov_b32 v51, 0
    v_mov_b32 v52, 0
    v_mov_b32 v53, 0
    v_mov_b32 v54, 0
    v_mov_b32 v55, 0
    v_mov_b32 v56, 0
    v_mov_b32 v57, 0
    v_mov_b32 v58, 0
    v_mov_b32 v59, 0
    v_mov_b32 v60, 0
    v_mov_b32 v61, 0
    v_mov_b32 v62, 0
    v_mov_b32 v63, 0
    v_mov_b32 v96, 0
    v_mov_b32 v97, 0
    v_mov_b32 v98, 0
    v_mov_b32 v99, 0
    v_mov_b32 v100, 0
    v_mov_b32 v101, 0
    v_mov_b32 v102, 0
    v_mov_b32 v103, 0
Lrp_45:
    buffer_load_dwordx4 v[8:11], v4, s[4:7], s56 offen offset:0 sc1
    buffer_load_dwordx4 v[12:15], v4, s[4:7], s56 offen offset:1024 sc1
    s_sub_u32 s60, s60, 1
    s_addc_u32 s61, s61, 0
    s_waitcnt vmcnt(0)
    v_max3_u32 v16, v8, v9, v10
    v_max3_u32 v20, v11, v12, v13
    v_max3_u32 v16, v16, v14, v15
    v_max_u32 v16, v16, v20
    v_cmp_lt_u32 vcc, s61, v16
    s_cbranch_vccnz Lrp_45
Lrg_46:
    v_smfmac_f32_16x16x64_bf16 v[36:39], v[8:11], a[0:7], v6
    ds_write_b128 v4, v[8:11] offset:0
    v_smfmac_f32_16x16x64_bf16 v[40:43], v[8:11], a[56:63], v6
    ds_write_b128 v4, v[12:15] offset:1024
    v_smfmac_f32_16x16x64_bf16 v[44:47], v[8:11], a[112:119], v6
    v_smfmac_f32_16x16x64_bf16 v[48:51], v[8:11], a[168:175], v6
    s_add_u32 s56, s56, s34
    s_and_b32 s56, s56, s35
    s_add_u32 s57, s56, 4096
    v_smfmac_f32_16x16x64_bf16 v[52:55], v[8:11], a[224:231], v6
    buffer_load_dwordx4 v[64:67], v0, s[4:7], s66 offen sc1
    v_smfmac_f32_16x16x64_bf16 v[56:59], v[8:11], v[144:151], v6
    v_smfmac_f32_16x16x64_bf16 v[60:63], v[8:11], v[200:207], v6
    v_smfmac_f32_16x16x64_bf16 v[36:39], v[12:15], a[8:15], v6
    s_waitcnt lgkmcnt(0)
    s_barrier
    ds_read_b128 v[16:19], v4 offset:2048
    v_smfmac_f32_16x16x64_bf16 v[40:43], v[12:15], a[64:71], v6
    ds_read_b128 v[20:23], v4 offset:3072
    buffer_load_dwordx4 v[72:75], v1, s[4:7], s66 offen offset:256 sc1
    v_smfmac_f32_16x16x64_bf16 v[44:47], v[12:15], a[120:127], v6
    s_add_u32 s66, s66, 28672
    ds_read_b128 v[24:27], v4 offset:4096
    v_smfmac_f32_16x16x64_bf16 v[48:51], v[12:15], a[176:183], v6
    ds_read_b128 v[28:31], v4 offset:5120
    v_smfmac_f32_16x16x64_bf16 v[52:55], v[12:15], a[232:239], v6
    ds_read_b128 v[32:35], v4 offset:6144
    v_smfmac_f32_16x16x64_bf16 v[56:59], v[12:15], v[152:159], v6
    buffer_load_dwordx4 v[68:71], v0, s[4:7], s66 offen sc1
    v_smfmac_f32_16x16x64_bf16 v[60:63], v[12:15], v[208:215], v6
    s_waitcnt lgkmcnt(4)
    v_smfmac_f32_16x16x64_bf16 v[36:39], v[16:19], a[16:23], v6
    s_waitcnt lgkmcnt(3)
    v_smfmac_f32_16x16x64_bf16 v[36:39], v[20:23], a[24:31], v6
    s_waitcnt lgkmcnt(2)
    v_smfmac_f32_16x16x64_bf16 v[36:39], v[24:27], a[32:39], v6
    s_waitcnt lgkmcnt(1)
    buffer_load_dwordx4 v[76:79], v1, s[4:7], s66 offen offset:256 sc1
    v_smfmac_f32_16x16x64_bf16 v[36:39], v[28:31], a[40:47], v6
    s_add_u32 s66, s66, 28672
    s_waitcnt lgkmcnt(0)
    v_smfmac_f32_16x16x64_bf16 v[36:39], v[32:35], a[48:55], v6
    s_nop 0
    v_smfmac_f32_16x16x64_bf16 v[40:43], v[16:19], a[72:79], v6
    s_nop 2
    v_smfmac_f32_16x16x64_bf16 v[40:43], v[20:23], a[80:87], v6
    buffer_load_dwordx4 v[80:83], v0, s[4:7], s66 offen sc1
    v_smfmac_f32_16x16x64_bf16 v[40:43], v[24:27], a[88:95], v6
    v_add_f32 v36, v36, v38
    v_smfmac_f32_16x16x64_bf16 v[40:43], v[28:31], a[96:103], v6
    v_add_f32 v37, v37, v39
    v_smfmac_f32_16x16x64_bf16 v[40:43], v[32:35], a[104:111], v6
    v_cvt_pk_bf16_f32 v36, v36, v37
    v_smfmac_f32_16x16x64_bf16 v[44:47], v[16:19], a[128:135], v6
    buffer_load_dwordx4 v[88:91], v1, s[4:7], s66 offen offset:256 sc1
    ds_write_b32 v118, v36 offset:8192
    v_smfmac_f32_16x16x64_bf16 v[44:47], v[20:23], a[136:143], v6
    s_add_u32 s66, s66, 28672
    s_nop 0
    v_smfmac_f32_16x16x64_bf16 v[44:47], v[24:27], a[144:151], v6
    v_add_f32 v40, v40, v42
    v_smfmac_f32_16x16x64_bf16 v[44:47], v[28:31], a[152:159], v6
    v_add_f32 v41, v41, v43
    v_smfmac_f32_16x16x64_bf16 v[44:47], v[32:35], a[160:167], v6
    buffer_load_dwordx4 v[84:87], v0, s[4:7], s66 offen sc1
    v_cvt_pk_bf16_f32 v40, v40, v41
    v_smfmac_f32_16x16x64_bf16 v[48:51], v[16:19], a[184:191], v6
    ds_write_b32 v118, v40 offset:8448
    v_smfmac_f32_16x16x64_bf16 v[48:51], v[20:23], a[192:199], v6
    s_nop 1
    v_smfmac_f32_16x16x64_bf16 v[48:51], v[24:27], a[200:207], v6
    v_add_f32 v44, v44, v46
    v_smfmac_f32_16x16x64_bf16 v[48:51], v[28:31], a[208:215], v6
    buffer_load_dwordx4 v[92:95], v1, s[4:7], s66 offen offset:256 sc1
    v_add_f32 v45, v45, v47
    v_smfmac_f32_16x16x64_bf16 v[48:51], v[32:35], a[216:223], v6
    s_add_u32 s66, s66, 28672
    v_cvt_pk_bf16_f32 v44, v44, v45
    v_smfmac_f32_16x16x64_bf16 v[52:55], v[16:19], a[240:247], v6
    ds_write_b32 v118, v44 offset:8704
    v_smfmac_f32_16x16x64_bf16 v[52:55], v[20:23], a[248:255], v6
    s_nop 1
    v_smfmac_f32_16x16x64_bf16 v[52:55], v[24:27], v[120:127], v6
    v_add_f32 v48, v48, v50
    v_smfmac_f32_16x16x64_bf16 v[52:55], v[28:31], v[128:135], v6
    v_add_f32 v49, v49, v51
    v_smfmac_f32_16x16x64_bf16 v[52:55], v[32:35], v[136:143], v6
    v_cvt_pk_bf16_f32 v48, v48, v49
    v_smfmac_f32_16x16x64_bf16 v[56:59], v[16:19], v[160:167], v6
    ds_write_b32 v118, v48 offset:8960
    v_smfmac_f32_16x16x64_bf16 v[56:59], v[20:23], v[168:175], v6
    s_add_u32 s66, s66, 344064
    s_nop 1
    v_smfmac_f32_16x16x64_bf16 v[56:59], v[24:27], v[176:183], v6
    v_add_f32 v52, v52, v54
    v_smfmac_f32_16x16x64_bf16 v[56:59], v[28:31], v[184:191], v6
    v_add_f32 v53, v53, v55
    v_smfmac_f32_16x16x64_bf16 v[56:59], v[32:35], v[192:199], v6
    v_cvt_pk_bf16_f32 v52, v52, v53
    v_smfmac_f32_16x16x64_bf16 v[60:63], v[16:19], v[216:223], v6
    ds_write_b32 v118, v52 offset:9216
    v_smfmac_f32_16x16x64_bf16 v[60:63], v[20:23], v[224:231], v6
    s_nop 2
    v_smfmac_f32_16x16x64_bf16 v[60:63], v[24:27], v[232:239], v6
    v_add_f32 v56, v56, v58
    v_smfmac_f32_16x16x64_bf16 v[60:63], v[28:31], v[240:247], v6
    v_add_f32 v57, v57, v59
    v_smfmac_f32_16x16x64_bf16 v[60:63], v[32:35], v[248:255], v6
    v_cvt_pk_bf16_f32 v56, v56, v57
    ds_write_b32 v118, v56 offset:9472
    s_nop 5
    v_add_f32 v60, v60, v62
    v_add_f32 v61, v61, v63
    v_cvt_pk_bf16_f32 v60, v60, v61
    ds_write_b32 v118, v60 offset:9728
    s_waitcnt lgkmcnt(0)
    s_barrier
    ds_read_b128 v[16:19], v119 offset:8192
    ds_read_b128 v[20:23], v119 offset:10240
    ds_read_b128 v[24:27], v119 offset:8448
    ds_read_b128 v[28:31], v119 offset:10496
    s_add_u32 s67, s68, 8192
    v_mov_b32 v104, -1
    v_mov_b32 v105, -1
    v_mov_b32 v106, -1
    v_mov_b32 v107, -1
    v_mov_b32 v108, -1
    v_mov_b32 v109, -1
    v_mov_b32 v110, -1
    v_mov_b32 v111, -1
    v_mov_b32 v112, -1
    v_mov_b32 v113, -1
    v_mov_b32 v114, -1
    v_mov_b32 v115, -1
    s_waitcnt lgkmcnt(0)
    s_sleep 4
Lrp_47:
    buffer_load_dwordx4 v[108:111], v4, s[4:7], s68 offen sc1
    buffer_load_dwordx4 v[112:115], v4, s[4:7], s68 offen offset:1024 sc1
    buffer_load_dwordx4 v[104:107], v4, s[4:7], s67 offen sc1
    s_sub_u32 s60, s60, 1
    s_addc_u32 s61, s61, 0
    s_nop 4
    v_mov_b32 v100, 0
    v_mov_b32 v101, 0
    v_mov_b32 v102, 0
    v_mov_b32 v103, 0
    s_waitcnt vmcnt(0)
    v_max3_u32 v36, v104, v105, v106
    v_max3_u32 v37, v107, v108, v109
    v_max3_u32 v36, v36, v110, v111
    v_max3_u32 v37, v37, v112, v113
    v_max3_u32 v36, v36, v114, v115
    v_max_u32 v36, v36, v37
    v_cmp_lt_u32 vcc, s61, v36
    v_smfmac_f32_16x16x64_bf16 v[100:103], v[108:111], v[72:79], v6
    v_smfmac_f32_16x16x64_bf16 v[100:103], v[112:115], v[88:95], v6
    s_cbranch_vccnz Lrp_47
Lrg_48:
    v_smfmac_f32_16x16x64_bf16 v[100:103], v[104:107], v[24:31], v6
    s_nop 2
    v_smfmac_f32_16x16x64_bf16 v[96:99], v[108:111], v[64:71], v6
    s_nop 2
    v_smfmac_f32_16x16x64_bf16 v[96:99], v[112:115], v[80:87], v6
    v_add_f32 v100, v100, v102
    v_add_f32 v101, v101, v103
    v_smfmac_f32_16x16x64_bf16 v[96:99], v[104:107], v[16:23], v6
    ds_write2st64_b32 v7, v100, v101 offset0:72 offset1:76
    s_mov_b64 vcc, s[64:65]
    s_nop 5
    v_add_f32 v96, v96, v98
    v_add_f32 v97, v97, v99
    s_waitcnt lgkmcnt(0)
    s_barrier
    ds_read_b64 v[40:41], v2 offset:16640
    ds_read_b64 v[42:43], v2 offset:16896
    ds_read_b64 v[44:45], v2 offset:17152
    v_cndmask_b32_dpp v38, v97, v96, vcc quad_perm:[1,0,3,2] row_mask:0xf bank_mask:0xf
    s_not_b64 vcc, vcc
    v_cndmask_b32_dpp v39, v96, v97, vcc quad_perm:[1,0,3,2] row_mask:0xf bank_mask:0xf
    s_waitcnt lgkmcnt(2)
    v_pk_add_f32 v[38:39], v[38:39], v[40:41]
    s_waitcnt lgkmcnt(0)
    v_pk_add_f32 v[42:43], v[42:43], v[44:45]
    v_pk_add_f32 v[38:39], v[38:39], v[42:43]
    v_cvt_pk_bf16_f32 v36, v38, v39
    buffer_store_dword v36, v5, s[4:7], s73 offen
    s_cmp_eq_u32 s59, 0
    s_cbranch_scc1 K2_B_noy0
    buffer_store_dword v36, v5, s[4:7], s74 offen sc1
K2_B_noy0:
    s_barrier
    s_add_u32 s73, s73, 32768
    s_and_b32 s73, s73, 4294836223
    s_add_u32 s68, s68, 32768
    s_and_b32 s68, s68, 4294836223
    s_add_u32 s74, s74, 7168
    s_add_u32 s26, s26, 1
    s_cmp_lt_u32 s26, 63
    s_cbranch_scc1 K2_B_w0
    s_branch K2_end
.p2align 6
K2_B_w1:
    v_mov_b32 v16, -1
    v_mov_b32 v17, -1
    v_mov_b32 v18, -1
    v_mov_b32 v19, -1
    v_mov_b32 v20, -1
    v_mov_b32 v21, -1
    v_mov_b32 v22, -1
    v_mov_b32 v23, -1
    v_mov_b32 v36, 0
    v_mov_b32 v37, 0
    v_mov_b32 v38, 0
    v_mov_b32 v39, 0
    v_mov_b32 v40, 0
    v_mov_b32 v41, 0
    v_mov_b32 v42, 0
    v_mov_b32 v43, 0
    v_mov_b32 v44, 0
    v_mov_b32 v45, 0
    v_mov_b32 v46, 0
    v_mov_b32 v47, 0
    v_mov_b32 v48, 0
    v_mov_b32 v49, 0
    v_mov_b32 v50, 0
    v_mov_b32 v51, 0
    v_mov_b32 v52, 0
    v_mov_b32 v53, 0
    v_mov_b32 v54, 0
    v_mov_b32 v55, 0
    v_mov_b32 v56, 0
    v_mov_b32 v57, 0
    v_mov_b32 v58, 0
    v_mov_b32 v59, 0
    v_mov_b32 v60, 0
    v_mov_b32 v61, 0
    v_mov_b32 v62, 0
    v_mov_b32 v63, 0
    v_mov_b32 v96, 0
    v_mov_b32 v97, 0
    v_mov_b32 v98, 0
    v_mov_b32 v99, 0
    v_mov_b32 v100, 0
    v_mov_b32 v101, 0
    v_mov_b32 v102, 0
    v_mov_b32 v103, 0
Lrp_49:
    buffer_load_dwordx4 v[16:19], v4, s[4:7], s56 offen offset:2048 sc1
    buffer_load_dwordx4 v[20:23], v4, s[4:7], s56 offen offset:3072 sc1
    s_sub_u32 s60, s60, 1
    s_addc_u32 s61, s61, 0
    s_waitcnt vmcnt(0)
    v_max3_u32 v8, v16, v17, v18
    v_max3_u32 v12, v19, v20, v21
    v_max3_u32 v8, v8, v22, v23
    v_max_u32 v8, v8, v12
    v_cmp_lt_u32 vcc, s61, v8
    s_cbranch_vccnz Lrp_49
Lrg_50:
    v_smfmac_f32_16x16x64_bf16 v[36:39], v[16:19], a[16:23], v6
    ds_write_b128 v4, v[16:19] offset:2048
    v_smfmac_f32_16x16x64_bf16 v[40:43], v[16:19], a[72:79], v6
    ds_write_b128 v4, v[20:23] offset:3072
    v_smfmac_f32_16x16x64_bf16 v[44:47], v[16:19], a[128:135], v6
    v_smfmac_f32_16x16x64_bf16 v[48:51], v[16:19], a[184:191], v6
    s_add_u32 s56, s56, s34
    s_and_b32 s56, s56, s35
    s_add_u32 s57, s56, 4096
    v_smfmac_f32_16x16x64_bf16 v[52:55], v[16:19], a[240:247], v6
    v_smfmac_f32_16x16x64_bf16 v[56:59], v[16:19], v[160:167], v6
    buffer_load_dwordx4 v[64:67], v0, s[4:7], s66 offen sc1
    v_smfmac_f32_16x16x64_bf16 v[60:63], v[16:19], v[216:223], v6
    v_smfmac_f32_16x16x64_bf16 v[36:39], v[20:23], a[24:31], v6
    s_waitcnt lgkmcnt(0)
    s_barrier
    ds_read_b128 v[24:27], v4 offset:4096
    v_smfmac_f32_16x16x64_bf16 v[40:43], v[20:23], a[80:87], v6
    ds_read_b128 v[28:31], v4 offset:5120
    v_smfmac_f32_16x16x64_bf16 v[44:47], v[20:23], a[136:143], v6
    ds_read_b128 v[32:35], v4 offset:6144
    buffer_load_dwordx4 v[72:75], v1, s[4:7], s66 offen offset:256 sc1
    v_smfmac_f32_16x16x64_bf16 v[48:51], v[20:23], a[192:199], v6
    s_add_u32 s66, s66, 28672
    ds_read_b128 v[8:11], v4 offset:0
    v_smfmac_f32_16x16x64_bf16 v[52:55], v[20:23], a[248:255], v6
    ds_read_b128 v[12:15], v4 offset:1024
    v_smfmac_f32_16x16x64_bf16 v[56:59], v[20:23], v[168:175], v6
    v_smfmac_f32_16x16x64_bf16 v[60:63], v[20:23], v[224:231], v6
    s_waitcnt lgkmcnt(4)
    buffer_load_dwordx4 v[68:71], v0, s[4:7], s66 offen sc1
    v_smfmac_f32_16x16x64_bf16 v[36:39], v[24:27], a[32:39], v6
    s_waitcnt lgkmcnt(3)
    v_smfmac_f32_16x16x64_bf16 v[36:39], v[28:31], a[40:47], v6
    s_waitcnt lgkmcnt(2)
    v_smfmac_f32_16x16x64_bf16 v[36:39], v[32:35], a[48:55], v6
    s_waitcnt lgkmcnt(1)
    v_smfmac_f32_16x16x64_bf16 v[36:39], v[8:11], a[0:7], v6
    s_waitcnt lgkmcnt(0)
    buffer_load_dwordx4 v[76:79], v1, s[4:7], s66 offen offset:256 sc1
    v_smfmac_f32_16x16x64_bf16 v[36:39], v[12:15], a[8:15], v6
    s_add_u32 s66, s66, 28672
    v_smfmac_f32_16x16x64_bf16 v[40:43], v[24:27], a[88:95], v6
    v_smfmac_f32_16x16x64_bf16 v[40:43], v[28:31], a[96:103], v6
    s_nop 2
    v_smfmac_f32_16x16x64_bf16 v[40:43], v[32:35], a[104:111], v6
    buffer_load_dwordx4 v[80:83], v0, s[4:7], s66 offen sc1
    v_add_f32 v36, v36, v38
    v_smfmac_f32_16x16x64_bf16 v[40:43], v[8:11], a[56:63], v6
    v_add_f32 v37, v37, v39
    v_smfmac_f32_16x16x64_bf16 v[40:43], v[12:15], a[64:71], v6
    v_cvt_pk_bf16_f32 v36, v36, v37
    v_smfmac_f32_16x16x64_bf16 v[44:47], v[24:27], a[144:151], v6
    ds_write_b32 v118, v36 offset:8192
    v_smfmac_f32_16x16x64_bf16 v[44:47], v[28:31], a[152:159], v6
    s_nop 0
    buffer_load_dwordx4 v[88:91], v1, s[4:7], s66 offen offset:256 sc1
    v_smfmac_f32_16x16x64_bf16 v[44:47], v[32:35], a[160:167], v6
    s_add_u32 s66, s66, 28672
    v_add_f32 v40, v40, v42
    v_smfmac_f32_16x16x64_bf16 v[44:47], v[8:11], a[112:119], v6
    v_add_f32 v41, v41, v43
    v_smfmac_f32_16x16x64_bf16 v[44:47], v[12:15], a[120:127], v6
    v_cvt_pk_bf16_f32 v40, v40, v41
    v_smfmac_f32_16x16x64_bf16 v[48:51], v[24:27], a[200:207], v6
    buffer_load_dwordx4 v[84:87], v0, s[4:7], s66 offen sc1
    ds_write_b32 v118, v40 offset:8448
    v_smfmac_f32_16x16x64_bf16 v[48:51], v[28:31], a[208:215], v6
    s_nop 1
    v_smfmac_f32_16x16x64_bf16 v[48:51], v[32:35], a[216:223], v6
    v_add_f32 v44, v44, v46
    v_smfmac_f32_16x16x64_bf16 v[48:51], v[8:11], a[168:175], v6
    v_add_f32 v45, v45, v47
    v_smfmac_f32_16x16x64_bf16 v[48:51], v[12:15], a[176:183], v6
    buffer_load_dwordx4 v[92:95], v1, s[4:7], s66 offen offset:256 sc1
    v_cvt_pk_bf16_f32 v44, v44, v45
    v_smfmac_f32_16x16x64_bf16 v[52:55], v[24:27], v[120:127], v6
    s_add_u32 s66, s66, 28672
    ds_write_b32 v118, v44 offset:8704
    v_smfmac_f32_16x16x64_bf16 v[52:55], v[28:31], v[128:135], v6
    s_nop 0
    v_smfmac_f32_16x16x64_bf16 v[52:55], v[32:35], v[136:143], v6
    v_add_f32 v48, v48, v50
    v_smfmac_f32_16x16x64_bf16 v[52:55], v[8:11], a[224:231], v6
    v_add_f32 v49, v49, v51
    v_smfmac_f32_16x16x64_bf16 v[52:55], v[12:15], a[232:239], v6
    v_cvt_pk_bf16_f32 v48, v48, v49
    v_smfmac_f32_16x16x64_bf16 v[56:59], v[24:27], v[176:183], v6
    ds_write_b32 v118, v48 offset:8960
    v_smfmac_f32_16x16x64_bf16 v[56:59], v[28:31], v[184:191], v6
    s_add_u32 s66, s66, 344064
    s_nop 1
    v_smfmac_f32_16x16x64_bf16 v[56:59], v[32:35], v[192:199], v6
    v_add_f32 v52, v52, v54
    v_smfmac_f32_16x16x64_bf16 v[56:59], v[8:11], v[144:151], v6
    v_add_f32 v53, v53, v55
    v_smfmac_f32_16x16x64_bf16 v[56:59], v[12:15], v[152:159], v6
    v_cvt_pk_bf16_f32 v52, v52, v53
    v_smfmac_f32_16x16x64_bf16 v[60:63], v[24:27], v[232:239], v6
    s_nop 0
    ds_write_b32 v118, v52 offset:9216
    v_smfmac_f32_16x16x64_bf16 v[60:63], v[28:31], v[240:247], v6
    s_xor_b32 s28, s73, 65536
    buffer_store_dwordx2 v[116:117], v3, s[4:7], s28 offen
    v_smfmac_f32_16x16x64_bf16 v[60:63], v[32:35], v[248:255], v6
    v_add_f32 v56, v56, v58
    v_smfmac_f32_16x16x64_bf16 v[60:63], v[8:11], v[200:207], v6
    v_add_f32 v57, v57, v59
    v_smfmac_f32_16x16x64_bf16 v[60:63], v[12:15], v[208:215], v6
    v_cvt_pk_bf16_f32 v56, v56, v57
    ds_write_b32 v118, v56 offset:9472
    s_nop 5
    v_add_f32 v60, v60, v62
    v_add_f32 v61, v61, v63
    v_cvt_pk_bf16_f32 v60, v60, v61
    ds_write_b32 v118, v60 offset:9728
    s_waitcnt lgkmcnt(0)
    s_barrier
    v_mov_b32 v108, -1
    v_mov_b32 v109, -1
    v_mov_b32 v110, -1
    v_mov_b32 v111, -1
    v_mov_b32 v112, -1
    v_mov_b32 v113, -1
    v_mov_b32 v114, -1
    v_mov_b32 v115, -1
    s_waitcnt lgkmcnt(0)
    s_sleep 4
Lrp_51:
    buffer_load_dwordx4 v[108:111], v4, s[4:7], s68 offen sc1
    buffer_load_dwordx4 v[112:115], v4, s[4:7], s68 offen offset:1024 sc1
    s_sub_u32 s60, s60, 1
    s_addc_u32 s61, s61, 0
    s_nop 4
    v_mov_b32 v100, 0
    v_mov_b32 v101, 0
    v_mov_b32 v102, 0
    v_mov_b32 v103, 0
    s_waitcnt vmcnt(0)
    v_max3_u32 v36, v108, v109, v110
    v_max3_u32 v37, v111, v112, v113
    v_max3_u32 v36, v36, v114, v115
    v_max_u32 v36, v36, v37
    v_cmp_lt_u32 vcc, s61, v36
    v_smfmac_f32_16x16x64_bf16 v[100:103], v[108:111], v[72:79], v6
    v_smfmac_f32_16x16x64_bf16 v[100:103], v[112:115], v[88:95], v6
    s_cbranch_vccnz Lrp_51
Lrg_52:
    v_smfmac_f32_16x16x64_bf16 v[96:99], v[108:111], v[64:71], v6
    s_nop 2
    v_smfmac_f32_16x16x64_bf16 v[96:99], v[112:115], v[80:87], v6
    s_nop 1
    v_add_f32 v100, v100, v102
    v_add_f32 v101, v101, v103
    ds_write2st64_b32 v7, v100, v101 offset0:73 offset1:77
    s_nop 2
    v_add_f32 v96, v96, v98
    v_add_f32 v97, v97, v99
    ds_write2st64_b32 v7, v96, v97 offset0:65 offset1:69
    s_waitcnt lgkmcnt(0)
    s_barrier
K2_B_noy1:
    s_barrier
    s_add_u32 s73, s73, 32768
    s_and_b32 s73, s73, 4294836223
    s_add_u32 s68, s68, 32768
    s_and_b32 s68, s68, 4294836223
    s_add_u32 s74, s74, 7168
    s_add_u32 s26, s26, 1
    s_cmp_lt_u32 s26, 63
    s_cbranch_scc1 K2_B_w1
    s_branch K2_end
.p2align 6
K2_B_w2:
    v_mov_b32 v24, -1
    v_mov_b32 v25, -1
    v_mov_b32 v26, -1
    v_mov_b32 v27, -1
    v_mov_b32 v28, -1
    v_mov_b32 v29, -1
    v_mov_b32 v30, -1
    v_mov_b32 v31, -1
    v_mov_b32 v36, 0
    v_mov_b32 v37, 0
    v_mov_b32 v38, 0
    v_mov_b32 v39, 0
    v_mov_b32 v40, 0
    v_mov_b32 v41, 0
    v_mov_b32 v42, 0
    v_mov_b32 v43, 0
    v_mov_b32 v44, 0
    v_mov_b32 v45, 0
    v_mov_b32 v46, 0
    v_mov_b32 v47, 0
    v_mov_b32 v48, 0
    v_mov_b32 v49, 0
    v_mov_b32 v50, 0
    v_mov_b32 v51, 0
    v_mov_b32 v52, 0
    v_mov_b32 v53, 0
    v_mov_b32 v54, 0
    v_mov_b32 v55, 0
    v_mov_b32 v56, 0
    v_mov_b32 v57, 0
    v_mov_b32 v58, 0
    v_mov_b32 v59, 0
    v_mov_b32 v60, 0
    v_mov_b32 v61, 0
    v_mov_b32 v62, 0
    v_mov_b32 v63, 0
    v_mov_b32 v96, 0
    v_mov_b32 v97, 0
    v_mov_b32 v98, 0
    v_mov_b32 v99, 0
    v_mov_b32 v100, 0
    v_mov_b32 v101, 0
    v_mov_b32 v102, 0
    v_mov_b32 v103, 0
Lrp_53:
    buffer_load_dwordx4 v[24:27], v4, s[4:7], s57 offen offset:0 sc1
    buffer_load_dwordx4 v[28:31], v4, s[4:7], s57 offen offset:1024 sc1
    s_sub_u32 s60, s60, 1
    s_addc_u32 s61, s61, 0
    s_waitcnt vmcnt(0)
    v_max3_u32 v8, v24, v25, v26
    v_max3_u32 v12, v27, v28, v29
    v_max3_u32 v8, v8, v30, v31
    v_max_u32 v8, v8, v12
    v_cmp_lt_u32 vcc, s61, v8
    s_cbranch_vccnz Lrp_53
Lrg_54:
    v_smfmac_f32_16x16x64_bf16 v[36:39], v[24:27], a[32:39], v6
    ds_write_b128 v4, v[24:27] offset:4096
    v_smfmac_f32_16x16x64_bf16 v[40:43], v[24:27], a[88:95], v6
    ds_write_b128 v4, v[28:31] offset:5120
    v_smfmac_f32_16x16x64_bf16 v[44:47], v[24:27], a[144:151], v6
    v_smfmac_f32_16x16x64_bf16 v[48:51], v[24:27], a[200:207], v6
    s_add_u32 s56, s56, s34
    s_and_b32 s56, s56, s35
    s_add_u32 s57, s56, 4096
    v_smfmac_f32_16x16x64_bf16 v[52:55], v[24:27], v[120:127], v6
    v_smfmac_f32_16x16x64_bf16 v[56:59], v[24:27], v[176:183], v6
    v_smfmac_f32_16x16x64_bf16 v[60:63], v[24:27], v[232:239], v6
    buffer_load_dwordx4 v[64:67], v0, s[4:7], s66 offen sc1
    v_smfmac_f32_16x16x64_bf16 v[36:39], v[28:31], a[40:47], v6
    s_waitcnt lgkmcnt(0)
    s_barrier
    ds_read_b128 v[32:35], v4 offset:6144
    v_smfmac_f32_16x16x64_bf16 v[40:43], v[28:31], a[96:103], v6
    ds_read_b128 v[8:11], v4 offset:0
    v_smfmac_f32_16x16x64_bf16 v[44:47], v[28:31], a[152:159], v6
    ds_read_b128 v[12:15], v4 offset:1024
    v_smfmac_f32_16x16x64_bf16 v[48:51], v[28:31], a[208:215], v6
    ds_read_b128 v[16:19], v4 offset:2048
    buffer_load_dwordx4 v[72:75], v1, s[4:7], s66 offen offset:256 sc1
    v_smfmac_f32_16x16x64_bf16 v[52:55], v[28:31], v[128:135], v6
    s_add_u32 s66, s66, 28672
    ds_read_b128 v[20:23], v4 offset:3072
    v_smfmac_f32_16x16x64_bf16 v[56:59], v[28:31], v[184:191], v6
    v_smfmac_f32_16x16x64_bf16 v[60:63], v[28:31], v[240:247], v6
    s_waitcnt lgkmcnt(4)
    v_smfmac_f32_16x16x64_bf16 v[36:39], v[32:35], a[48:55], v6
    s_waitcnt lgkmcnt(3)
    buffer_load_dwordx4 v[68:71], v0, s[4:7], s66 offen sc1
    v_smfmac_f32_16x16x64_bf16 v[36:39], v[8:11], a[0:7], v6
    s_waitcnt lgkmcnt(2)
    v_smfmac_f32_16x16x64_bf16 v[36:39], v[12:15], a[8:15], v6
    s_waitcnt lgkmcnt(1)
    v_smfmac_f32_16x16x64_bf16 v[36:39], v[16:19], a[16:23], v6
    s_waitcnt lgkmcnt(0)
    v_smfmac_f32_16x16x64_bf16 v[36:39], v[20:23], a[24:31], v6
    buffer_load_dwordx4 v[76:79], v1, s[4:7], s66 offen offset:256 sc1
    v_smfmac_f32_16x16x64_bf16 v[40:43], v[32:35], a[104:111], v6
    s_add_u32 s66, s66, 28672
    v_smfmac_f32_16x16x64_bf16 v[40:43], v[8:11], a[56:63], v6
    s_nop 2
    v_smfmac_f32_16x16x64_bf16 v[40:43], v[12:15], a[64:71], v6
    v_add_f32 v36, v36, v38
    v_smfmac_f32_16x16x64_bf16 v[40:43], v[16:19], a[72:79], v6
    buffer_load_dwordx4 v[80:83], v0, s[4:7], s66 offen sc1
    v_add_f32 v37, v37, v39
    v_smfmac_f32_16x16x64_bf16 v[40:43], v[20:23], a[80:87], v6
    v_cvt_pk_bf16_f32 v36, v36, v37
    v_smfmac_f32_16x16x64_bf16 v[44:47], v[32:35], a[160:167], v6
    ds_write_b32 v118, v36 offset:8192
    v_smfmac_f32_16x16x64_bf16 v[44:47], v[8:11], a[112:119], v6
    s_nop 1
    v_smfmac_f32_16x16x64_bf16 v[44:47], v[12:15], a[120:127], v6
    buffer_load_dwordx4 v[88:91], v1, s[4:7], s66 offen offset:256 sc1
    v_add_f32 v40, v40, v42
    v_smfmac_f32_16x16x64_bf16 v[44:47], v[16:19], a[128:135], v6
    s_add_u32 s66, s66, 28672
    v_add_f32 v41, v41, v43
    v_smfmac_f32_16x16x64_bf16 v[44:47], v[20:23], a[136:143], v6
    v_cvt_pk_bf16_f32 v40, v40, v41
    v_smfmac_f32_16x16x64_bf16 v[48:51], v[32:35], a[216:223], v6
    ds_write_b32 v118, v40 offset:8448
    v_smfmac_f32_16x16x64_bf16 v[48:51], v[8:11], a[168:175], v6
    s_nop 1
    buffer_load_dwordx4 v[84:87], v0, s[4:7], s66 offen sc1
    v_smfmac_f32_16x16x64_bf16 v[48:51], v[12:15], a[176:183], v6
    v_add_f32 v44, v44, v46
    v_smfmac_f32_16x16x64_bf16 v[48:51], v[16:19], a[184:191], v6
    v_add_f32 v45, v45, v47
    v_smfmac_f32_16x16x64_bf16 v[48:51], v[20:23], a[192:199], v6
    v_cvt_pk_bf16_f32 v44, v44, v45
    v_smfmac_f32_16x16x64_bf16 v[52:55], v[32:35], v[136:143], v6
    buffer_load_dwordx4 v[92:95], v1, s[4:7], s66 offen offset:256 sc1
    ds_write_b32 v118, v44 offset:8704
    v_smfmac_f32_16x16x64_bf16 v[52:55], v[8:11], a[224:231], v6
    s_add_u32 s66, s66, 28672
    s_nop 0
    v_smfmac_f32_16x16x64_bf16 v[52:55], v[12:15], a[232:239], v6
    v_add_f32 v48, v48, v50
    v_smfmac_f32_16x16x64_bf16 v[52:55], v[16:19], a[240:247], v6
    v_add_f32 v49, v49, v51
    v_smfmac_f32_16x16x64_bf16 v[52:55], v[20:23], a[248:255], v6
    v_cvt_pk_bf16_f32 v48, v48, v49
    v_smfmac_f32_16x16x64_bf16 v[56:59], v[32:35], v[192:199], v6
    ds_write_b32 v118, v48 offset:8960
    v_smfmac_f32_16x16x64_bf16 v[56:59], v[8:11], v[144:151], v6
    s_add_u32 s66, s66, 344064
    s_nop 1
    v_smfmac_f32_16x16x64_bf16 v[56:59], v[12:15], v[152:159], v6
    v_add_f32 v52, v52, v54
    v_smfmac_f32_16x16x64_bf16 v[56:59], v[16:19], v[160:167], v6
    v_add_f32 v53, v53, v55
    v_smfmac_f32_16x16x64_bf16 v[56:59], v[20:23], v[168:175], v6
    v_cvt_pk_bf16_f32 v52, v52, v53
    v_smfmac_f32_16x16x64_bf16 v[60:63], v[32:35], v[248:255], v6
    ds_write_b32 v118, v52 offset:9216
    v_smfmac_f32_16x16x64_bf16 v[60:63], v[8:11], v[200:207], v6
    s_nop 2
    v_smfmac_f32_16x16x64_bf16 v[60:63], v[12:15], v[208:215], v6
    v_add_f32 v56, v56, v58
    v_smfmac_f32_16x16x64_bf16 v[60:63], v[16:19], v[216:223], v6
    v_add_f32 v57, v57, v59
    v_smfmac_f32_16x16x64_bf16 v[60:63], v[20:23], v[224:231], v6
    v_cvt_pk_bf16_f32 v56, v56, v57
    ds_write_b32 v118, v56 offset:9472
    s_nop 5
    v_add_f32 v60, v60, v62
    v_add_f32 v61, v61, v63
    v_cvt_pk_bf16_f32 v60, v60, v61
    ds_write_b32 v118, v60 offset:9728
    s_waitcnt lgkmcnt(0)
    s_barrier
    ds_read_b128 v[8:11], v119 offset:8192
    ds_read_b128 v[12:15], v119 offset:10240
    ds_read_b128 v[16:19], v119 offset:8448
    ds_read_b128 v[20:23], v119 offset:10496
    s_add_u32 s67, s68, 5120
    v_mov_b32 v104, -1
    v_mov_b32 v105, -1
    v_mov_b32 v106, -1
    v_mov_b32 v107, -1
    v_mov_b32 v108, -1
    v_mov_b32 v109, -1
    v_mov_b32 v110, -1
    v_mov_b32 v111, -1
    v_mov_b32 v112, -1
    v_mov_b32 v113, -1
    v_mov_b32 v114, -1
    v_mov_b32 v115, -1
    s_waitcnt lgkmcnt(0)
    s_sleep 4
Lrp_55:
    buffer_load_dwordx4 v[108:111], v4, s[4:7], s68 offen sc1
    buffer_load_dwordx4 v[112:115], v4, s[4:7], s68 offen offset:1024 sc1
    buffer_load_dwordx4 v[104:107], v4, s[4:7], s67 offen sc1
    s_sub_u32 s60, s60, 1
    s_addc_u32 s61, s61, 0
    s_nop 4
    v_mov_b32 v96, 0
    v_mov_b32 v97, 0
    v_mov_b32 v98, 0
    v_mov_b32 v99, 0
    s_waitcnt vmcnt(0)
    v_max3_u32 v36, v104, v105, v106
    v_max3_u32 v37, v107, v108, v109
    v_max3_u32 v36, v36, v110, v111
    v_max3_u32 v37, v37, v112, v113
    v_max3_u32 v36, v36, v114, v115
    v_max_u32 v36, v36, v37
    v_cmp_lt_u32 vcc, s61, v36
    v_smfmac_f32_16x16x64_bf16 v[96:99], v[108:111], v[64:71], v6
    v_smfmac_f32_16x16x64_bf16 v[96:99], v[112:115], v[80:87], v6
    s_cbranch_vccnz Lrp_55
Lrg_56:
    v_smfmac_f32_16x16x64_bf16 v[96:99], v[104:107], v[8:15], v6
    s_nop 2
    v_smfmac_f32_16x16x64_bf16 v[100:103], v[108:111], v[72:79], v6
    s_nop 2
    v_smfmac_f32_16x16x64_bf16 v[100:103], v[112:115], v[88:95], v6
    v_add_f32 v96, v96, v98
    v_add_f32 v97, v97, v99
    v_smfmac_f32_16x16x64_bf16 v[100:103], v[104:107], v[16:23], v6
    ds_write2st64_b32 v7, v96, v97 offset0:66 offset1:70
    s_mov_b64 vcc, s[64:65]
    s_nop 5
    v_add_f32 v100, v100, v102
    v_add_f32 v101, v101, v103
    s_waitcnt lgkmcnt(0)
    s_barrier
    ds_read_b64 v[40:41], v2 offset:18432
    ds_read_b64 v[42:43], v2 offset:18688
    ds_read_b64 v[44:45], v2 offset:19200
    v_cndmask_b32_dpp v38, v101, v100, vcc quad_perm:[1,0,3,2] row_mask:0xf bank_mask:0xf
    s_not_b64 vcc, vcc
    v_cndmask_b32_dpp v39, v100, v101, vcc quad_perm:[1,0,3,2] row_mask:0xf bank_mask:0xf
    s_waitcnt lgkmcnt(2)
    v_pk_add_f32 v[38:39], v[38:39], v[40:41]
    s_waitcnt lgkmcnt(0)
    v_pk_add_f32 v[42:43], v[42:43], v[44:45]
    v_pk_add_f32 v[38:39], v[38:39], v[42:43]
    v_cvt_pk_bf16_f32 v36, v38, v39
    buffer_store_dword v36, v5, s[4:7], s73 offen
    s_cmp_eq_u32 s59, 0
    s_cbranch_scc1 K2_B_noy2
    buffer_store_dword v36, v5, s[4:7], s74 offen sc1
K2_B_noy2:
    s_barrier
    s_add_u32 s73, s73, 32768
    s_and_b32 s73, s73, 4294836223
    s_add_u32 s68, s68, 32768
    s_and_b32 s68, s68, 4294836223
    s_add_u32 s74, s74, 7168
    s_add_u32 s26, s26, 1
    s_cmp_lt_u32 s26, 63
    s_cbranch_scc1 K2_B_w2
    s_branch K2_end
.p2align 6
K2_B_w3:
    v_mov_b32 v32, -1
    v_mov_b32 v33, -1
    v_mov_b32 v34, -1
    v_mov_b32 v35, -1
    v_mov_b32 v8, -1
    v_mov_b32 v9, -1
    v_mov_b32 v10, -1
    v_mov_b32 v11, -1
    v_mov_b32 v36, 0
    v_mov_b32 v37, 0
    v_mov_b32 v38, 0
    v_mov_b32 v39, 0
    v_mov_b32 v40, 0
    v_mov_b32 v41, 0
    v_mov_b32 v42, 0
    v_mov_b32 v43, 0
    v_mov_b32 v44, 0
    v_mov_b32 v45, 0
    v_mov_b32 v46, 0
    v_mov_b32 v47, 0
    v_mov_b32 v48, 0
    v_mov_b32 v49, 0
    v_mov_b32 v50, 0
    v_mov_b32 v51, 0
    v_mov_b32 v52, 0
    v_mov_b32 v53, 0
    v_mov_b32 v54, 0
    v_mov_b32 v55, 0
    v_mov_b32 v56, 0
    v_mov_b32 v57, 0
    v_mov_b32 v58, 0
    v_mov_b32 v59, 0
    v_mov_b32 v60, 0
    v_mov_b32 v61, 0
    v_mov_b32 v62, 0
    v_mov_b32 v63, 0
    v_mov_b32 v96, 0
    v_mov_b32 v97, 0
    v_mov_b32 v98, 0
    v_mov_b32 v99, 0
    v_mov_b32 v100, 0
    v_mov_b32 v101, 0
    v_mov_b32 v102, 0
    v_mov_b32 v103, 0
Lrp_57:
    buffer_load_dwordx4 v[32:35], v4, s[4:7], s57 offen offset:2048 sc1
    buffer_load_dwordx4 v[8:11], v4, s[4:7], s56 offen offset:0 sc1
    s_sub_u32 s60, s60, 1
    s_addc_u32 s61, s61, 0
    s_waitcnt vmcnt(0)
    v_max3_u32 v12, v32, v33, v34
    v_max3_u32 v16, v35, v8, v9
    v_max3_u32 v12, v12, v10, v11
    v_max_u32 v12, v12, v16
    v_cmp_lt_u32 vcc, s61, v12
    s_cbranch_vccnz Lrp_57
Lrg_58:
    v_smfmac_f32_16x16x64_bf16 v[36:39], v[32:35], a[48:55], v6
    ds_write_b128 v4, v[32:35] offset:6144
    v_smfmac_f32_16x16x64_bf16 v[40:43], v[32:35], a[104:111], v6
    v_smfmac_f32_16x16x64_bf16 v[44:47], v[32:35], a[160:167], v6
    v_smfmac_f32_16x16x64_bf16 v[48:51], v[32:35], a[216:223], v6
    s_add_u32 s56, s56, s34
    s_and_b32 s56, s56, s35
    s_add_u32 s57, s56, 4096
    v_smfmac_f32_16x16x64_bf16 v[52:55], v[32:35], v[136:143], v6
    v_smfmac_f32_16x16x64_bf16 v[56:59], v[32:35], v[192:199], v6
    v_smfmac_f32_16x16x64_bf16 v[60:63], v[32:35], v[248:255], v6
    v_smfmac_f32_16x16x64_bf16 v[36:39], v[8:11], a[0:7], v6
    s_waitcnt lgkmcnt(0)
    s_barrier
    ds_read_b128 v[12:15], v4 offset:1024
    buffer_load_dwordx4 v[64:67], v0, s[4:7], s66 offen sc1
    v_smfmac_f32_16x16x64_bf16 v[40:43], v[8:11], a[56:63], v6
    ds_read_b128 v[16:19], v4 offset:2048
    v_smfmac_f32_16x16x64_bf16 v[44:47], v[8:11], a[112:119], v6
    ds_read_b128 v[20:23], v4 offset:3072
    v_smfmac_f32_16x16x64_bf16 v[48:51], v[8:11], a[168:175], v6
    ds_read_b128 v[24:27], v4 offset:4096
    v_smfmac_f32_16x16x64_bf16 v[52:55], v[8:11], a[224:231], v6
    ds_read_b128 v[28:31], v4 offset:5120
    buffer_load_dwordx4 v[72:75], v1, s[4:7], s66 offen offset:256 sc1
    v_smfmac_f32_16x16x64_bf16 v[56:59], v[8:11], v[144:151], v6
    s_add_u32 s66, s66, 28672
    v_smfmac_f32_16x16x64_bf16 v[60:63], v[8:11], v[200:207], v6
    s_waitcnt lgkmcnt(4)
    v_smfmac_f32_16x16x64_bf16 v[36:39], v[12:15], a[8:15], v6
    s_waitcnt lgkmcnt(3)
    v_smfmac_f32_16x16x64_bf16 v[36:39], v[16:19], a[16:23], v6
    s_waitcnt lgkmcnt(2)
    buffer_load_dwordx4 v[68:71], v0, s[4:7], s66 offen sc1
    v_smfmac_f32_16x16x64_bf16 v[36:39], v[20:23], a[24:31], v6
    s_waitcnt lgkmcnt(1)
    v_smfmac_f32_16x16x64_bf16 v[36:39], v[24:27], a[32:39], v6
    s_waitcnt lgkmcnt(0)
    v_smfmac_f32_16x16x64_bf16 v[36:39], v[28:31], a[40:47], v6
    s_nop 2
    v_smfmac_f32_16x16x64_bf16 v[40:43], v[12:15], a[64:71], v6
    buffer_load_dwordx4 v[76:79], v1, s[4:7], s66 offen offset:256 sc1
    v_smfmac_f32_16x16x64_bf16 v[40:43], v[16:19], a[72:79], v6
    s_add_u32 s66, s66, 28672
    v_smfmac_f32_16x16x64_bf16 v[40:43], v[20:23], a[80:87], v6
    v_add_f32 v36, v36, v38
    v_smfmac_f32_16x16x64_bf16 v[40:43], v[24:27], a[88:95], v6
    v_add_f32 v37, v37, v39
    v_smfmac_f32_16x16x64_bf16 v[40:43], v[28:31], a[96:103], v6
    buffer_load_dwordx4 v[80:83], v0, s[4:7], s66 offen sc1
    v_cvt_pk_bf16_f32 v36, v36, v37
    v_smfmac_f32_16x16x64_bf16 v[44:47], v[12:15], a[120:127], v6
    ds_write_b32 v118, v36 offset:8192
    v_smfmac_f32_16x16x64_bf16 v[44:47], v[16:19], a[128:135], v6
    s_nop 1
    v_smfmac_f32_16x16x64_bf16 v[44:47], v[20:23], a[136:143], v6
    v_add_f32 v40, v40, v42
    v_smfmac_f32_16x16x64_bf16 v[44:47], v[24:27], a[144:151], v6
    buffer_load_dwordx4 v[88:91], v1, s[4:7], s66 offen offset:256 sc1
    v_add_f32 v41, v41, v43
    v_smfmac_f32_16x16x64_bf16 v[44:47], v[28:31], a[152:159], v6
    s_add_u32 s66, s66, 28672
    v_cvt_pk_bf16_f32 v40, v40, v41
    v_smfmac_f32_16x16x64_bf16 v[48:51], v[12:15], a[176:183], v6
    ds_write_b32 v118, v40 offset:8448
    v_smfmac_f32_16x16x64_bf16 v[48:51], v[16:19], a[184:191], v6
    s_nop 0
    v_smfmac_f32_16x16x64_bf16 v[48:51], v[20:23], a[192:199], v6
    buffer_load_dwordx4 v[84:87], v0, s[4:7], s66 offen sc1
    v_add_f32 v44, v44, v46
    v_smfmac_f32_16x16x64_bf16 v[48:51], v[24:27], a[200:207], v6
    v_add_f32 v45, v45, v47
    v_smfmac_f32_16x16x64_bf16 v[48:51], v[28:31], a[208:215], v6
    v_cvt_pk_bf16_f32 v44, v44, v45
    v_smfmac_f32_16x16x64_bf16 v[52:55], v[12:15], a[232:239], v6
    ds_write_b32 v118, v44 offset:8704
    v_smfmac_f32_16x16x64_bf16 v[52:55], v[16:19], a[240:247], v6
    s_nop 0
    buffer_load_dwordx4 v[92:95], v1, s[4:7], s66 offen offset:256 sc1
    v_smfmac_f32_16x16x64_bf16 v[52:55], v[20:23], a[248:255], v6
    s_add_u32 s66, s66, 28672
    v_add_f32 v48, v48, v50
    v_smfmac_f32_16x16x64_bf16 v[52:55], v[24:27], v[120:127], v6
    v_add_f32 v49, v49, v51
    v_smfmac_f32_16x16x64_bf16 v[52:55], v[28:31], v[128:135], v6
    v_cvt_pk_bf16_f32 v48, v48, v49
    v_smfmac_f32_16x16x64_bf16 v[56:59], v[12:15], v[152:159], v6
    ds_write_b32 v118, v48 offset:8960
    v_smfmac_f32_16x16x64_bf16 v[56:59], v[16:19], v[160:167], v6
    s_add_u32 s66, s66, 344064
    s_nop 1
    v_smfmac_f32_16x16x64_bf16 v[56:59], v[20:23], v[168:175], v6
    v_add_f32 v52, v52, v54
    v_smfmac_f32_16x16x64_bf16 v[56:59], v[24:27], v[176:183], v6
    v_add_f32 v53, v53, v55
    v_smfmac_f32_16x16x64_bf16 v[56:59], v[28:31], v[184:191], v6
    v_cvt_pk_bf16_f32 v52, v52, v53
    v_smfmac_f32_16x16x64_bf16 v[60:63], v[12:15], v[208:215], v6
    ds_write_b32 v118, v52 offset:9216
    v_smfmac_f32_16x16x64_bf16 v[60:63], v[16:19], v[216:223], v6
    s_nop 2
    v_smfmac_f32_16x16x64_bf16 v[60:63], v[20:23], v[224:231], v6
    v_add_f32 v56, v56, v58
    v_smfmac_f32_16x16x64_bf16 v[60:63], v[24:27], v[232:239], v6
    v_add_f32 v57, v57, v59
    v_smfmac_f32_16x16x64_bf16 v[60:63], v[28:31], v[240:247], v6
    v_cvt_pk_bf16_f32 v56, v56, v57
    ds_write_b32 v118, v56 offset:9472
    s_nop 5
    v_add_f32 v60, v60, v62
    v_add_f32 v61, v61, v63
    v_cvt_pk_bf16_f32 v60, v60, v61
    ds_write_b32 v118, v60 offset:9728
    s_waitcnt lgkmcnt(0)
    s_barrier
    v_mov_b32 v108, -1
    v_mov_b32 v109, -1
    v_mov_b32 v110, -1
    v_mov_b32 v111, -1
    v_mov_b32 v112, -1
    v_mov_b32 v113, -1
    v_mov_b32 v114, -1
    v_mov_b32 v115, -1
    s_waitcnt lgkmcnt(0)
    s_sleep 4
Lrp_59:
    buffer_load_dwordx4 v[108:111], v4, s[4:7], s68 offen sc1
    buffer_load_dwordx4 v[112:115], v4, s[4:7], s68 offen offset:1024 sc1
    s_sub_u32 s60, s60, 1
    s_addc_u32 s61, s61, 0
    s_nop 4
    v_mov_b32 v96, 0
    v_mov_b32 v97, 0
    v_mov_b32 v98, 0
    v_mov_b32 v99, 0
    s_waitcnt vmcnt(0)
    v_max3_u32 v36, v108, v109, v110
    v_max3_u32 v37, v111, v112, v113
    v_max3_u32 v36, v36, v114, v115
    v_max_u32 v36, v36, v37
    v_cmp_lt_u32 vcc, s61, v36
    v_smfmac_f32_16x16x64_bf16 v[96:99], v[108:111], v[64:71], v6
    v_smfmac_f32_16x16x64_bf16 v[96:99], v[112:115], v[80:87], v6
    s_cbranch_vccnz Lrp_59
Lrg_60:
    v_smfmac_f32_16x16x64_bf16 v[100:103], v[108:111], v[72:79], v6
    s_nop 2
    v_smfmac_f32_16x16x64_bf16 v[100:103], v[112:115], v[88:95], v6
    s_nop 1
    v_add_f32 v96, v96, v98
    v_add_f32 v97, v97, v99
    ds_write2st64_b32 v7, v96, v97 offset0:67 offset1:71
    s_nop 2
    v_add_f32 v100, v100, v102
    v_add_f32 v101, v101, v103
    ds_write2st64_b32 v7, v100, v101 offset0:75 offset1:79
    s_waitcnt lgkmcnt(0)
    s_barrier
K2_B_noy3:
    s_barrier
    s_add_u32 s73, s73, 32768
    s_and_b32 s73, s73, 4294836223
    s_add_u32 s68, s68, 32768
    s_and_b32 s68, s68, 4294836223
    s_add_u32 s74, s74, 7168
    s_add_u32 s26, s26, 1
    s_cmp_lt_u32 s26, 63
    s_cbranch_scc1 K2_B_w3
    s_branch K2_end
.p2align 6
K2_V:
    s_add_u32 s50, s30, 16
    s_lshr_b32 s28, s50, 2
    s_xor_b32 s28, s28, 4
    s_and_b32 s29, s50, 3
    s_lshl_b32 s29, s29, 3
    s_or_b32 s28, s28, s29
    s_lshl_b32 s28, s28, 7
    v_and_b32 v12, 1, v1
    v_lshlrev_b32 v12, 12, v12
    v_add_u32 v12, s28, v12
    s_cmp_lg_u32 s24, 0
    s_cbranch_scc1 Lmw_61
Lsw_62:
    buffer_load_dwordx4 v[8:11], v12, s[4:7], s49 offen sc1
Lse_64:
    s_waitcnt vmcnt(0)
    v_xor_b32 v8, s48, v8
    v_xor_b32 v9, s48, v9
    v_xor_b32 v10, s48, v10
    v_xor_b32 v11, s48, v11
    v_or3_b32 v8, v8, v9, v10
    v_or_b32 v8, v8, v11
    v_cmp_lt_u32 vcc, 1, v8
    s_cbranch_vccz Lsd_63
    s_sleep 1
    s_sub_u32 s27, s27, 1
    s_cbranch_scc1 K2_end
    s_branch Lsw_62
Lsd_63:
Lmw_61:
    s_barrier
    s_mul_i32 s50, s50, 401408
    s_mul_i32 s51, s24, 1792
    s_add_u32 s50, s50, s51
    s_add_u32 s50, s50, 2097152
    v_mul_u32_u24 v7, 7168, v3
    v_lshl_add_u32 v6, v2, 4, v7
    v_mov_b32 v116, 0
    v_mov_b32 v117, s48
    s_mov_b32 s26, s31
    v_lshlrev_b32 v12, 7, v1
    buffer_load_dwordx4 a[0:3], v6, s[4:7], s50 offen offset:0
    buffer_load_dwordx4 a[56:59], v6, s[4:7], s50 offen offset:256
    buffer_load_dwordx4 a[112:115], v6, s[4:7], s50 offen offset:512
    buffer_load_dwordx4 a[168:171], v6, s[4:7], s50 offen offset:768
    buffer_load_dwordx4 a[224:227], v6, s[4:7], s50 offen offset:1024
    buffer_load_dwordx4 v[144:147], v6, s[4:7], s50 offen offset:1280
    buffer_load_dwordx4 v[200:203], v6, s[4:7], s50 offen offset:1536
    s_add_u32 s50, s50, 28672
    buffer_load_dwordx4 a[4:7], v6, s[4:7], s50 offen offset:0
    buffer_load_dwordx4 a[60:63], v6, s[4:7], s50 offen offset:256
    buffer_load_dwordx4 a[116:119], v6, s[4:7], s50 offen offset:512
    buffer_load_dwordx4 a[172:175], v6, s[4:7], s50 offen offset:768
    buffer_load_dwordx4 a[228:231], v6, s[4:7], s50 offen offset:1024
    buffer_load_dwordx4 v[148:151], v6, s[4:7], s50 offen offset:1280
    buffer_load_dwordx4 v[204:207], v6, s[4:7], s50 offen offset:1536
    s_add_u32 s50, s50, 28672
    buffer_load_dwordx4 a[8:11], v6, s[4:7], s50 offen offset:0
    buffer_load_dwordx4 a[64:67], v6, s[4:7], s50 offen offset:256
    buffer_load_dwordx4 a[120:123], v6, s[4:7], s50 offen offset:512
    buffer_load_dwordx4 a[176:179], v6, s[4:7], s50 offen offset:768
    buffer_load_dwordx4 a[232:235], v6, s[4:7], s50 offen offset:1024
    buffer_load_dwordx4 v[152:155], v6, s[4:7], s50 offen offset:1280
    buffer_load_dwordx4 v[208:211], v6, s[4:7], s50 offen offset:1536
    s_add_u32 s50, s50, 28672
    buffer_load_dwordx4 a[12:15], v6, s[4:7], s50 offen offset:0
    buffer_load_dwordx4 a[68:71], v6, s[4:7], s50 offen offset:256
    buffer_load_dwordx4 a[124:127], v6, s[4:7], s50 offen offset:512
    buffer_load_dwordx4 a[180:183], v6, s[4:7], s50 offen offset:768
    buffer_load_dwordx4 a[236:239], v6, s[4:7], s50 offen offset:1024
    buffer_load_dwordx4 v[156:159], v6, s[4:7], s50 offen offset:1280
    buffer_load_dwordx4 v[212:215], v6, s[4:7], s50 offen offset:1536
    s_add_u32 s50, s50, 28672
    buffer_load_dwordx4 a[16:19], v6, s[4:7], s50 offen offset:0
    buffer_load_dwordx4 a[72:75], v6, s[4:7], s50 offen offset:256
    buffer_load_dwordx4 a[128:131], v6, s[4:7], s50 offen offset:512
    buffer_load_dwordx4 a[184:187], v6, s[4:7], s50 offen offset:768
    buffer_load_dwordx4 a[240:243], v6, s[4:7], s50 offen offset:1024
    buffer_load_dwordx4 v[160:163], v6, s[4:7], s50 offen offset:1280
    buffer_load_dwordx4 v[216:219], v6, s[4:7], s50 offen offset:1536
    s_add_u32 s50, s50, 28672
    buffer_load_dwordx4 a[20:23], v6, s[4:7], s50 offen offset:0
    buffer_load_dwordx4 a[76:79], v6, s[4:7], s50 offen offset:256
    buffer_load_dwordx4 a[132:135], v6, s[4:7], s50 offen offset:512
    buffer_load_dwordx4 a[188:191], v6, s[4:7], s50 offen offset:768
    buffer_load_dwordx4 a[244:247], v6, s[4:7], s50 offen offset:1024
    buffer_load_dwordx4 v[164:167], v6, s[4:7], s50 offen offset:1280
    buffer_load_dwordx4 v[220:223], v6, s[4:7], s50 offen offset:1536
    s_add_u32 s50, s50, 28672
    buffer_load_dwordx4 a[24:27], v6, s[4:7], s50 offen offset:0
    buffer_load_dwordx4 a[80:83], v6, s[4:7], s50 offen offset:256
    buffer_load_dwordx4 a[136:139], v6, s[4:7], s50 offen offset:512
    buffer_load_dwordx4 a[192:195], v6, s[4:7], s50 offen offset:768
    buffer_load_dwordx4 a[248:251], v6, s[4:7], s50 offen offset:1024
    buffer_load_dwordx4 v[168:171], v6, s[4:7], s50 offen offset:1280
    buffer_load_dwordx4 v[224:227], v6, s[4:7], s50 offen offset:1536
    s_add_u32 s50, s50, 28672
    buffer_load_dwordx4 a[28:31], v6, s[4:7], s50 offen offset:0
    buffer_load_dwordx4 a[84:87], v6, s[4:7], s50 offen offset:256
    buffer_load_dwordx4 a[140:143], v6, s[4:7], s50 offen offset:512
    buffer_load_dwordx4 a[196:199], v6, s[4:7], s50 offen offset:768
    buffer_load_dwordx4 a[252:255], v6, s[4:7], s50 offen offset:1024
    buffer_load_dwordx4 v[172:175], v6, s[4:7], s50 offen offset:1280
    buffer_load_dwordx4 v[228:231], v6, s[4:7], s50 offen offset:1536
    s_add_u32 s50, s50, 28672
    buffer_load_dwordx4 a[32:35], v6, s[4:7], s50 offen offset:0
    buffer_load_dwordx4 a[88:91], v6, s[4:7], s50 offen offset:256
    buffer_load_dwordx4 a[144:147], v6, s[4:7], s50 offen offset:512
    buffer_load_dwordx4 a[200:203], v6, s[4:7], s50 offen offset:768
    buffer_load_dwordx4 v[120:123], v6, s[4:7], s50 offen offset:1024
    buffer_load_dwordx4 v[176:179], v6, s[4:7], s50 offen offset:1280
    buffer_load_dwordx4 v[232:235], v6, s[4:7], s50 offen offset:1536
    s_add_u32 s50, s50, 28672
    buffer_load_dwordx4 a[36:39], v6, s[4:7], s50 offen offset:0
    buffer_load_dwordx4 a[92:95], v6, s[4:7], s50 offen offset:256
    buffer_load_dwordx4 a[148:151], v6, s[4:7], s50 offen offset:512
    buffer_load_dwordx4 a[204:207], v6, s[4:7], s50 offen offset:768
    buffer_load_dwordx4 v[124:127], v6, s[4:7], s50 offen offset:1024
    buffer_load_dwordx4 v[180:183], v6, s[4:7], s50 offen offset:1280
    buffer_load_dwordx4 v[236:239], v6, s[4:7], s50 offen offset:1536
    s_add_u32 s50, s50, 28672
    buffer_load_dwordx4 a[40:43], v6, s[4:7], s50 offen offset:0
    buffer_load_dwordx4 a[96:99], v6, s[4:7], s50 offen offset:256
    buffer_load_dwordx4 a[152:155], v6, s[4:7], s50 offen offset:512
    buffer_load_dwordx4 a[208:211], v6, s[4:7], s50 offen offset:768
    buffer_load_dwordx4 v[128:131], v6, s[4:7], s50 offen offset:1024
    buffer_load_dwordx4 v[184:187], v6, s[4:7], s50 offen offset:1280
    buffer_load_dwordx4 v[240:243], v6, s[4:7], s50 offen offset:1536
    s_add_u32 s50, s50, 28672
    buffer_load_dwordx4 a[44:47], v6, s[4:7], s50 offen offset:0
    buffer_load_dwordx4 a[100:103], v6, s[4:7], s50 offen offset:256
    buffer_load_dwordx4 a[156:159], v6, s[4:7], s50 offen offset:512
    buffer_load_dwordx4 a[212:215], v6, s[4:7], s50 offen offset:768
    buffer_load_dwordx4 v[132:135], v6, s[4:7], s50 offen offset:1024
    buffer_load_dwordx4 v[188:191], v6, s[4:7], s50 offen offset:1280
    buffer_load_dwordx4 v[244:247], v6, s[4:7], s50 offen offset:1536
    s_add_u32 s50, s50, 28672
    buffer_load_dwordx4 a[48:51], v6, s[4:7], s50 offen offset:0
    buffer_load_dwordx4 a[104:107], v6, s[4:7], s50 offen offset:256
    buffer_load_dwordx4 a[160:163], v6, s[4:7], s50 offen offset:512
    buffer_load_dwordx4 a[216:219], v6, s[4:7], s50 offen offset:768
    buffer_load_dwordx4 v[136:139], v6, s[4:7], s50 offen offset:1024
    buffer_load_dwordx4 v[192:195], v6, s[4:7], s50 offen offset:1280
    buffer_load_dwordx4 v[248:251], v6, s[4:7], s50 offen offset:1536
    s_add_u32 s50, s50, 28672
    buffer_load_dwordx4 a[52:55], v6, s[4:7], s50 offen offset:0
    buffer_load_dwordx4 a[108:111], v6, s[4:7], s50 offen offset:256
    buffer_load_dwordx4 a[164:167], v6, s[4:7], s50 offen offset:512
    buffer_load_dwordx4 a[220:223], v6, s[4:7], s50 offen offset:768
    buffer_load_dwordx4 v[140:143], v6, s[4:7], s50 offen offset:1024
    buffer_load_dwordx4 v[196:199], v6, s[4:7], s50 offen offset:1280
    buffer_load_dwordx4 v[252:255], v6, s[4:7], s50 offen offset:1536
    s_add_u32 s50, s50, 28672
Lsw_65:
    buffer_load_dwordx4 v[8:11], v12, s[4:7], s49 offen sc1
Lse_67:
    s_waitcnt vmcnt(0)
    v_xor_b32 v8, s48, v8
    v_xor_b32 v9, s48, v9
    v_xor_b32 v10, s48, v10
    v_xor_b32 v11, s48, v11
    v_or3_b32 v8, v8, v9, v10
    v_or_b32 v8, v8, v11
    v_cmp_lt_u32 vcc, 1, v8
    s_cbranch_vccz Lsd_66
    s_sleep 1
    s_sub_u32 s27, s27, 1
    s_cbranch_scc1 K2_end
    s_branch Lsw_65
Lsd_66:
    v_cmp_eq_u32 vcc, 1, v8
    s_cmp_lg_u64 vcc, 0
    s_cselect_b32 s59, 1, 0
    s_mov_b32 s60, 1
    s_mov_b32 s26, 0
    s_cmp_eq_u32 s31, 4
    s_cbranch_scc1 K2_Z0
K2_V_ret:
    s_mov_b32 s26, s31
    v_mul_u32_u24 v7, 7168, v3
    v_lshl_add_u32 v6, v2, 4, v7
    s_mov_b32 s38, 0
    s_mov_b32 s39, 0
    s_mul_i32 s36, s26, 28672
    s_mul_i32 s37, s24, 7168
    s_add_u32 s36, s36, s37
    s_add_u32 m0, s38, s37
    s_nop 0
    buffer_load_dwordx4 v4, s[4:7], s36 offen offset:0 lds
    buffer_load_dwordx4 v4, s[4:7], s36 offen offset:1024 lds
    buffer_load_dwordx4 v4, s[4:7], s36 offen offset:2048 lds
    buffer_load_dwordx4 v4, s[4:7], s36 offen offset:3072 lds
    s_add_u32 s36, s36, 4096
    s_add_u32 m0, m0, 4096
    s_nop 0
    buffer_load_dwordx4 v4, s[4:7], s36 offen offset:0 lds
    buffer_load_dwordx4 v4, s[4:7], s36 offen offset:1024 lds
    buffer_load_dwordx4 v4, s[4:7], s36 offen offset:2048 lds
    s_waitcnt vmcnt(0)
    s_branch K2_V_go
K2_V_loop:
    s_waitcnt vmcnt(7)
K2_V_go:
    s_barrier
    v_add_u32 v5, s38, v4
    s_xor_b32 s38, s38, 28672
    s_add_u32 s61, s26, 5
    s_min_u32 s61, s61, 63
    s_cmp_eq_u32 s26, 64
    s_cselect_b32 s61, 0, s61
    s_mul_i32 s36, s61, 28672
    s_mul_i32 s37, s24, 7168
    s_add_u32 s36, s36, s37
    s_add_u32 m0, s38, s37
    s_nop 0
    buffer_load_dwordx4 v4, s[4:7], s36 offen offset:0 lds
    buffer_load_dwordx4 v4, s[4:7], s36 offen offset:1024 lds
    buffer_load_dwordx4 v4, s[4:7], s36 offen offset:2048 lds
    buffer_load_dwordx4 v4, s[4:7], s36 offen offset:3072 lds
    s_add_u32 s36, s36, 4096
    s_add_u32 m0, m0, 4096
    s_nop 0
    buffer_load_dwordx4 v4, s[4:7], s36 offen offset:0 lds
    buffer_load_dwordx4 v4, s[4:7], s36 offen offset:1024 lds
    buffer_load_dwordx4 v4, s[4:7], s36 offen offset:2048 lds
    ds_read_b128 v[64:67], v5 offset:0
    ds_read_b128 v[68:71], v5 offset:14336
    ds_read_b128 v[72:75], v5 offset:1024
    ds_read_b128 v[76:79], v5 offset:15360
    s_waitcnt lgkmcnt(2)
    v_mfma_f32_16x16x32_bf16 v[8:11], v[64:67], a[0:3], 0
    v_mfma_f32_16x16x32_bf16 v[12:15], v[68:71], a[0:3], 0
    v_mfma_f32_16x16x32_bf16 v[16:19], v[64:67], a[56:59], 0
    v_mfma_f32_16x16x32_bf16 v[20:23], v[68:71], a[56:59], 0
    v_mfma_f32_16x16x32_bf16 v[24:27], v[64:67], a[112:115], 0
    v_mfma_f32_16x16x32_bf16 v[28:31], v[68:71], a[112:115], 0
    v_mfma_f32_16x16x32_bf16 v[32:35], v[64:67], a[168:171], 0
    v_mfma_f32_16x16x32_bf16 v[36:39], v[68:71], a[168:171], 0
    v_mfma_f32_16x16x32_bf16 v[40:43], v[64:67], a[224:227], 0
    v_mfma_f32_16x16x32_bf16 v[44:47], v[68:71], a[224:227], 0
    v_mfma_f32_16x16x32_bf16 v[48:51], v[64:67], v[144:147], 0
    v_mfma_f32_16x16x32_bf16 v[52:55], v[68:71], v[144:147], 0
    v_mfma_f32_16x16x32_bf16 v[56:59], v[64:67], v[200:203], 0
    v_mfma_f32_16x16x32_bf16 v[60:63], v[68:71], v[200:203], 0
    ds_read_b128 v[64:67], v5 offset:2048
    ds_read_b128 v[68:71], v5 offset:16384
    s_waitcnt lgkmcnt(2)
    v_mfma_f32_16x16x32_bf16 v[8:11], v[72:75], a[4:7], v[8:11]
    v_mfma_f32_16x16x32_bf16 v[12:15], v[76:79], a[4:7], v[12:15]
    v_mfma_f32_16x16x32_bf16 v[16:19], v[72:75], a[60:63], v[16:19]
    v_mfma_f32_16x16x32_bf16 v[20:23], v[76:79], a[60:63], v[20:23]
    v_mfma_f32_16x16x32_bf16 v[24:27], v[72:75], a[116:119], v[24:27]
    v_mfma_f32_16x16x32_bf16 v[28:31], v[76:79], a[116:119], v[28:31]
    v_mfma_f32_16x16x32_bf16 v[32:35], v[72:75], a[172:175], v[32:35]
    v_mfma_f32_16x16x32_bf16 v[36:39], v[76:79], a[172:175], v[36:39]
    v_mfma_f32_16x16x32_bf16 v[40:43], v[72:75], a[228:231], v[40:43]
    v_mfma_f32_16x16x32_bf16 v[44:47], v[76:79], a[228:231], v[44:47]
    v_mfma_f32_16x16x32_bf16 v[48:51], v[72:75], v[148:151], v[48:51]
    v_mfma_f32_16x16x32_bf16 v[52:55], v[76:79], v[148:151], v[52:55]
    v_mfma_f32_16x16x32_bf16 v[56:59], v[72:75], v[204:207], v[56:59]
    v_mfma_f32_16x16x32_bf16 v[60:63], v[76:79], v[204:207], v[60:63]
    ds_read_b128 v[72:75], v5 offset:3072
    ds_read_b128 v[76:79], v5 offset:17408
    s_waitcnt lgkmcnt(2)
    v_mfma_f32_16x16x32_bf16 v[8:11], v[64:67], a[8:11], v[8:11]
    v_mfma_f32_16x16x32_bf16 v[12:15], v[68:71], a[8:11], v[12:15]
    v_mfma_f32_16x16x32_bf16 v[16:19], v[64:67], a[64:67], v[16:19]
    v_mfma_f32_16x16x32_bf16 v[20:23], v[68:71], a[64:67], v[20:23]
    v_mfma_f32_16x16x32_bf16 v[24:27], v[64:67], a[120:123], v[24:27]
    v_mfma_f32_16x16x32_bf16 v[28:31], v[68:71], a[120:123], v[28:31]
    v_mfma_f32_16x16x32_bf16 v[32:35], v[64:67], a[176:179], v[32:35]
    v_mfma_f32_16x16x32_bf16 v[36:39], v[68:71], a[176:179], v[36:39]
    v_mfma_f32_16x16x32_bf16 v[40:43], v[64:67], a[232:235], v[40:43]
    v_mfma_f32_16x16x32_bf16 v[44:47], v[68:71], a[232:235], v[44:47]
    v_mfma_f32_16x16x32_bf16 v[48:51], v[64:67], v[152:155], v[48:51]
    v_mfma_f32_16x16x32_bf16 v[52:55], v[68:71], v[152:155], v[52:55]
    v_mfma_f32_16x16x32_bf16 v[56:59], v[64:67], v[208:211], v[56:59]
    v_mfma_f32_16x16x32_bf16 v[60:63], v[68:71], v[208:211], v[60:63]
    ds_read_b128 v[64:67], v5 offset:4096
    ds_read_b128 v[68:71], v5 offset:18432
    s_waitcnt lgkmcnt(2)
    v_mfma_f32_16x16x32_bf16 v[8:11], v[72:75], a[12:15], v[8:11]
    v_mfma_f32_16x16x32_bf16 v[12:15], v[76:79], a[12:15], v[12:15]
    v_mfma_f32_16x16x32_bf16 v[16:19], v[72:75], a[68:71], v[16:19]
    v_mfma_f32_16x16x32_bf16 v[20:23], v[76:79], a[68:71], v[20:23]
    v_mfma_f32_16x16x32_bf16 v[24:27], v[72:75], a[124:127], v[24:27]
    v_mfma_f32_16x16x32_bf16 v[28:31], v[76:79], a[124:127], v[28:31]
    v_mfma_f32_16x16x32_bf16 v[32:35], v[72:75], a[180:183], v[32:35]
    v_mfma_f32_16x16x32_bf16 v[36:39], v[76:79], a[180:183], v[36:39]
    v_mfma_f32_16x16x32_bf16 v[40:43], v[72:75], a[236:239], v[40:43]
    v_mfma_f32_16x16x32_bf16 v[44:47], v[76:79], a[236:239], v[44:47]
    v_mfma_f32_16x16x32_bf16 v[48:51], v[72:75], v[156:159], v[48:51]
    v_mfma_f32_16x16x32_bf16 v[52:55], v[76:79], v[156:159], v[52:55]
    v_mfma_f32_16x16x32_bf16 v[56:59], v[72:75], v[212:215], v[56:59]
    v_mfma_f32_16x16x32_bf16 v[60:63], v[76:79], v[212:215], v[60:63]
    ds_read_b128 v[72:75], v5 offset:5120
    ds_read_b128 v[76:79], v5 offset:19456
    s_waitcnt lgkmcnt(2)
    v_mfma_f32_16x16x32_bf16 v[8:11], v[64:67], a[16:19], v[8:11]
    v_mfma_f32_16x16x32_bf16 v[12:15], v[68:71], a[16:19], v[12:15]
    v_mfma_f32_16x16x32_bf16 v[16:19], v[64:67], a[72:75], v[16:19]
    v_mfma_f32_16x16x32_bf16 v[20:23], v[68:71], a[72:75], v[20:23]
    v_mfma_f32_16x16x32_bf16 v[24:27], v[64:67], a[128:131], v[24:27]
    v_mfma_f32_16x16x32_bf16 v[28:31], v[68:71], a[128:131], v[28:31]
    v_mfma_f32_16x16x32_bf16 v[32:35], v[64:67], a[184:187], v[32:35]
    v_mfma_f32_16x16x32_bf16 v[36:39], v[68:71], a[184:187], v[36:39]
    v_mfma_f32_16x16x32_bf16 v[40:43], v[64:67], a[240:243], v[40:43]
    v_mfma_f32_16x16x32_bf16 v[44:47], v[68:71], a[240:243], v[44:47]
    v_mfma_f32_16x16x32_bf16 v[48:51], v[64:67], v[160:163], v[48:51]
    v_mfma_f32_16x16x32_bf16 v[52:55], v[68:71], v[160:163], v[52:55]
    v_mfma_f32_16x16x32_bf16 v[56:59], v[64:67], v[216:219], v[56:59]
    v_mfma_f32_16x16x32_bf16 v[60:63], v[68:71], v[216:219], v[60:63]
    ds_read_b128 v[64:67], v5 offset:6144
    ds_read_b128 v[68:71], v5 offset:20480
    s_waitcnt lgkmcnt(2)
    v_mfma_f32_16x16x32_bf16 v[8:11], v[72:75], a[20:23], v[8:11]
    v_mfma_f32_16x16x32_bf16 v[12:15], v[76:79], a[20:23], v[12:15]
    v_mfma_f32_16x16x32_bf16 v[16:19], v[72:75], a[76:79], v[16:19]
    v_mfma_f32_16x16x32_bf16 v[20:23], v[76:79], a[76:79], v[20:23]
    v_mfma_f32_16x16x32_bf16 v[24:27], v[72:75], a[132:135], v[24:27]
    v_mfma_f32_16x16x32_bf16 v[28:31], v[76:79], a[132:135], v[28:31]
    v_mfma_f32_16x16x32_bf16 v[32:35], v[72:75], a[188:191], v[32:35]
    v_mfma_f32_16x16x32_bf16 v[36:39], v[76:79], a[188:191], v[36:39]
    v_mfma_f32_16x16x32_bf16 v[40:43], v[72:75], a[244:247], v[40:43]
    v_mfma_f32_16x16x32_bf16 v[44:47], v[76:79], a[244:247], v[44:47]
    v_mfma_f32_16x16x32_bf16 v[48:51], v[72:75], v[164:167], v[48:51]
    v_mfma_f32_16x16x32_bf16 v[52:55], v[76:79], v[164:167], v[52:55]
    v_mfma_f32_16x16x32_bf16 v[56:59], v[72:75], v[220:223], v[56:59]
    v_mfma_f32_16x16x32_bf16 v[60:63], v[76:79], v[220:223], v[60:63]
    ds_read_b128 v[72:75], v5 offset:7168
    ds_read_b128 v[76:79], v5 offset:21504
    s_waitcnt lgkmcnt(2)
    v_mfma_f32_16x16x32_bf16 v[8:11], v[64:67], a[24:27], v[8:11]
    v_mfma_f32_16x16x32_bf16 v[12:15], v[68:71], a[24:27], v[12:15]
    v_mfma_f32_16x16x32_bf16 v[16:19], v[64:67], a[80:83], v[16:19]
    v_mfma_f32_16x16x32_bf16 v[20:23], v[68:71], a[80:83], v[20:23]
    v_mfma_f32_16x16x32_bf16 v[24:27], v[64:67], a[136:139], v[24:27]
    v_mfma_f32_16x16x32_bf16 v[28:31], v[68:71], a[136:139], v[28:31]
    v_mfma_f32_16x16x32_bf16 v[32:35], v[64:67], a[192:195], v[32:35]
    v_mfma_f32_16x16x32_bf16 v[36:39], v[68:71], a[192:195], v[36:39]
    v_mfma_f32_16x16x32_bf16 v[40:43], v[64:67], a[248:251], v[40:43]
    v_mfma_f32_16x16x32_bf16 v[44:47], v[68:71], a[248:251], v[44:47]
    v_mfma_f32_16x16x32_bf16 v[48:51], v[64:67], v[168:171], v[48:51]
    v_mfma_f32_16x16x32_bf16 v[52:55], v[68:71], v[168:171], v[52:55]
    v_mfma_f32_16x16x32_bf16 v[56:59], v[64:67], v[224:227], v[56:59]
    v_mfma_f32_16x16x32_bf16 v[60:63], v[68:71], v[224:227], v[60:63]
    s_cmp_eq_u32 s39, 0
    s_cbranch_scc1 Lpf_69
    s_waitcnt vmcnt(7)
    s_mov_b64 exec, 1
    buffer_store_dword v117, v116, s[4:7], s39 offen sc1
    s_mov_b64 exec, -1
Lpf_69:
    ds_read_b128 v[64:67], v5 offset:8192
    ds_read_b128 v[68:71], v5 offset:22528
    s_waitcnt lgkmcnt(2)
    v_mfma_f32_16x16x32_bf16 v[8:11], v[72:75], a[28:31], v[8:11]
    v_mfma_f32_16x16x32_bf16 v[12:15], v[76:79], a[28:31], v[12:15]
    v_mfma_f32_16x16x32_bf16 v[16:19], v[72:75], a[84:87], v[16:19]
    v_mfma_f32_16x16x32_bf16 v[20:23], v[76:79], a[84:87], v[20:23]
    v_mfma_f32_16x16x32_bf16 v[24:27], v[72:75], a[140:143], v[24:27]
    v_mfma_f32_16x16x32_bf16 v[28:31], v[76:79], a[140:143], v[28:31]
    v_mfma_f32_16x16x32_bf16 v[32:35], v[72:75], a[196:199], v[32:35]
    v_mfma_f32_16x16x32_bf16 v[36:39], v[76:79], a[196:199], v[36:39]
    v_mfma_f32_16x16x32_bf16 v[40:43], v[72:75], a[252:255], v[40:43]
    v_mfma_f32_16x16x32_bf16 v[44:47], v[76:79], a[252:255], v[44:47]
    v_mfma_f32_16x16x32_bf16 v[48:51], v[72:75], v[172:175], v[48:51]
    v_mfma_f32_16x16x32_bf16 v[52:55], v[76:79], v[172:175], v[52:55]
    v_mfma_f32_16x16x32_bf16 v[56:59], v[72:75], v[228:231], v[56:59]
    v_mfma_f32_16x16x32_bf16 v[60:63], v[76:79], v[228:231], v[60:63]
    ds_read_b128 v[72:75], v5 offset:9216
    ds_read_b128 v[76:79], v5 offset:23552
    s_waitcnt lgkmcnt(2)
    v_mfma_f32_16x16x32_bf16 v[8:11], v[64:67], a[32:35], v[8:11]
    v_mfma_f32_16x16x32_bf16 v[12:15], v[68:71], a[32:35], v[12:15]
    v_mfma_f32_16x16x32_bf16 v[16:19], v[64:67], a[88:91], v[16:19]
    v_mfma_f32_16x16x32_bf16 v[20:23], v[68:71], a[88:91], v[20:23]
    v_mfma_f32_16x16x32_bf16 v[24:27], v[64:67], a[144:147], v[24:27]
    v_mfma_f32_16x16x32_bf16 v[28:31], v[68:71], a[144:147], v[28:31]
    v_mfma_f32_16x16x32_bf16 v[32:35], v[64:67], a[200:203], v[32:35]
    v_mfma_f32_16x16x32_bf16 v[36:39], v[68:71], a[200:203], v[36:39]
    v_mfma_f32_16x16x32_bf16 v[40:43], v[64:67], v[120:123], v[40:43]
    v_mfma_f32_16x16x32_bf16 v[44:47], v[68:71], v[120:123], v[44:47]
    v_mfma_f32_16x16x32_bf16 v[48:51], v[64:67], v[176:179], v[48:51]
    v_mfma_f32_16x16x32_bf16 v[52:55], v[68:71], v[176:179], v[52:55]
    v_mfma_f32_16x16x32_bf16 v[56:59], v[64:67], v[232:235], v[56:59]
    v_mfma_f32_16x16x32_bf16 v[60:63], v[68:71], v[232:235], v[60:63]
    ds_read_b128 v[64:67], v5 offset:10240
    ds_read_b128 v[68:71], v5 offset:24576
    s_waitcnt lgkmcnt(2)
    v_mfma_f32_16x16x32_bf16 v[8:11], v[72:75], a[36:39], v[8:11]
    v_mfma_f32_16x16x32_bf16 v[12:15], v[76:79], a[36:39], v[12:15]
    v_mfma_f32_16x16x32_bf16 v[16:19], v[72:75], a[92:95], v[16:19]
    v_mfma_f32_16x16x32_bf16 v[20:23], v[76:79], a[92:95], v[20:23]
    v_mfma_f32_16x16x32_bf16 v[24:27], v[72:75], a[148:151], v[24:27]
    v_mfma_f32_16x16x32_bf16 v[28:31], v[76:79], a[148:151], v[28:31]
    v_mfma_f32_16x16x32_bf16 v[32:35], v[72:75], a[204:207], v[32:35]
    v_mfma_f32_16x16x32_bf16 v[36:39], v[76:79], a[204:207], v[36:39]
    v_mfma_f32_16x16x32_bf16 v[40:43], v[72:75], v[124:127], v[40:43]
    v_mfma_f32_16x16x32_bf16 v[44:47], v[76:79], v[124:127], v[44:47]
    v_mfma_f32_16x16x32_bf16 v[48:51], v[72:75], v[180:183], v[48:51]
    v_mfma_f32_16x16x32_bf16 v[52:55], v[76:79], v[180:183], v[52:55]
    v_mfma_f32_16x16x32_bf16 v[56:59], v[72:75], v[236:239], v[56:59]
    v_mfma_f32_16x16x32_bf16 v[60:63], v[76:79], v[236:239], v[60:63]
    ds_read_b128 v[72:75], v5 offset:11264
    ds_read_b128 v[76:79], v5 offset:25600
    s_waitcnt lgkmcnt(2)
    v_mfma_f32_16x16x32_bf16 v[8:11], v[64:67], a[40:43], v[8:11]
    v_mfma_f32_16x16x32_bf16 v[12:15], v[68:71], a[40:43], v[12:15]
    v_mfma_f32_16x16x32_bf16 v[16:19], v[64:67], a[96:99], v[16:19]
    v_mfma_f32_16x16x32_bf16 v[20:23], v[68:71], a[96:99], v[20:23]
    v_mfma_f32_16x16x32_bf16 v[24:27], v[64:67], a[152:155], v[24:27]
    v_mfma_f32_16x16x32_bf16 v[28:31], v[68:71], a[152:155], v[28:31]
    v_mfma_f32_16x16x32_bf16 v[32:35], v[64:67], a[208:211], v[32:35]
    v_mfma_f32_16x16x32_bf16 v[36:39], v[68:71], a[208:211], v[36:39]
    v_mfma_f32_16x16x32_bf16 v[40:43], v[64:67], v[128:131], v[40:43]
    v_mfma_f32_16x16x32_bf16 v[44:47], v[68:71], v[128:131], v[44:47]
    v_mfma_f32_16x16x32_bf16 v[48:51], v[64:67], v[184:187], v[48:51]
    v_mfma_f32_16x16x32_bf16 v[52:55], v[68:71], v[184:187], v[52:55]
    v_mfma_f32_16x16x32_bf16 v[56:59], v[64:67], v[240:243], v[56:59]
    v_mfma_f32_16x16x32_bf16 v[60:63], v[68:71], v[240:243], v[60:63]
    ds_read_b128 v[64:67], v5 offset:12288
    ds_read_b128 v[68:71], v5 offset:26624
    s_waitcnt lgkmcnt(2)
    v_mfma_f32_16x16x32_bf16 v[8:11], v[72:75], a[44:47], v[8:11]
    v_mfma_f32_16x16x32_bf16 v[12:15], v[76:79], a[44:47], v[12:15]
    v_mfma_f32_16x16x32_bf16 v[16:19], v[72:75], a[100:103], v[16:19]
    v_mfma_f32_16x16x32_bf16 v[20:23], v[76:79], a[100:103], v[20:23]
    v_mfma_f32_16x16x32_bf16 v[24:27], v[72:75], a[156:159], v[24:27]
    v_mfma_f32_16x16x32_bf16 v[28:31], v[76:79], a[156:159], v[28:31]
    v_mfma_f32_16x16x32_bf16 v[32:35], v[72:75], a[212:215], v[32:35]
    v_mfma_f32_16x16x32_bf16 v[36:39], v[76:79], a[212:215], v[36:39]
    v_mfma_f32_16x16x32_bf16 v[40:43], v[72:75], v[132:135], v[40:43]
    v_mfma_f32_16x16x32_bf16 v[44:47], v[76:79], v[132:135], v[44:47]
    v_mfma_f32_16x16x32_bf16 v[48:51], v[72:75], v[188:191], v[48:51]
    v_mfma_f32_16x16x32_bf16 v[52:55], v[76:79], v[188:191], v[52:55]
    v_mfma_f32_16x16x32_bf16 v[56:59], v[72:75], v[244:247], v[56:59]
    v_mfma_f32_16x16x32_bf16 v[60:63], v[76:79], v[244:247], v[60:63]
    ds_read_b128 v[72:75], v5 offset:13312
    ds_read_b128 v[76:79], v5 offset:27648
    s_waitcnt lgkmcnt(2)
    v_mfma_f32_16x16x32_bf16 v[8:11], v[64:67], a[48:51], v[8:11]
    v_mfma_f32_16x16x32_bf16 v[12:15], v[68:71], a[48:51], v[12:15]
    v_mfma_f32_16x16x32_bf16 v[16:19], v[64:67], a[104:107], v[16:19]
    v_mfma_f32_16x16x32_bf16 v[20:23], v[68:71], a[104:107], v[20:23]
    v_mfma_f32_16x16x32_bf16 v[24:27], v[64:67], a[160:163], v[24:27]
    v_mfma_f32_16x16x32_bf16 v[28:31], v[68:71], a[160:163], v[28:31]
    v_mfma_f32_16x16x32_bf16 v[32:35], v[64:67], a[216:219], v[32:35]
    v_mfma_f32_16x16x32_bf16 v[36:39], v[68:71], a[216:219], v[36:39]
    v_mfma_f32_16x16x32_bf16 v[40:43], v[64:67], v[136:139], v[40:43]
    v_mfma_f32_16x16x32_bf16 v[44:47], v[68:71], v[136:139], v[44:47]
    v_mfma_f32_16x16x32_bf16 v[48:51], v[64:67], v[192:195], v[48:51]
    v_mfma_f32_16x16x32_bf16 v[52:55], v[68:71], v[192:195], v[52:55]
    v_mfma_f32_16x16x32_bf16 v[56:59], v[64:67], v[248:251], v[56:59]
    v_mfma_f32_16x16x32_bf16 v[60:63], v[68:71], v[248:251], v[60:63]
    s_waitcnt lgkmcnt(0)
    v_mfma_f32_16x16x32_bf16 v[8:11], v[72:75], a[52:55], v[8:11]
    v_mfma_f32_16x16x32_bf16 v[12:15], v[76:79], a[52:55], v[12:15]
    v_mfma_f32_16x16x32_bf16 v[16:19], v[72:75], a[108:111], v[16:19]
    v_mfma_f32_16x16x32_bf16 v[20:23], v[76:79], a[108:111], v[20:23]
    v_mfma_f32_16x16x32_bf16 v[24:27], v[72:75], a[164:167], v[24:27]
    v_mfma_f32_16x16x32_bf16 v[28:31], v[76:79], a[164:167], v[28:31]
    v_mfma_f32_16x16x32_bf16 v[32:35], v[72:75], a[220:223], v[32:35]
    v_mfma_f32_16x16x32_bf16 v[36:39], v[76:79], a[220:223], v[36:39]
    v_mfma_f32_16x16x32_bf16 v[40:43], v[72:75], v[140:143], v[40:43]
    v_mfma_f32_16x16x32_bf16 v[44:47], v[76:79], v[140:143], v[44:47]
    v_mfma_f32_16x16x32_bf16 v[48:51], v[72:75], v[196:199], v[48:51]
    v_mfma_f32_16x16x32_bf16 v[52:55], v[76:79], v[196:199], v[52:55]
    v_mfma_f32_16x16x32_bf16 v[56:59], v[72:75], v[252:255], v[56:59]
    v_mfma_f32_16x16x32_bf16 v[60:63], v[76:79], v[252:255], v[60:63]
    s_nop 7
    s_lshl_b32 s28, s26, 4
    s_add_u32 s28, s28, s30
    s_mul_i32 s28, s28, 28672
    s_add_u32 s28, s28, s51
    s_add_u32 s28, s28, 18874368
    v_cvt_pk_bf16_f32 v80, v8, v9
    v_cvt_pk_bf16_f32 v81, v12, v13
    v_cvt_pk_bf16_f32 v82, v10, v11
    v_cvt_pk_bf16_f32 v83, v14, v15
    buffer_store_dwordx4 v[80:83], v6, s[4:7], s28 offen offset:0 sc1
    v_cvt_pk_bf16_f32 v84, v16, v17
    v_cvt_pk_bf16_f32 v85, v20, v21
    v_cvt_pk_bf16_f32 v86, v18, v19
    v_cvt_pk_bf16_f32 v87, v22, v23
    buffer_store_dwordx4 v[84:87], v6, s[4:7], s28 offen offset:256 sc1
    v_cvt_pk_bf16_f32 v88, v24, v25
    v_cvt_pk_bf16_f32 v89, v28, v29
    v_cvt_pk_bf16_f32 v90, v26, v27
    v_cvt_pk_bf16_f32 v91, v30, v31
    buffer_store_dwordx4 v[88:91], v6, s[4:7], s28 offen offset:512 sc1
    v_cvt_pk_bf16_f32 v92, v32, v33
    v_cvt_pk_bf16_f32 v93, v36, v37
    v_cvt_pk_bf16_f32 v94, v34, v35
    v_cvt_pk_bf16_f32 v95, v38, v39
    buffer_store_dwordx4 v[92:95], v6, s[4:7], s28 offen offset:768 sc1
    v_cvt_pk_bf16_f32 v96, v40, v41
    v_cvt_pk_bf16_f32 v97, v44, v45
    v_cvt_pk_bf16_f32 v98, v42, v43
    v_cvt_pk_bf16_f32 v99, v46, v47
    buffer_store_dwordx4 v[96:99], v6, s[4:7], s28 offen offset:1024 sc1
    v_cvt_pk_bf16_f32 v100, v48, v49
    v_cvt_pk_bf16_f32 v101, v52, v53
    v_cvt_pk_bf16_f32 v102, v50, v51
    v_cvt_pk_bf16_f32 v103, v54, v55
    buffer_store_dwordx4 v[100:103], v6, s[4:7], s28 offen offset:1280 sc1
    v_cvt_pk_bf16_f32 v104, v56, v57
    v_cvt_pk_bf16_f32 v105, v60, v61
    v_cvt_pk_bf16_f32 v106, v58, v59
    v_cvt_pk_bf16_f32 v107, v62, v63
    buffer_store_dwordx4 v[104:107], v6, s[4:7], s28 offen offset:1536 sc1
    s_lshl_b32 s39, s26, 13
    s_lshl_b32 s28, s30, 7
    s_add_u32 s39, s39, s28
    s_lshl_b32 s28, s24, 2
    s_add_u32 s39, s39, s28
    s_add_u32 s39, s39, 72351744
    s_cmp_ge_u32 s26, 5
    s_cbranch_scc1 K2_V_lazy
    s_waitcnt vmcnt(0)
    s_mov_b64 exec, 1
    buffer_store_dword v117, v116, s[4:7], s39 offen sc1
    s_mov_b64 exec, -1
    s_mov_b32 s39, 0
K2_V_lazy:
    s_add_u32 s26, s26, 5
    s_cmp_lt_u32 s26, 64
    s_cbranch_scc1 K2_V_loop
    s_waitcnt vmcnt(0)
    s_mov_b64 exec, 1
    buffer_store_dword v117, v116, s[4:7], s39 offen sc1
    s_mov_b64 exec, -1
    s_barrier
    s_cmp_lt_u32 s31, 2
    s_cbranch_scc1 K2_Z
    s_mul_i32 s28, s30, 3
    s_add_u32 s28, s28, s31
    s_sub_u32 s28, s28, 2
    s_cmp_ge_u32 s28, 42
    s_cbranch_scc1 K2_end
    s_mul_hi_u32 s26, s28, 0x24924925
    s_mul_i32 s29, s26, 7
    s_sub_u32 s30, s28, s29
    v_lshrrev_b32 v65, 2, v2
    v_lshlrev_b32 v65, 7, v65
    v_and_b32 v64, 3, v2
    v_lshl_add_u32 v64, v64, 2, v65
    v_and_b32 v7, 1, v2
    v_lshl_add_u32 v65, v7, 2, v65
    v_lshlrev_b32 v66, 9, v3
    v_lshl_add_u32 v66, v2, 4, v66
    v_mul_u32_u24 v67, 272, v2
    v_lshl_add_u32 v67, v3, 4, v67
    s_mul_i32 s28, s24, 8704
    v_add_u32 v67, s28, v67
    v_lshrrev_b32 v68, 3, v0
    v_and_b32 v7, 7, v0
    v_mul_u32_u24 v69, 896, v68
    v_lshl_add_u32 v69, v7, 4, v69
    v_mul_u32_u24 v68, 272, v68
    v_lshl_add_u32 v68, v7, 5, v68
K2_O_loop:
    s_lshl_b32 s32, s26, 13
    s_add_u32 s32, s32, 72351744
    s_lshl_b32 s28, s24, 9
    s_add_u32 s33, s32, s28
Lwf_70:
    buffer_load_dword v70, v64, s[4:7], s33 offen sc1
    s_waitcnt vmcnt(0)
    v_cmp_ne_u32 vcc, s48, v70
    s_cbranch_vccz Lwd_71
    s_sleep 4
    s_sub_u32 s27, s27, 1
    s_cbranch_scc1 K2_end
    s_branch Lwf_70
Lwd_71:
    s_lshl_b32 s34, s26, 4
    s_lshl_b32 s28, s24, 2
    s_add_u32 s34, s34, s28
    s_mul_i32 s35, s34, 28672
    s_lshl_b32 s28, s30, 10
    s_add_u32 s35, s35, s28
    s_add_u32 s35, s35, 18874368
    buffer_load_dwordx4 v[120:123], v6, s[4:7], s35 offen offset:0 sc1
    buffer_load_dwordx4 v[124:127], v6, s[4:7], s35 offen offset:256 sc1
    buffer_load_dwordx4 v[128:131], v6, s[4:7], s35 offen offset:512 sc1
    buffer_load_dwordx4 v[132:135], v6, s[4:7], s35 offen offset:768 sc1
    s_add_u32 s35, s35, 28672
    buffer_load_dwordx4 v[136:139], v6, s[4:7], s35 offen offset:0 sc1
    buffer_load_dwordx4 v[140:143], v6, s[4:7], s35 offen offset:256 sc1
    buffer_load_dwordx4 v[144:147], v6, s[4:7], s35 offen offset:512 sc1
    buffer_load_dwordx4 v[148:151], v6, s[4:7], s35 offen offset:768 sc1
    s_add_u32 s35, s35, 28672
    buffer_load_dwordx4 v[152:155], v6, s[4:7], s35 offen offset:0 sc1
    buffer_load_dwordx4 v[156:159], v6, s[4:7], s35 offen offset:256 sc1
    buffer_load_dwordx4 v[160:163], v6, s[4:7], s35 offen offset:512 sc1
    buffer_load_dwordx4 v[164:167], v6, s[4:7], s35 offen offset:768 sc1
    s_add_u32 s35, s35, 28672
    buffer_load_dwordx4 v[168:171], v6, s[4:7], s35 offen offset:0 sc1
    buffer_load_dwordx4 v[172:175], v6, s[4:7], s35 offen offset:256 sc1
    buffer_load_dwordx4 v[176:179], v6, s[4:7], s35 offen offset:512 sc1
    buffer_load_dwordx4 v[180:183], v6, s[4:7], s35 offen offset:768 sc1
    s_add_u32 s35, s35, 28672
    s_add_u32 s36, s32, 6656
Lwf_72:
    buffer_load_dword v70, v64, s[4:7], s36 offen sc1
    s_waitcnt vmcnt(0)
    v_cmp_ne_u32 vcc, s48, v70
    s_cbranch_vccz Lwd_73
    s_sleep 4
    s_sub_u32 s27, s27, 1
    s_cbranch_scc1 K2_end
    s_branch Lwf_72
Lwd_73:
    s_mul_i32 s37, s26, 28672
    s_lshl_b32 s29, s30, 7
    s_add_u32 s37, s37, s29
    s_add_u32 s36, s37, 67108864
    buffer_load_dwordx4 v[72:75], v69, s[12:15], s37 offen
    buffer_load_dwordx4 v[76:79], v69, s[4:7], s36 offen sc1
    s_add_u32 s33, s33, 2048
    s_cmp_ge_u32 s26, 62
    s_cbranch_scc1 K2_O_data
Lwf_74:
    buffer_load_dword v70, v64, s[4:7], s33 offen sc1
    s_waitcnt vmcnt(0)
    v_cmp_ne_u32 vcc, s48, v70
    s_cbranch_vccz Lwd_75
    s_sleep 2
    s_sub_u32 s27, s27, 1
    s_cbranch_scc1 K2_end
    s_branch Lwf_74
Lwd_75:
    s_add_u32 s33, s33, 2048
Lwf_76:
    buffer_load_dword v70, v65, s[4:7], s33 offen sc1
    s_waitcnt vmcnt(0)
    v_cmp_ne_u32 vcc, s48, v70
    s_cbranch_vccz Lwd_77
    s_sleep 2
    s_sub_u32 s27, s27, 1
    s_cbranch_scc1 K2_end
    s_branch Lwf_76
Lwd_77:
K2_O_data:
    s_mul_i32 s35, s34, 7168
    s_add_u32 s35, s35, s28
    s_add_u32 s35, s35, 55836672
    s_lshl_b32 s50, s34, 11
    s_add_u32 s50, s50, 63963136
    s_add_u32 s51, s50, 4096
    s_lshl_b32 s52, s34, 9
    s_add_u32 s52, s52, 66125824
K2_O_poll:
    buffer_load_dwordx4 v[232:235], v66, s[4:7], s52 offen offset:0 sc1
    buffer_load_dwordx4 v[236:239], v66, s[4:7], s52 offen offset:256 sc1
    buffer_load_dwordx4 v[184:187], v6, s[4:7], s35 offen offset:0 sc1
    buffer_load_dwordx4 v[188:191], v6, s[4:7], s35 offen offset:256 sc1
    buffer_load_dwordx4 v[192:195], v6, s[4:7], s35 offen offset:512 sc1
    buffer_load_dwordx4 v[196:199], v6, s[4:7], s35 offen offset:768 sc1
    buffer_load_dwordx4 v[200:203], v4, s[4:7], s50 offen offset:0 sc1
    buffer_load_dwordx4 v[204:207], v4, s[4:7], s50 offen offset:1024 sc1
    buffer_load_dwordx4 v[208:211], v4, s[4:7], s50 offen offset:2048 sc1
    buffer_load_dwordx4 v[212:215], v4, s[4:7], s50 offen offset:3072 sc1
    buffer_load_dwordx4 v[216:219], v4, s[4:7], s51 offen offset:0 sc1
    buffer_load_dwordx4 v[220:223], v4, s[4:7], s51 offen offset:1024 sc1
    buffer_load_dwordx4 v[224:227], v4, s[4:7], s51 offen offset:2048 sc1
    buffer_load_dwordx4 v[228:231], v4, s[4:7], s51 offen offset:3072 sc1
    s_waitcnt vmcnt(0)
    v_max3_u32 v70, v184, v185, v186
    v_max3_u32 v71, v187, v188, v189
    v_max3_u32 v71, v71, v190, v191
    v_max3_u32 v70, v70, v192, v193
    v_max3_u32 v71, v71, v194, v195
    v_max3_u32 v70, v70, v196, v197
    v_max3_u32 v71, v71, v198, v199
    v_max3_u32 v70, v70, v200, v201
    v_max3_u32 v71, v71, v202, v203
    v_max3_u32 v70, v70, v204, v205
    v_max3_u32 v71, v71, v206, v207
    v_max3_u32 v70, v70, v208, v209
    v_max3_u32 v71, v71, v210, v211
    v_max3_u32 v70, v70, v212, v213
    v_max3_u32 v71, v71, v214, v215
    v_max3_u32 v70, v70, v216, v217
    v_max3_u32 v71, v71, v218, v219
    v_max3_u32 v70, v70, v220, v221
    v_max3_u32 v71, v71, v222, v223
    v_max3_u32 v70, v70, v224, v225
    v_max3_u32 v71, v71, v226, v227
    v_max3_u32 v70, v70, v228, v229
    v_max3_u32 v71, v71, v230, v231
    v_max3_u32 v70, v70, v232, v233
    v_max3_u32 v71, v71, v234, v235
    v_max3_u32 v70, v70, v236, v237
    v_max3_u32 v71, v71, v238, v239
    v_max_u32 v70, v70, v71
    v_cmp_eq_u32 vcc, -1, v70
    s_cbranch_vccz K2_O_go
    s_sleep 1
    s_sub_u32 s27, s27, 1
    s_cbranch_scc1 K2_end
    s_branch K2_O_poll
K2_O_go:
    v_mfma_f32_16x16x32_bf16 v[8:11], v[120:123], v[200:203], 0
    v_mfma_f32_16x16x32_bf16 v[12:15], v[120:123], v[204:207], 0
    v_mfma_f32_16x16x32_bf16 v[16:19], v[124:127], v[200:203], 0
    v_mfma_f32_16x16x32_bf16 v[20:23], v[124:127], v[204:207], 0
    v_mfma_f32_16x16x32_bf16 v[24:27], v[128:131], v[200:203], 0
    v_mfma_f32_16x16x32_bf16 v[28:31], v[128:131], v[204:207], 0
    v_mfma_f32_16x16x32_bf16 v[32:35], v[132:135], v[200:203], 0
    v_mfma_f32_16x16x32_bf16 v[36:39], v[132:135], v[204:207], 0
    v_mfma_f32_16x16x32_bf16 v[8:11], v[136:139], v[208:211], v[8:11]
    v_mfma_f32_16x16x32_bf16 v[12:15], v[136:139], v[212:215], v[12:15]
    v_mfma_f32_16x16x32_bf16 v[16:19], v[140:143], v[208:211], v[16:19]
    v_mfma_f32_16x16x32_bf16 v[20:23], v[140:143], v[212:215], v[20:23]
    v_mfma_f32_16x16x32_bf16 v[24:27], v[144:147], v[208:211], v[24:27]
    v_mfma_f32_16x16x32_bf16 v[28:31], v[144:147], v[212:215], v[28:31]
    v_mfma_f32_16x16x32_bf16 v[32:35], v[148:151], v[208:211], v[32:35]
    v_mfma_f32_16x16x32_bf16 v[36:39], v[148:151], v[212:215], v[36:39]
    v_mfma_f32_16x16x32_bf16 v[8:11], v[152:155], v[216:219], v[8:11]
    v_mfma_f32_16x16x32_bf16 v[12:15], v[152:155], v[220:223], v[12:15]
    v_mfma_f32_16x16x32_bf16 v[16:19], v[156:159], v[216:219], v[16:19]
    v_mfma_f32_16x16x32_bf16 v[20:23], v[156:159], v[220:223], v[20:23]
    v_mfma_f32_16x16x32_bf16 v[24:27], v[160:163], v[216:219], v[24:27]
    v_mfma_f32_16x16x32_bf16 v[28:31], v[160:163], v[220:223], v[28:31]
    v_mfma_f32_16x16x32_bf16 v[32:35], v[164:167], v[216:219], v[32:35]
    v_mfma_f32_16x16x32_bf16 v[36:39], v[164:167], v[220:223], v[36:39]
    v_mfma_f32_16x16x32_bf16 v[8:11], v[168:171], v[224:227], v[8:11]
    v_mfma_f32_16x16x32_bf16 v[12:15], v[168:171], v[228:231], v[12:15]
    v_mfma_f32_16x16x32_bf16 v[16:19], v[172:175], v[224:227], v[16:19]
    v_mfma_f32_16x16x32_bf16 v[20:23], v[172:175], v[228:231], v[20:23]
    v_mfma_f32_16x16x32_bf16 v[24:27], v[176:179], v[224:227], v[24:27]
    v_mfma_f32_16x16x32_bf16 v[28:31], v[176:179], v[228:231], v[28:31]
    v_mfma_f32_16x16x32_bf16 v[32:35], v[180:183], v[224:227], v[32:35]
    v_mfma_f32_16x16x32_bf16 v[36:39], v[180:183], v[228:231], v[36:39]
    v_mfma_f32_16x16x32_bf16 v[8:11], v[184:187], v[232:235], v[8:11]
    v_mfma_f32_16x16x32_bf16 v[12:15], v[184:187], v[236:239], v[12:15]
    v_mfma_f32_16x16x32_bf16 v[16:19], v[188:191], v[232:235], v[16:19]
    v_mfma_f32_16x16x32_bf16 v[20:23], v[188:191], v[236:239], v[20:23]
    v_mfma_f32_16x16x32_bf16 v[24:27], v[192:195], v[232:235], v[24:27]
    v_mfma_f32_16x16x32_bf16 v[28:31], v[192:195], v[236:239], v[28:31]
    v_mfma_f32_16x16x32_bf16 v[32:35], v[196:199], v[232:235], v[32:35]
    v_mfma_f32_16x16x32_bf16 v[36:39], v[196:199], v[236:239], v[36:39]
    s_nop 7
    ds_write_b128 v67, v[8:11] offset:0
    ds_write_b128 v67, v[12:15] offset:4352
    ds_write_b128 v67, v[16:19] offset:64
    ds_write_b128 v67, v[20:23] offset:4416
    ds_write_b128 v67, v[24:27] offset:128
    ds_write_b128 v67, v[28:31] offset:4480
    ds_write_b128 v67, v[32:35] offset:192
    ds_write_b128 v67, v[36:39] offset:4544
    s_waitcnt lgkmcnt(0)
    s_barrier
    ds_read_b128 v[8:11], v68 offset:0
    ds_read_b128 v[12:15], v68 offset:16
    ds_read_b128 v[16:19], v68 offset:8704
    ds_read_b128 v[20:23], v68 offset:8720
    ds_read_b128 v[24:27], v68 offset:17408
    ds_read_b128 v[28:31], v68 offset:17424
    ds_read_b128 v[32:35], v68 offset:26112
    ds_read_b128 v[36:39], v68 offset:26128
    s_waitcnt lgkmcnt(0)
    s_barrier
    v_pk_add_f32 v[8:9], v[8:9], v[16:17]
    v_pk_add_f32 v[24:25], v[24:25], v[32:33]
    v_pk_add_f32 v[8:9], v[8:9], v[24:25]
    v_pk_add_f32 v[10:11], v[10:11], v[18:19]
    v_pk_add_f32 v[26:27], v[26:27], v[34:35]
    v_pk_add_f32 v[10:11], v[10:11], v[26:27]
    v_pk_add_f32 v[12:13], v[12:13], v[20:21]
    v_pk_add_f32 v[28:29], v[28:29], v[36:37]
    v_pk_add_f32 v[12:13], v[12:13], v[28:29]
    v_pk_add_f32 v[14:15], v[14:15], v[22:23]
    v_pk_add_f32 v[30:31], v[30:31], v[38:39]
    v_pk_add_f32 v[14:15], v[14:15], v[30:31]
    v_cvt_pk_bf16_f32 v40, v8, v9
    v_lshlrev_b32 v41, 16, v40
    v_and_b32 v42, 0xffff0000, v40
    v_lshlrev_b32 v43, 16, v72
    v_and_b32 v44, 0xffff0000, v72
    v_add_f32 v41, v41, v43
    v_add_f32 v42, v42, v44
    v_cvt_pk_bf16_f32 v40, v41, v42
    v_lshlrev_b32 v41, 16, v40
    v_and_b32 v42, 0xffff0000, v40
    v_lshlrev_b32 v43, 16, v76
    v_and_b32 v44, 0xffff0000, v76
    v_add_f32 v41, v41, v43
    v_add_f32 v42, v42, v44
    v_cvt_pk_bf16_f32 v48, v41, v42
    v_cvt_pk_bf16_f32 v40, v10, v11
    v_lshlrev_b32 v41, 16, v40
    v_and_b32 v42, 0xffff0000, v40
    v_lshlrev_b32 v43, 16, v73
    v_and_b32 v44, 0xffff0000, v73
    v_add_f32 v41, v41, v43
    v_add_f32 v42, v42, v44
    v_cvt_pk_bf16_f32 v40, v41, v42
    v_lshlrev_b32 v41, 16, v40
    v_and_b32 v42, 0xffff0000, v40
    v_lshlrev_b32 v43, 16, v77
    v_and_b32 v44, 0xffff0000, v77
    v_add_f32 v41, v41, v43
    v_add_f32 v42, v42, v44
    v_cvt_pk_bf16_f32 v49, v41, v42
    v_cvt_pk_bf16_f32 v40, v12, v13
    v_lshlrev_b32 v41, 16, v40
    v_and_b32 v42, 0xffff0000, v40
    v_lshlrev_b32 v43, 16, v74
    v_and_b32 v44, 0xffff0000, v74
    v_add_f32 v41, v41, v43
    v_add_f32 v42, v42, v44
    v_cvt_pk_bf16_f32 v40, v41, v42
    v_lshlrev_b32 v41, 16, v40
    v_and_b32 v42, 0xffff0000, v40
    v_lshlrev_b32 v43, 16, v78
    v_and_b32 v44, 0xffff0000, v78
    v_add_f32 v41, v41, v43
    v_add_f32 v42, v42, v44
    v_cvt_pk_bf16_f32 v50, v41, v42
    v_cvt_pk_bf16_f32 v40, v14, v15
    v_lshlrev_b32 v41, 16, v40
    v_and_b32 v42, 0xffff0000, v40
    v_lshlrev_b32 v43, 16, v75
    v_and_b32 v44, 0xffff0000, v75
    v_add_f32 v41, v41, v43
    v_add_f32 v42, v42, v44
    v_cvt_pk_bf16_f32 v40, v41, v42
    v_lshlrev_b32 v41, 16, v40
    v_and_b32 v42, 0xffff0000, v40
    v_lshlrev_b32 v43, 16, v79
    v_and_b32 v44, 0xffff0000, v79
    v_add_f32 v41, v41, v43
    v_add_f32 v42, v42, v44
    v_cvt_pk_bf16_f32 v51, v41, v42
    buffer_store_dwordx4 v[48:51], v69, s[8:11], s37 offen sc1
    s_add_u32 s26, s26, 6
    s_cmp_lt_u32 s26, 63
    s_cbranch_scc1 K2_O_loop
    s_branch K2_end
K2_Z:
    s_mov_b32 s60, 0
    s_mov_b32 s26, s31
K2_Z0:
    v_mov_b32 v6, 0x4444
    v_mov_b32 v7, 0xeeee
    v_and_b32 v5, 2, v2
    v_cmp_ne_u32 vcc, 0, v5
    s_nop 1
    v_cndmask_b32 v6, v6, v7, vcc
    s_lshl_b32 s54, s24, 11
    v_add_u32 v5, 4096, v4
    v_lshrrev_b32 v72, 1, v3
    v_and_b32 v73, 1, v3
    v_lshlrev_b32 v64, 4, v2
    v_lshl_add_u32 v64, v72, 2, v64
    v_lshl_add_u32 v64, v73, 3, v64
    v_add_u32 v64, s54, v64
    v_add_u32 v66, s54, v4
    v_cmp_gt_u32 s[62:63], 48, v1
    s_mov_b32 s56, 70254592
    s_mul_i32 s57, s30, 7168
    s_add_u32 s57, s57, s51
    s_add_u32 s57, s57, 55836672
    s_lshl_b32 s58, s30, 7
    s_lshl_b32 s28, s24, 2
    s_add_u32 s58, s58, s28
    s_add_u32 s58, s58, 72353792
    s_mul_i32 s28, s26, 7168
    s_add_u32 s56, s56, s28
    s_mul_i32 s28, s26, 114688
    s_add_u32 s57, s57, s28
    s_lshl_b32 s28, s26, 13
    s_add_u32 s58, s58, s28
K2_Z_loop:
    v_mov_b32 v36, 0
    v_mov_b32 v37, 0
    v_mov_b32 v38, 0
    v_mov_b32 v39, 0
    v_mov_b32 v40, 0
    v_mov_b32 v41, 0
    v_mov_b32 v42, 0
    v_mov_b32 v43, 0
    v_mov_b32 v44, 0
    v_mov_b32 v45, 0
    v_mov_b32 v46, 0
    v_mov_b32 v47, 0
    v_mov_b32 v48, 0
    v_mov_b32 v49, 0
    v_mov_b32 v50, 0
    v_mov_b32 v51, 0
    v_mov_b32 v52, 0
    v_mov_b32 v53, 0
    v_mov_b32 v54, 0
    v_mov_b32 v55, 0
    v_mov_b32 v56, 0
    v_mov_b32 v57, 0
    v_mov_b32 v58, 0
    v_mov_b32 v59, 0
    v_mov_b32 v60, 0
    v_mov_b32 v61, 0
    v_mov_b32 v62, 0
    v_mov_b32 v63, 0
    s_add_u32 s52, s56, s54
    s_cmp_eq_u32 s24, 3
    s_cselect_b32 s53, 0, 1024
    s_add_u32 s53, s53, s52
K2_Z_poll:
    buffer_load_dwordx4 v[80:83], v4, s[4:7], s52 offen sc1
    buffer_load_dwordx4 v[84:87], v4, s[4:7], s53 offen sc1
    s_waitcnt vmcnt(0)
    v_max3_u32 v7, v80, v81, v82
    v_max3_u32 v88, v83, v84, v85
    v_max3_u32 v7, v7, v86, v87
    v_max_u32 v7, v7, v88
    v_cmp_eq_u32 vcc, -1, v7
    s_cbranch_vccz K2_Z_go
    s_sleep 4
    s_sub_u32 s27, s27, 1
    s_cbranch_scc1 K2_end
    s_branch K2_Z_poll
K2_Z_go:
    ds_write_b128 v66, v[80:83] offset:16384
    ds_write_b128 v66, v[84:87] offset:17408
    s_waitcnt lgkmcnt(0)
    s_barrier
    ds_read_b128 v[8:11], v4 offset:16384
    ds_read_b128 v[12:15], v4 offset:17408
    ds_read_b128 v[16:19], v4 offset:18432
    ds_read_b128 v[20:23], v4 offset:19456
    ds_read_b128 v[24:27], v4 offset:20480
    ds_read_b128 v[28:31], v4 offset:21504
    ds_read_b128 v[32:35], v4 offset:22528
    s_waitcnt lgkmcnt(0)
    s_barrier
    v_smfmac_f32_16x16x64_bf16 v[36:39], v[8:11], a[0:7], v6
    v_smfmac_f32_16x16x64_bf16 v[36:39], v[12:15], a[8:15], v6
    v_smfmac_f32_16x16x64_bf16 v[36:39], v[16:19], a[16:23], v6
    v_smfmac_f32_16x16x64_bf16 v[36:39], v[20:23], a[24:31], v6
    v_smfmac_f32_16x16x64_bf16 v[36:39], v[24:27], a[32:39], v6
    v_smfmac_f32_16x16x64_bf16 v[36:39], v[28:31], a[40:47], v6
    v_smfmac_f32_16x16x64_bf16 v[36:39], v[32:35], a[48:55], v6
    v_smfmac_f32_16x16x64_bf16 v[40:43], v[8:11], a[56:63], v6
    s_nop 1
    v_smfmac_f32_16x16x64_bf16 v[40:43], v[12:15], a[64:71], v6
    s_nop 2
    v_smfmac_f32_16x16x64_bf16 v[40:43], v[16:19], a[72:79], v6
    v_add_f32 v36, v36, v38
    v_smfmac_f32_16x16x64_bf16 v[40:43], v[20:23], a[80:87], v6
    v_add_f32 v37, v37, v39
    v_smfmac_f32_16x16x64_bf16 v[40:43], v[24:27], a[88:95], v6
    v_cvt_pk_bf16_f32 v36, v36, v37
    v_smfmac_f32_16x16x64_bf16 v[40:43], v[28:31], a[96:103], v6
    ds_write_b32 v64, v36 offset:0
    v_smfmac_f32_16x16x64_bf16 v[40:43], v[32:35], a[104:111], v6
    v_smfmac_f32_16x16x64_bf16 v[44:47], v[8:11], a[112:119], v6
    s_nop 1
    v_smfmac_f32_16x16x64_bf16 v[44:47], v[12:15], a[120:127], v6
    s_nop 2
    v_smfmac_f32_16x16x64_bf16 v[44:47], v[16:19], a[128:135], v6
    v_add_f32 v40, v40, v42
    v_smfmac_f32_16x16x64_bf16 v[44:47], v[20:23], a[136:143], v6
    v_add_f32 v41, v41, v43
    v_smfmac_f32_16x16x64_bf16 v[44:47], v[24:27], a[144:151], v6
    v_cvt_pk_bf16_f32 v40, v40, v41
    v_smfmac_f32_16x16x64_bf16 v[44:47], v[28:31], a[152:159], v6
    ds_write_b32 v64, v40 offset:256
    v_smfmac_f32_16x16x64_bf16 v[44:47], v[32:35], a[160:167], v6
    v_smfmac_f32_16x16x64_bf16 v[48:51], v[8:11], a[168:175], v6
    s_nop 1
    v_smfmac_f32_16x16x64_bf16 v[48:51], v[12:15], a[176:183], v6
    s_nop 2
    v_smfmac_f32_16x16x64_bf16 v[48:51], v[16:19], a[184:191], v6
    v_add_f32 v44, v44, v46
    v_smfmac_f32_16x16x64_bf16 v[48:51], v[20:23], a[192:199], v6
    v_add_f32 v45, v45, v47
    v_smfmac_f32_16x16x64_bf16 v[48:51], v[24:27], a[200:207], v6
    v_cvt_pk_bf16_f32 v44, v44, v45
    v_smfmac_f32_16x16x64_bf16 v[48:51], v[28:31], a[208:215], v6
    ds_write_b32 v64, v44 offset:512
    v_smfmac_f32_16x16x64_bf16 v[48:51], v[32:35], a[216:223], v6
    v_smfmac_f32_16x16x64_bf16 v[52:55], v[8:11], a[224:231], v6
    s_nop 1
    v_smfmac_f32_16x16x64_bf16 v[52:55], v[12:15], a[232:239], v6
    s_nop 2
    v_smfmac_f32_16x16x64_bf16 v[52:55], v[16:19], a[240:247], v6
    v_add_f32 v48, v48, v50
    v_smfmac_f32_16x16x64_bf16 v[52:55], v[20:23], a[248:255], v6
    v_add_f32 v49, v49, v51
    v_smfmac_f32_16x16x64_bf16 v[52:55], v[24:27], v[120:127], v6
    v_cvt_pk_bf16_f32 v48, v48, v49
    v_smfmac_f32_16x16x64_bf16 v[52:55], v[28:31], v[128:135], v6
    ds_write_b32 v64, v48 offset:768
    v_smfmac_f32_16x16x64_bf16 v[52:55], v[32:35], v[136:143], v6
    v_smfmac_f32_16x16x64_bf16 v[56:59], v[8:11], v[144:151], v6
    s_nop 1
    v_smfmac_f32_16x16x64_bf16 v[56:59], v[12:15], v[152:159], v6
    s_nop 2
    v_smfmac_f32_16x16x64_bf16 v[56:59], v[16:19], v[160:167], v6
    v_add_f32 v52, v52, v54
    v_smfmac_f32_16x16x64_bf16 v[56:59], v[20:23], v[168:175], v6
    v_add_f32 v53, v53, v55
    v_smfmac_f32_16x16x64_bf16 v[56:59], v[24:27], v[176:183], v6
    v_cvt_pk_bf16_f32 v52, v52, v53
    v_smfmac_f32_16x16x64_bf16 v[56:59], v[28:31], v[184:191], v6
    ds_write_b32 v64, v52 offset:1024
    v_smfmac_f32_16x16x64_bf16 v[56:59], v[32:35], v[192:199], v6
    v_smfmac_f32_16x16x64_bf16 v[60:63], v[8:11], v[200:207], v6
    s_nop 1
    v_smfmac_f32_16x16x64_bf16 v[60:63], v[12:15], v[208:215], v6
    s_nop 2
    v_smfmac_f32_16x16x64_bf16 v[60:63], v[16:19], v[216:223], v6
    v_add_f32 v56, v56, v58
    v_smfmac_f32_16x16x64_bf16 v[60:63], v[20:23], v[224:231], v6
    v_add_f32 v57, v57, v59
    v_smfmac_f32_16x16x64_bf16 v[60:63], v[24:27], v[232:239], v6
    v_cvt_pk_bf16_f32 v56, v56, v57
    v_smfmac_f32_16x16x64_bf16 v[60:63], v[28:31], v[240:247], v6
    ds_write_b32 v64, v56 offset:1280
    v_smfmac_f32_16x16x64_bf16 v[60:63], v[32:35], v[248:255], v6
    s_nop 7
    v_add_f32 v60, v60, v62
    v_add_f32 v61, v61, v63
    v_cvt_pk_bf16_f32 v60, v60, v61
    ds_write_b32 v64, v60 offset:1536
    ds_read_b128 v[72:75], v66
    ds_read_b128 v[76:79], v66 offset:1024
    s_waitcnt lgkmcnt(0)
    buffer_store_dwordx4 v[72:75], v4, s[4:7], s57 offen sc1
    s_mov_b64 exec, s[62:63]
    buffer_store_dwordx4 v[76:79], v4, s[4:7], s57 offen offset:1024 sc1
    s_mov_b64 exec, -1
    s_waitcnt vmcnt(0)
    s_mov_b64 exec, 1
    buffer_store_dword v117, v116, s[4:7], s58 offen sc1
    s_mov_b64 exec, -1
    s_cmp_eq_u32 s60, 0
    s_cbranch_scc1 K2_Z_next
    s_barrier
    s_branch K2_V_ret
K2_Z_next:
    s_add_u32 s56, s56, 14336
    s_add_u32 s57, s57, 229376
    s_add_u32 s58, s58, 16384
    s_add_u32 s26, s26, 2
    s_cmp_lt_u32 s26, 64
    s_cbranch_scc1 K2_Z_loop
    s_branch K2_end
K2_E:
    s_sub_u32 s25, s25, 192
    s_cmp_ge_u32 s25, 28
    s_cbranch_scc1 K2_end
    s_and_b32 s31, s25, 1
    s_lshr_b32 s30, s25, 1
    v_mul_u32_u24 v7, 7168, v3
    v_lshl_add_u32 v6, v2, 4, v7
    v_lshrrev_b32 v64, 2, v2
    v_lshlrev_b32 v64, 7, v64
    v_and_b32 v7, 3, v2
    v_lshl_add_u32 v64, v7, 2, v64
    v_lshlrev_b32 v66, 9, v3
    v_lshl_add_u32 v66, v2, 4, v66
    v_mul_u32_u24 v67, 144, v2
    v_lshl_add_u32 v67, v3, 4, v67
    s_mul_i32 s28, s24, 2304
    v_add_u32 v67, s28, v67
    v_lshrrev_b32 v68, 4, v0
    v_mul_u32_u24 v69, 896, v68
    v_lshl_add_u32 v69, v2, 2, v69
    v_mul_u32_u24 v68, 144, v68
    v_lshl_add_u32 v68, v2, 3, v68
    v_mov_b32 v65, 0x7ffffff0
    s_cmp_eq_u32 s31, 0
    s_cbranch_scc1 K2_E_last
    s_lshl_b32 s28, s24, 9
    s_add_u32 s33, s28, 72353792
Lwf_78:
    buffer_load_dword v70, v64, s[4:7], s33 offen sc1
    s_waitcnt vmcnt(0)
    v_cmp_ne_u32 vcc, s48, v70
    s_cbranch_vccz Lwd_79
    s_sleep 8
    s_sub_u32 s27, s27, 1
    s_cbranch_scc1 K2_end
    s_branch Lwf_78
Lwd_79:
    s_lshl_b32 s34, s24, 2
    s_lshl_b32 s28, s30, 9
    s_mul_i32 s35, s34, 7168
    s_add_u32 s35, s35, s28
    s_add_u32 s35, s35, 55836672
    buffer_load_dwordx4 v[152:155], v6, s[4:7], s35 offen offset:0 sc1
    buffer_load_dwordx4 v[156:159], v6, s[4:7], s35 offen offset:256 sc1
    s_sub_u32 s33, s33, 2048
Lwf_80:
    buffer_load_dword v70, v64, s[4:7], s33 offen sc1
    s_waitcnt vmcnt(0)
    v_cmp_ne_u32 vcc, s48, v70
    s_cbranch_vccz Lwd_81
    s_sleep 2
    s_sub_u32 s27, s27, 1
    s_cbranch_scc1 K2_end
    s_branch Lwf_80
Lwd_81:
    s_mul_i32 s35, s34, 28672
    s_add_u32 s35, s35, s28
    s_add_u32 s35, s35, 18874368
    buffer_load_dwordx4 v[120:123], v6, s[4:7], s35 offen offset:0 sc1
    buffer_load_dwordx4 v[124:127], v6, s[4:7], s35 offen offset:256 sc1
    s_add_u32 s35, s35, 28672
    buffer_load_dwordx4 v[128:131], v6, s[4:7], s35 offen offset:0 sc1
    buffer_load_dwordx4 v[132:135], v6, s[4:7], s35 offen offset:256 sc1
    s_add_u32 s35, s35, 28672
    buffer_load_dwordx4 v[136:139], v6, s[4:7], s35 offen offset:0 sc1
    buffer_load_dwordx4 v[140:143], v6, s[4:7], s35 offen offset:256 sc1
    s_add_u32 s35, s35, 28672
    buffer_load_dwordx4 v[144:147], v6, s[4:7], s35 offen offset:0 sc1
    buffer_load_dwordx4 v[148:151], v6, s[4:7], s35 offen offset:256 sc1
    s_add_u32 s35, s35, 28672
    s_lshl_b32 s50, s34, 11
    s_add_u32 s50, s50, 66061312
    s_add_u32 s51, s50, 4096
    s_lshl_b32 s52, s34, 9
    s_add_u32 s52, s52, 66650368
    v_lshrrev_b32 v40, 4, v0
    v_lshrrev_b32 v41, 1, v40
    v_lshlrev_b32 v41, 6, v41
    v_and_b32 v42, 1, v40
    v_lshl_add_u32 v41, v42, 4, v41
    v_lshrrev_b32 v42, 3, v2
    v_lshl_add_u32 v41, v42, 8, v41
    v_bfe_u32 v42, v2, 2, 1
    v_lshl_add_u32 v41, v42, 5, v41
    v_and_b32 v42, 3, v2
    v_lshl_add_u32 v41, v42, 2, v41
    v_cmp_gt_u32 vcc, 8, v40
    v_cmp_gt_u32 s[62:63], 8, v2
    s_add_u32 s36, s28, 69255168
    v_cndmask_b32 v47, v65, v41, vcc
    s_add_u32 s37, s28, 70261760
K2_E0_poll:
    buffer_load_dwordx4 v[176:179], v66, s[4:7], s52 offen sc1
    buffer_load_dwordx4 v[160:163], v4, s[4:7], s50 offen offset:0 sc1
    buffer_load_dwordx4 v[164:167], v4, s[4:7], s50 offen offset:2048 sc1
    buffer_load_dwordx4 v[168:171], v4, s[4:7], s51 offen offset:0 sc1
    buffer_load_dwordx4 v[172:175], v4, s[4:7], s51 offen offset:2048 sc1
    s_waitcnt vmcnt(0)
    v_max3_u32 v70, v160, v161, v162
    v_max3_u32 v71, v163, v164, v165
    v_max3_u32 v71, v71, v166, v167
    v_max3_u32 v70, v70, v168, v169
    v_max3_u32 v71, v71, v170, v171
    v_max3_u32 v70, v70, v172, v173
    v_max3_u32 v71, v71, v174, v175
    v_max3_u32 v70, v70, v176, v177
    v_max3_u32 v71, v71, v178, v179
    v_max_u32 v70, v70, v71
    v_cmp_eq_u32 vcc, -1, v70
    s_and_b64 vcc, vcc, s[62:63]
    s_cbranch_scc0 K2_E0_go
    s_sleep 1
    s_sub_u32 s27, s27, 1
    s_cbranch_scc1 K2_end
    s_branch K2_E0_poll
K2_E0_go:
    v_mfma_f32_16x16x32_bf16 v[8:11], v[120:123], v[160:163], 0
    v_mfma_f32_16x16x32_bf16 v[12:15], v[124:127], v[160:163], 0
    v_mfma_f32_16x16x32_bf16 v[8:11], v[128:131], v[164:167], v[8:11]
    v_mfma_f32_16x16x32_bf16 v[12:15], v[132:135], v[164:167], v[12:15]
    v_mfma_f32_16x16x32_bf16 v[8:11], v[136:139], v[168:171], v[8:11]
    v_mfma_f32_16x16x32_bf16 v[12:15], v[140:143], v[168:171], v[12:15]
    v_mfma_f32_16x16x32_bf16 v[8:11], v[144:147], v[172:175], v[8:11]
    v_mfma_f32_16x16x32_bf16 v[12:15], v[148:151], v[172:175], v[12:15]
    v_mfma_f32_16x16x32_bf16 v[8:11], v[152:155], v[176:179], v[8:11]
    v_mfma_f32_16x16x32_bf16 v[12:15], v[156:159], v[176:179], v[12:15]
    s_nop 7
    ds_write_b128 v67, v[8:11] offset:0
    ds_write_b128 v67, v[12:15] offset:64
    s_waitcnt lgkmcnt(0)
    s_barrier
    ds_read_b64 v[16:17], v68 offset:0
    ds_read_b64 v[18:19], v68 offset:2304
    ds_read_b64 v[20:21], v68 offset:4608
    ds_read_b64 v[22:23], v68 offset:6912
    s_waitcnt lgkmcnt(0)
    v_pk_add_f32 v[16:17], v[16:17], v[18:19]
    v_pk_add_f32 v[20:21], v[20:21], v[22:23]
    v_pk_add_f32 v[16:17], v[16:17], v[20:21]
    v_cvt_pk_bf16_f32 v40, v16, v17
    buffer_store_dword v40, v47, s[4:7], s36 offen sc1
    buffer_store_dword v40, v47, s[4:7], s37 offen sc1
    s_barrier
K2_E_last:
    s_lshl_b32 s28, s24, 9
    s_add_u32 s33, s28, 72867840
Lwf_82:
    buffer_load_dword v70, v64, s[4:7], s33 offen sc1
    s_waitcnt vmcnt(0)
    v_cmp_ne_u32 vcc, s48, v70
    s_cbranch_vccz Lwd_83
    s_sleep 64
    s_sub_u32 s27, s27, 1
    s_cbranch_scc1 K2_end
    s_branch Lwf_82
Lwd_83:
    s_lshl_b32 s34, s24, 2
    s_add_u32 s34, s34, 1008
    s_mul_i32 s35, s34, 28672
    s_lshl_b32 s28, s30, 9
    s_add_u32 s35, s35, s28
    s_add_u32 s35, s35, 18874368
    buffer_load_dwordx4 v[120:123], v6, s[4:7], s35 offen offset:0 sc1
    buffer_load_dwordx4 v[124:127], v6, s[4:7], s35 offen offset:256 sc1
    s_add_u32 s35, s35, 28672
    buffer_load_dwordx4 v[128:131], v6, s[4:7], s35 offen offset:0 sc1
    buffer_load_dwordx4 v[132:135], v6, s[4:7], s35 offen offset:256 sc1
    s_add_u32 s35, s35, 28672
    buffer_load_dwordx4 v[136:139], v6, s[4:7], s35 offen offset:0 sc1
    buffer_load_dwordx4 v[140:143], v6, s[4:7], s35 offen offset:256 sc1
    s_add_u32 s35, s35, 28672
    buffer_load_dwordx4 v[144:147], v6, s[4:7], s35 offen offset:0 sc1
    buffer_load_dwordx4 v[148:151], v6, s[4:7], s35 offen offset:256 sc1
    s_add_u32 s35, s35, 28672
    s_mov_b32 s36, 72874496
Lwf_84:
    buffer_load_dword v70, v64, s[4:7], s36 offen sc1
    s_waitcnt vmcnt(0)
    v_cmp_ne_u32 vcc, s48, v70
    s_cbranch_vccz Lwd_85
    s_sleep 64
    s_sub_u32 s27, s27, 1
    s_cbranch_scc1 K2_end
    s_branch Lwf_84
Lwd_85:
    s_mul_i32 s37, s31, 14336
    s_lshl_b32 s29, s30, 6
    s_add_u32 s37, s37, s29
    s_add_u32 s37, s37, 1806336
    s_add_u32 s36, s37, 67108864
    buffer_load_dword v72, v69, s[12:15], s37 offen
    buffer_load_dword v73, v69, s[4:7], s36 offen sc1
    s_mul_i32 s35, s34, 7168
    s_add_u32 s35, s35, s28
    s_add_u32 s35, s35, 55836672
    s_lshl_b32 s50, s34, 11
    s_lshl_b32 s29, s31, 10
    s_add_u32 s50, s50, s29
    s_add_u32 s50, s50, 63963136
    s_add_u32 s51, s50, 4096
    s_lshl_b32 s52, s34, 9
    s_lshl_b32 s29, s31, 8
    s_add_u32 s52, s52, s29
    s_add_u32 s52, s52, 66125824
    s_add_u32 s33, s33, -22528
Lwf_86:
    buffer_load_dword v70, v64, s[4:7], s33 offen sc1
    s_waitcnt vmcnt(0)
    v_cmp_ne_u32 vcc, s48, v70
    s_cbranch_vccz Lwd_87
    s_sleep 16
    s_sub_u32 s27, s27, 1
    s_cbranch_scc1 K2_end
    s_branch Lwf_86
Lwd_87:
    s_mov_b32 s53, 0
    s_branch K2_E_go
K2_E_poll:
    buffer_load_dwordx4 v[176:179], v66, s[4:7], s52 offen sc1
    buffer_load_dwordx4 v[152:155], v6, s[4:7], s35 offen offset:0 sc1
    buffer_load_dwordx4 v[156:159], v6, s[4:7], s35 offen offset:256 sc1
    buffer_load_dwordx4 v[160:163], v4, s[4:7], s50 offen offset:0 sc1
    buffer_load_dwordx4 v[164:167], v4, s[4:7], s50 offen offset:2048 sc1
    buffer_load_dwordx4 v[168:171], v4, s[4:7], s51 offen offset:0 sc1
    buffer_load_dwordx4 v[172:175], v4, s[4:7], s51 offen offset:2048 sc1
    s_waitcnt vmcnt(0)
    v_max3_u32 v70, v152, v153, v154
    v_max3_u32 v71, v155, v156, v157
    v_max3_u32 v71, v71, v158, v159
    v_max3_u32 v70, v70, v160, v161
    v_max3_u32 v71, v71, v162, v163
    v_max3_u32 v70, v70, v164, v165
    v_max3_u32 v71, v71, v166, v167
    v_max3_u32 v70, v70, v168, v169
    v_max3_u32 v71, v71, v170, v171
    v_max3_u32 v70, v70, v172, v173
    v_max3_u32 v71, v71, v174, v175
    v_max3_u32 v70, v70, v176, v177
    v_max3_u32 v71, v71, v178, v179
    v_max_u32 v70, v70, v71
    v_cmp_eq_u32 vcc, -1, v70
    s_cbranch_vccz K2_E_go
    s_sleep 1
    s_sub_u32 s27, s27, 1
    s_cbranch_scc1 K2_end
    s_branch K2_E_poll
K2_E_go:
    v_mfma_f32_16x16x32_bf16 v[8:11], v[120:123], v[160:163], 0
    v_mfma_f32_16x16x32_bf16 v[12:15], v[124:127], v[160:163], 0
    v_mfma_f32_16x16x32_bf16 v[8:11], v[128:131], v[164:167], v[8:11]
    v_mfma_f32_16x16x32_bf16 v[12:15], v[132:135], v[164:167], v[12:15]
    v_mfma_f32_16x16x32_bf16 v[8:11], v[136:139], v[168:171], v[8:11]
    v_mfma_f32_16x16x32_bf16 v[12:15], v[140:143], v[168:171], v[12:15]
    v_mfma_f32_16x16x32_bf16 v[8:11], v[144:147], v[172:175], v[8:11]
    v_mfma_f32_16x16x32_bf16 v[12:15], v[148:151], v[172:175], v[12:15]
    v_mfma_f32_16x16x32_bf16 v[8:11], v[152:155], v[176:179], v[8:11]
    v_mfma_f32_16x16x32_bf16 v[12:15], v[156:159], v[176:179], v[12:15]
    s_nop 7
    ds_write_b128 v67, v[8:11] offset:0
    ds_write_b128 v67, v[12:15] offset:64
    v_lshlrev_b32 v43, 16, v72
    v_and_b32 v44, 0xffff0000, v72
    v_lshlrev_b32 v45, 16, v73
    v_and_b32 v46, 0xffff0000, v73
    s_waitcnt lgkmcnt(0)
    s_barrier
    ds_read_b64 v[16:17], v68 offset:0
    ds_read_b64 v[18:19], v68 offset:2304
    ds_read_b64 v[20:21], v68 offset:4608
    ds_read_b64 v[22:23], v68 offset:6912
    s_waitcnt lgkmcnt(0)
    v_pk_add_f32 v[16:17], v[16:17], v[18:19]
    v_pk_add_f32 v[20:21], v[20:21], v[22:23]
    v_pk_add_f32 v[16:17], v[16:17], v[20:21]
    v_cvt_pk_bf16_f32 v40, v16, v17
    v_lshlrev_b32 v41, 16, v40
    v_and_b32 v42, 0xffff0000, v40
    v_add_f32 v41, v41, v43
    v_add_f32 v42, v42, v44
    v_cvt_pk_bf16_f32 v40, v41, v42
    v_lshlrev_b32 v41, 16, v40
    v_and_b32 v42, 0xffff0000, v40
    v_add_f32 v41, v41, v45
    v_add_f32 v42, v42, v46
    v_cvt_pk_bf16_f32 v48, v41, v42
    buffer_store_dword v48, v65, s[8:11], s37 offen
    s_cmp_lg_u32 s53, 0
    s_cbranch_scc1 K2_end
    s_mov_b32 s53, 1
    v_mov_b32 v65, v69
    s_barrier
    s_branch K2_E_poll
K2_T:
    s_cmp_lg_u32 s31, 5
    s_cbranch_scc1 K2_T_gate
    s_lshr_b32 s28, s30, 2
    s_xor_b32 s28, s28, 4
    s_and_b32 s29, s30, 3
    s_lshl_b32 s29, s29, 3
    s_or_b32 s28, s28, s29
    s_lshl_b32 s28, s28, 7
    v_and_b32 v12, 1, v1
    v_lshlrev_b32 v12, 12, v12
    v_add_u32 v12, s28, v12
    s_cmp_lg_u32 s24, 0
    s_cbranch_scc1 Lmw_88
Lsw_89:
    buffer_load_dwordx4 v[8:11], v12, s[4:7], s49 offen sc1
Lse_91:
    s_waitcnt vmcnt(0)
    v_xor_b32 v8, s48, v8
    v_xor_b32 v9, s48, v9
    v_xor_b32 v10, s48, v10
    v_xor_b32 v11, s48, v11
    v_or3_b32 v8, v8, v9, v10
    v_or_b32 v8, v8, v11
    v_cmp_lt_u32 vcc, 1, v8
    s_cbranch_vccz Lsd_90
    s_sleep 1
    s_sub_u32 s27, s27, 1
    s_cbranch_scc1 K2_end
    s_branch Lsw_89
Lsd_90:
Lmw_88:
    s_barrier
    s_branch K2_T_noep
K2_T_gate:
    v_and_b32 v12, 3, v1
    v_lshlrev_b32 v12, 2, v12
    s_and_b32 s28, s25, 15
    s_lshl_b32 s28, s28, 7
    s_add_u32 s28, s28, 72425472
Lwf_92:
    buffer_load_dword v13, v12, s[4:7], s28 offen sc1
    s_waitcnt vmcnt(0)
    v_cmp_ne_u32 vcc, s48, v13
    s_cbranch_vccz Lwd_93
    s_sleep 16
    s_sub_u32 s27, s27, 1
    s_cbranch_scc1 K2_end
    s_branch Lwf_92
Lwd_93:
K2_T_go0:
    s_cmp_lg_u32 s25, 6
    s_cbranch_scc1 K2_T_noep
    v_mov_b32 v6, s48
    v_mov_b32 v5, 0
    s_mov_b32 s28, 73007104
    s_mov_b64 exec, 1
    buffer_store_dword v6, v5, s[4:7], s28 offen sc1
    s_mov_b64 exec, -1
K2_T_noep:
    s_mul_i32 s50, s30, 401408
    s_add_u32 s50, s50, 2097152
    s_sub_u32 s26, s31, 5
    s_cmp_eq_u32 s26, 0
    s_cselect_b32 s26, 64, s26
    s_mul_i32 s32, s24, 7
    s_add_u32 s32, s32, 1
    s_lshr_b32 s32, s32, 1
    s_lshr_b32 s33, s24, 1
    s_mul_i32 s33, s33, 7
    s_add_u32 s33, s33, 3
    s_and_b32 s35, s24, 1
    s_sub_u32 s34, s35, 1
    v_lshrrev_b32 v7, 3, v2
    v_lshlrev_b32 v7, 8, v7
    v_and_b32 v6, 7, v2
    v_lshl_add_u32 v7, v6, 4, v7
    v_mul_u32_u24 v6, 7168, v3
    v_add_u32 v7, v7, v6
    s_lshl_b32 s28, s32, 9
    v_add_u32 v5, s28, v7
    s_lshl_b32 s28, s33, 9
    s_lshl_b32 s29, s35, 7
    s_add_u32 s28, s28, s29
    v_add_u32 v6, s28, v7
    buffer_load_dwordx4 a[0:3], v5, s[4:7], s50 offen offset:0
    buffer_load_dwordx4 a[56:59], v5, s[4:7], s50 offen offset:128
    buffer_load_dwordx4 a[112:115], v5, s[4:7], s50 offen offset:512
    buffer_load_dwordx4 a[168:171], v5, s[4:7], s50 offen offset:640
    buffer_load_dwordx4 a[224:227], v5, s[4:7], s50 offen offset:1024
    buffer_load_dwordx4 v[144:147], v5, s[4:7], s50 offen offset:1152
    buffer_load_dwordx4 v[200:203], v6, s[4:7], s50 offen
    s_add_u32 s50, s50, 28672
    buffer_load_dwordx4 a[4:7], v5, s[4:7], s50 offen offset:0
    buffer_load_dwordx4 a[60:63], v5, s[4:7], s50 offen offset:128
    buffer_load_dwordx4 a[116:119], v5, s[4:7], s50 offen offset:512
    buffer_load_dwordx4 a[172:175], v5, s[4:7], s50 offen offset:640
    buffer_load_dwordx4 a[228:231], v5, s[4:7], s50 offen offset:1024
    buffer_load_dwordx4 v[148:151], v5, s[4:7], s50 offen offset:1152
    buffer_load_dwordx4 v[204:207], v6, s[4:7], s50 offen
    s_add_u32 s50, s50, 28672
    buffer_load_dwordx4 a[8:11], v5, s[4:7], s50 offen offset:0
    buffer_load_dwordx4 a[64:67], v5, s[4:7], s50 offen offset:128
    buffer_load_dwordx4 a[120:123], v5, s[4:7], s50 offen offset:512
    buffer_load_dwordx4 a[176:179], v5, s[4:7], s50 offen offset:640
    buffer_load_dwordx4 a[232:235], v5, s[4:7], s50 offen offset:1024
    buffer_load_dwordx4 v[152:155], v5, s[4:7], s50 offen offset:1152
    buffer_load_dwordx4 v[208:211], v6, s[4:7], s50 offen
    s_add_u32 s50, s50, 28672
    buffer_load_dwordx4 a[12:15], v5, s[4:7], s50 offen offset:0
    buffer_load_dwordx4 a[68:71], v5, s[4:7], s50 offen offset:128
    buffer_load_dwordx4 a[124:127], v5, s[4:7], s50 offen offset:512
    buffer_load_dwordx4 a[180:183], v5, s[4:7], s50 offen offset:640
    buffer_load_dwordx4 a[236:239], v5, s[4:7], s50 offen offset:1024
    buffer_load_dwordx4 v[156:159], v5, s[4:7], s50 offen offset:1152
    buffer_load_dwordx4 v[212:215], v6, s[4:7], s50 offen
    s_add_u32 s50, s50, 28672
    buffer_load_dwordx4 a[16:19], v5, s[4:7], s50 offen offset:0
    buffer_load_dwordx4 a[72:75], v5, s[4:7], s50 offen offset:128
    buffer_load_dwordx4 a[128:131], v5, s[4:7], s50 offen offset:512
    buffer_load_dwordx4 a[184:187], v5, s[4:7], s50 offen offset:640
    buffer_load_dwordx4 a[240:243], v5, s[4:7], s50 offen offset:1024
    buffer_load_dwordx4 v[160:163], v5, s[4:7], s50 offen offset:1152
    buffer_load_dwordx4 v[216:219], v6, s[4:7], s50 offen
    s_add_u32 s50, s50, 28672
    buffer_load_dwordx4 a[20:23], v5, s[4:7], s50 offen offset:0
    buffer_load_dwordx4 a[76:79], v5, s[4:7], s50 offen offset:128
    buffer_load_dwordx4 a[132:135], v5, s[4:7], s50 offen offset:512
    buffer_load_dwordx4 a[188:191], v5, s[4:7], s50 offen offset:640
    buffer_load_dwordx4 a[244:247], v5, s[4:7], s50 offen offset:1024
    buffer_load_dwordx4 v[164:167], v5, s[4:7], s50 offen offset:1152
    buffer_load_dwordx4 v[220:223], v6, s[4:7], s50 offen
    s_add_u32 s50, s50, 28672
    buffer_load_dwordx4 a[24:27], v5, s[4:7], s50 offen offset:0
    buffer_load_dwordx4 a[80:83], v5, s[4:7], s50 offen offset:128
    buffer_load_dwordx4 a[136:139], v5, s[4:7], s50 offen offset:512
    buffer_load_dwordx4 a[192:195], v5, s[4:7], s50 offen offset:640
    buffer_load_dwordx4 a[248:251], v5, s[4:7], s50 offen offset:1024
    buffer_load_dwordx4 v[168:171], v5, s[4:7], s50 offen offset:1152
    buffer_load_dwordx4 v[224:227], v6, s[4:7], s50 offen
    s_add_u32 s50, s50, 28672
    buffer_load_dwordx4 a[28:31], v5, s[4:7], s50 offen offset:0
    buffer_load_dwordx4 a[84:87], v5, s[4:7], s50 offen offset:128
    buffer_load_dwordx4 a[140:143], v5, s[4:7], s50 offen offset:512
    buffer_load_dwordx4 a[196:199], v5, s[4:7], s50 offen offset:640
    buffer_load_dwordx4 a[252:255], v5, s[4:7], s50 offen offset:1024
    buffer_load_dwordx4 v[172:175], v5, s[4:7], s50 offen offset:1152
    buffer_load_dwordx4 v[228:231], v6, s[4:7], s50 offen
    s_add_u32 s50, s50, 28672
    buffer_load_dwordx4 a[32:35], v5, s[4:7], s50 offen offset:0
    buffer_load_dwordx4 a[88:91], v5, s[4:7], s50 offen offset:128
    buffer_load_dwordx4 a[144:147], v5, s[4:7], s50 offen offset:512
    buffer_load_dwordx4 a[200:203], v5, s[4:7], s50 offen offset:640
    buffer_load_dwordx4 v[120:123], v5, s[4:7], s50 offen offset:1024
    buffer_load_dwordx4 v[176:179], v5, s[4:7], s50 offen offset:1152
    buffer_load_dwordx4 v[232:235], v6, s[4:7], s50 offen
    s_add_u32 s50, s50, 28672
    buffer_load_dwordx4 a[36:39], v5, s[4:7], s50 offen offset:0
    buffer_load_dwordx4 a[92:95], v5, s[4:7], s50 offen offset:128
    buffer_load_dwordx4 a[148:151], v5, s[4:7], s50 offen offset:512
    buffer_load_dwordx4 a[204:207], v5, s[4:7], s50 offen offset:640
    buffer_load_dwordx4 v[124:127], v5, s[4:7], s50 offen offset:1024
    buffer_load_dwordx4 v[180:183], v5, s[4:7], s50 offen offset:1152
    buffer_load_dwordx4 v[236:239], v6, s[4:7], s50 offen
    s_add_u32 s50, s50, 28672
    buffer_load_dwordx4 a[40:43], v5, s[4:7], s50 offen offset:0
    buffer_load_dwordx4 a[96:99], v5, s[4:7], s50 offen offset:128
    buffer_load_dwordx4 a[152:155], v5, s[4:7], s50 offen offset:512
    buffer_load_dwordx4 a[208:211], v5, s[4:7], s50 offen offset:640
    buffer_load_dwordx4 v[128:131], v5, s[4:7], s50 offen offset:1024
    buffer_load_dwordx4 v[184:187], v5, s[4:7], s50 offen offset:1152
    buffer_load_dwordx4 v[240:243], v6, s[4:7], s50 offen
    s_add_u32 s50, s50, 28672
    buffer_load_dwordx4 a[44:47], v5, s[4:7], s50 offen offset:0
    buffer_load_dwordx4 a[100:103], v5, s[4:7], s50 offen offset:128
    buffer_load_dwordx4 a[156:159], v5, s[4:7], s50 offen offset:512
    buffer_load_dwordx4 a[212:215], v5, s[4:7], s50 offen offset:640
    buffer_load_dwordx4 v[132:135], v5, s[4:7], s50 offen offset:1024
    buffer_load_dwordx4 v[188:191], v5, s[4:7], s50 offen offset:1152
    buffer_load_dwordx4 v[244:247], v6, s[4:7], s50 offen
    s_add_u32 s50, s50, 28672
    buffer_load_dwordx4 a[48:51], v5, s[4:7], s50 offen offset:0
    buffer_load_dwordx4 a[104:107], v5, s[4:7], s50 offen offset:128
    buffer_load_dwordx4 a[160:163], v5, s[4:7], s50 offen offset:512
    buffer_load_dwordx4 a[216:219], v5, s[4:7], s50 offen offset:640
    buffer_load_dwordx4 v[136:139], v5, s[4:7], s50 offen offset:1024
    buffer_load_dwordx4 v[192:195], v5, s[4:7], s50 offen offset:1152
    buffer_load_dwordx4 v[248:251], v6, s[4:7], s50 offen
    s_add_u32 s50, s50, 28672
    buffer_load_dwordx4 a[52:55], v5, s[4:7], s50 offen offset:0
    buffer_load_dwordx4 a[108:111], v5, s[4:7], s50 offen offset:128
    buffer_load_dwordx4 a[164:167], v5, s[4:7], s50 offen offset:512
    buffer_load_dwordx4 a[220:223], v5, s[4:7], s50 offen offset:640
    buffer_load_dwordx4 v[140:143], v5, s[4:7], s50 offen offset:1024
    buffer_load_dwordx4 v[196:199], v5, s[4:7], s50 offen offset:1152
    buffer_load_dwordx4 v[252:255], v6, s[4:7], s50 offen
    s_add_u32 s50, s50, 28672
    v_lshrrev_b32 v112, 1, v3
    v_lshlrev_b32 v112, 8, v112
    v_bfe_u32 v7, v2, 1, 2
    v_lshl_add_u32 v112, v7, 6, v112
    v_and_b32 v7, 1, v2
    v_lshl_add_u32 v112, v7, 4, v112
    v_and_b32 v7, 1, v3
    v_lshl_add_u32 v112, v7, 3, v112
    s_mul_i32 s28, s24, 6144
    v_add_u32 v113, s28, v4
    s_mul_i32 s28, s24, 3072
    v_add_u32 v114, s28, v4
    s_lshl_b32 s28, s24, 4
    v_add_u32 v115, s28, v2
    v_lshlrev_b32 v7, 2, v3
    v_sub_u32 v115, v115, v7
    v_lshlrev_b32 v118, 4, v2
    v_lshl_add_u32 v118, v3, 2, v118
    v_mov_b32 v116, 0
    v_mov_b32 v117, s48
    s_not_b32 s51, s34
    s_cmp_lg_u32 s31, 5
    s_cbranch_scc1 K2_T_rdy
    v_lshlrev_b32 v12, 7, v1
Lsw_94:
    buffer_load_dwordx4 v[8:11], v12, s[4:7], s49 offen sc1
Lse_96:
    s_waitcnt vmcnt(0)
    v_xor_b32 v8, s48, v8
    v_xor_b32 v9, s48, v9
    v_xor_b32 v10, s48, v10
    v_xor_b32 v11, s48, v11
    v_or3_b32 v8, v8, v9, v10
    v_or_b32 v8, v8, v11
    v_cmp_lt_u32 vcc, 1, v8
    s_cbranch_vccz Lsd_95
    s_sleep 1
    s_sub_u32 s27, s27, 1
    s_cbranch_scc1 K2_end
    s_branch Lsw_94
Lsd_95:
K2_T_rdy:
    s_mov_b32 s38, 0
    s_mov_b32 s39, 0
    s_mul_i32 s36, s26, 28672
    s_mul_i32 s37, s24, 7168
    s_add_u32 s36, s36, s37
    s_add_u32 m0, s38, s37
    s_nop 0
    buffer_load_dwordx4 v4, s[4:7], s36 offen offset:0 lds
    buffer_load_dwordx4 v4, s[4:7], s36 offen offset:1024 lds
    buffer_load_dwordx4 v4, s[4:7], s36 offen offset:2048 lds
    buffer_load_dwordx4 v4, s[4:7], s36 offen offset:3072 lds
    s_add_u32 s36, s36, 4096
    s_add_u32 m0, m0, 4096
    s_nop 0
    buffer_load_dwordx4 v4, s[4:7], s36 offen offset:0 lds
    buffer_load_dwordx4 v4, s[4:7], s36 offen offset:1024 lds
    buffer_load_dwordx4 v4, s[4:7], s36 offen offset:2048 lds
    s_waitcnt vmcnt(0)
    s_branch K2_T_go
K2_T_loop:
    s_waitcnt vmcnt(3)
K2_T_go:
    s_barrier
    v_add_u32 v5, s38, v4
    s_xor_b32 s38, s38, 28672
    s_add_u32 s61, s26, 4
    s_min_u32 s61, s61, 63
    s_cmp_eq_u32 s26, 64
    s_cselect_b32 s61, 0, s61
    s_mul_i32 s36, s61, 28672
    s_mul_i32 s37, s24, 7168
    s_add_u32 s36, s36, s37
    s_add_u32 m0, s38, s37
    s_nop 0
    buffer_load_dwordx4 v4, s[4:7], s36 offen offset:0 lds
    buffer_load_dwordx4 v4, s[4:7], s36 offen offset:1024 lds
    buffer_load_dwordx4 v4, s[4:7], s36 offen offset:2048 lds
    buffer_load_dwordx4 v4, s[4:7], s36 offen offset:3072 lds
    s_add_u32 s36, s36, 4096
    s_add_u32 m0, m0, 4096
    s_nop 0
    buffer_load_dwordx4 v4, s[4:7], s36 offen offset:0 lds
    buffer_load_dwordx4 v4, s[4:7], s36 offen offset:1024 lds
    buffer_load_dwordx4 v4, s[4:7], s36 offen offset:2048 lds
    ds_read_b128 v[64:67], v5 offset:0
    ds_read_b128 v[68:71], v5 offset:14336
    ds_read_b128 v[72:75], v5 offset:1024
    ds_read_b128 v[76:79], v5 offset:15360
    s_waitcnt lgkmcnt(2)
    v_mfma_f32_16x16x32_bf16 v[8:11], a[0:3], v[64:67], 0
    v_mfma_f32_16x16x32_bf16 v[12:15], a[0:3], v[68:71], 0
    v_mfma_f32_16x16x32_bf16 v[16:19], a[56:59], v[64:67], 0
    v_mfma_f32_16x16x32_bf16 v[20:23], a[56:59], v[68:71], 0
    v_mfma_f32_16x16x32_bf16 v[24:27], a[112:115], v[64:67], 0
    v_mfma_f32_16x16x32_bf16 v[28:31], a[112:115], v[68:71], 0
    v_mfma_f32_16x16x32_bf16 v[32:35], a[168:171], v[64:67], 0
    v_mfma_f32_16x16x32_bf16 v[36:39], a[168:171], v[68:71], 0
    v_mfma_f32_16x16x32_bf16 v[40:43], a[224:227], v[64:67], 0
    v_mfma_f32_16x16x32_bf16 v[44:47], a[224:227], v[68:71], 0
    v_mfma_f32_16x16x32_bf16 v[48:51], v[144:147], v[64:67], 0
    v_mfma_f32_16x16x32_bf16 v[52:55], v[144:147], v[68:71], 0
    v_mfma_f32_16x16x32_bf16 v[56:59], v[200:203], v[64:67], 0
    v_mfma_f32_16x16x32_bf16 v[60:63], v[200:203], v[68:71], 0
    ds_read_b128 v[64:67], v5 offset:2048
    ds_read_b128 v[68:71], v5 offset:16384
    s_waitcnt lgkmcnt(2)
    v_mfma_f32_16x16x32_bf16 v[8:11], a[4:7], v[72:75], v[8:11]
    v_mfma_f32_16x16x32_bf16 v[12:15], a[4:7], v[76:79], v[12:15]
    v_mfma_f32_16x16x32_bf16 v[16:19], a[60:63], v[72:75], v[16:19]
    v_mfma_f32_16x16x32_bf16 v[20:23], a[60:63], v[76:79], v[20:23]
    v_mfma_f32_16x16x32_bf16 v[24:27], a[116:119], v[72:75], v[24:27]
    v_mfma_f32_16x16x32_bf16 v[28:31], a[116:119], v[76:79], v[28:31]
    v_mfma_f32_16x16x32_bf16 v[32:35], a[172:175], v[72:75], v[32:35]
    v_mfma_f32_16x16x32_bf16 v[36:39], a[172:175], v[76:79], v[36:39]
    v_mfma_f32_16x16x32_bf16 v[40:43], a[228:231], v[72:75], v[40:43]
    v_mfma_f32_16x16x32_bf16 v[44:47], a[228:231], v[76:79], v[44:47]
    v_mfma_f32_16x16x32_bf16 v[48:51], v[148:151], v[72:75], v[48:51]
    v_mfma_f32_16x16x32_bf16 v[52:55], v[148:151], v[76:79], v[52:55]
    v_mfma_f32_16x16x32_bf16 v[56:59], v[204:207], v[72:75], v[56:59]
    v_mfma_f32_16x16x32_bf16 v[60:63], v[204:207], v[76:79], v[60:63]
    ds_read_b128 v[72:75], v5 offset:3072
    ds_read_b128 v[76:79], v5 offset:17408
    s_waitcnt lgkmcnt(2)
    v_mfma_f32_16x16x32_bf16 v[8:11], a[8:11], v[64:67], v[8:11]
    v_mfma_f32_16x16x32_bf16 v[12:15], a[8:11], v[68:71], v[12:15]
    v_mfma_f32_16x16x32_bf16 v[16:19], a[64:67], v[64:67], v[16:19]
    v_mfma_f32_16x16x32_bf16 v[20:23], a[64:67], v[68:71], v[20:23]
    v_mfma_f32_16x16x32_bf16 v[24:27], a[120:123], v[64:67], v[24:27]
    v_mfma_f32_16x16x32_bf16 v[28:31], a[120:123], v[68:71], v[28:31]
    v_mfma_f32_16x16x32_bf16 v[32:35], a[176:179], v[64:67], v[32:35]
    v_mfma_f32_16x16x32_bf16 v[36:39], a[176:179], v[68:71], v[36:39]
    v_mfma_f32_16x16x32_bf16 v[40:43], a[232:235], v[64:67], v[40:43]
    v_mfma_f32_16x16x32_bf16 v[44:47], a[232:235], v[68:71], v[44:47]
    v_mfma_f32_16x16x32_bf16 v[48:51], v[152:155], v[64:67], v[48:51]
    v_mfma_f32_16x16x32_bf16 v[52:55], v[152:155], v[68:71], v[52:55]
    v_mfma_f32_16x16x32_bf16 v[56:59], v[208:211], v[64:67], v[56:59]
    v_mfma_f32_16x16x32_bf16 v[60:63], v[208:211], v[68:71], v[60:63]
    ds_read_b128 v[64:67], v5 offset:4096
    ds_read_b128 v[68:71], v5 offset:18432
    s_waitcnt lgkmcnt(2)
    v_mfma_f32_16x16x32_bf16 v[8:11], a[12:15], v[72:75], v[8:11]
    v_mfma_f32_16x16x32_bf16 v[12:15], a[12:15], v[76:79], v[12:15]
    v_mfma_f32_16x16x32_bf16 v[16:19], a[68:71], v[72:75], v[16:19]
    v_mfma_f32_16x16x32_bf16 v[20:23], a[68:71], v[76:79], v[20:23]
    v_mfma_f32_16x16x32_bf16 v[24:27], a[124:127], v[72:75], v[24:27]
    v_mfma_f32_16x16x32_bf16 v[28:31], a[124:127], v[76:79], v[28:31]
    v_mfma_f32_16x16x32_bf16 v[32:35], a[180:183], v[72:75], v[32:35]
    v_mfma_f32_16x16x32_bf16 v[36:39], a[180:183], v[76:79], v[36:39]
    v_mfma_f32_16x16x32_bf16 v[40:43], a[236:239], v[72:75], v[40:43]
    v_mfma_f32_16x16x32_bf16 v[44:47], a[236:239], v[76:79], v[44:47]
    v_mfma_f32_16x16x32_bf16 v[48:51], v[156:159], v[72:75], v[48:51]
    v_mfma_f32_16x16x32_bf16 v[52:55], v[156:159], v[76:79], v[52:55]
    v_mfma_f32_16x16x32_bf16 v[56:59], v[212:215], v[72:75], v[56:59]
    v_mfma_f32_16x16x32_bf16 v[60:63], v[212:215], v[76:79], v[60:63]
    ds_read_b128 v[72:75], v5 offset:5120
    ds_read_b128 v[76:79], v5 offset:19456
    s_waitcnt lgkmcnt(2)
    v_mfma_f32_16x16x32_bf16 v[8:11], a[16:19], v[64:67], v[8:11]
    v_mfma_f32_16x16x32_bf16 v[12:15], a[16:19], v[68:71], v[12:15]
    v_mfma_f32_16x16x32_bf16 v[16:19], a[72:75], v[64:67], v[16:19]
    v_mfma_f32_16x16x32_bf16 v[20:23], a[72:75], v[68:71], v[20:23]
    v_mfma_f32_16x16x32_bf16 v[24:27], a[128:131], v[64:67], v[24:27]
    v_mfma_f32_16x16x32_bf16 v[28:31], a[128:131], v[68:71], v[28:31]
    v_mfma_f32_16x16x32_bf16 v[32:35], a[184:187], v[64:67], v[32:35]
    v_mfma_f32_16x16x32_bf16 v[36:39], a[184:187], v[68:71], v[36:39]
    v_mfma_f32_16x16x32_bf16 v[40:43], a[240:243], v[64:67], v[40:43]
    v_mfma_f32_16x16x32_bf16 v[44:47], a[240:243], v[68:71], v[44:47]
    v_mfma_f32_16x16x32_bf16 v[48:51], v[160:163], v[64:67], v[48:51]
    v_mfma_f32_16x16x32_bf16 v[52:55], v[160:163], v[68:71], v[52:55]
    v_mfma_f32_16x16x32_bf16 v[56:59], v[216:219], v[64:67], v[56:59]
    v_mfma_f32_16x16x32_bf16 v[60:63], v[216:219], v[68:71], v[60:63]
    ds_read_b128 v[64:67], v5 offset:6144
    ds_read_b128 v[68:71], v5 offset:20480
    s_waitcnt lgkmcnt(2)
    v_mfma_f32_16x16x32_bf16 v[8:11], a[20:23], v[72:75], v[8:11]
    v_mfma_f32_16x16x32_bf16 v[12:15], a[20:23], v[76:79], v[12:15]
    v_mfma_f32_16x16x32_bf16 v[16:19], a[76:79], v[72:75], v[16:19]
    v_mfma_f32_16x16x32_bf16 v[20:23], a[76:79], v[76:79], v[20:23]
    v_mfma_f32_16x16x32_bf16 v[24:27], a[132:135], v[72:75], v[24:27]
    v_mfma_f32_16x16x32_bf16 v[28:31], a[132:135], v[76:79], v[28:31]
    v_mfma_f32_16x16x32_bf16 v[32:35], a[188:191], v[72:75], v[32:35]
    v_mfma_f32_16x16x32_bf16 v[36:39], a[188:191], v[76:79], v[36:39]
    v_mfma_f32_16x16x32_bf16 v[40:43], a[244:247], v[72:75], v[40:43]
    v_mfma_f32_16x16x32_bf16 v[44:47], a[244:247], v[76:79], v[44:47]
    v_mfma_f32_16x16x32_bf16 v[48:51], v[164:167], v[72:75], v[48:51]
    v_mfma_f32_16x16x32_bf16 v[52:55], v[164:167], v[76:79], v[52:55]
    v_mfma_f32_16x16x32_bf16 v[56:59], v[220:223], v[72:75], v[56:59]
    v_mfma_f32_16x16x32_bf16 v[60:63], v[220:223], v[76:79], v[60:63]
    ds_read_b128 v[72:75], v5 offset:7168
    ds_read_b128 v[76:79], v5 offset:21504
    s_waitcnt lgkmcnt(2)
    v_mfma_f32_16x16x32_bf16 v[8:11], a[24:27], v[64:67], v[8:11]
    v_mfma_f32_16x16x32_bf16 v[12:15], a[24:27], v[68:71], v[12:15]
    v_mfma_f32_16x16x32_bf16 v[16:19], a[80:83], v[64:67], v[16:19]
    v_mfma_f32_16x16x32_bf16 v[20:23], a[80:83], v[68:71], v[20:23]
    v_mfma_f32_16x16x32_bf16 v[24:27], a[136:139], v[64:67], v[24:27]
    v_mfma_f32_16x16x32_bf16 v[28:31], a[136:139], v[68:71], v[28:31]
    v_mfma_f32_16x16x32_bf16 v[32:35], a[192:195], v[64:67], v[32:35]
    v_mfma_f32_16x16x32_bf16 v[36:39], a[192:195], v[68:71], v[36:39]
    v_mfma_f32_16x16x32_bf16 v[40:43], a[248:251], v[64:67], v[40:43]
    v_mfma_f32_16x16x32_bf16 v[44:47], a[248:251], v[68:71], v[44:47]
    v_mfma_f32_16x16x32_bf16 v[48:51], v[168:171], v[64:67], v[48:51]
    v_mfma_f32_16x16x32_bf16 v[52:55], v[168:171], v[68:71], v[52:55]
    v_mfma_f32_16x16x32_bf16 v[56:59], v[224:227], v[64:67], v[56:59]
    v_mfma_f32_16x16x32_bf16 v[60:63], v[224:227], v[68:71], v[60:63]
    s_cmp_eq_u32 s39, 0
    s_cbranch_scc1 Lpf_98
    s_waitcnt vmcnt(7)
    s_mov_b64 exec, 1
    buffer_store_dword v117, v116, s[4:7], s39 offen sc1
    s_mov_b64 exec, -1
Lpf_98:
    ds_read_b128 v[64:67], v5 offset:8192
    ds_read_b128 v[68:71], v5 offset:22528
    s_waitcnt lgkmcnt(2)
    v_mfma_f32_16x16x32_bf16 v[8:11], a[28:31], v[72:75], v[8:11]
    v_mfma_f32_16x16x32_bf16 v[12:15], a[28:31], v[76:79], v[12:15]
    v_mfma_f32_16x16x32_bf16 v[16:19], a[84:87], v[72:75], v[16:19]
    v_mfma_f32_16x16x32_bf16 v[20:23], a[84:87], v[76:79], v[20:23]
    v_mfma_f32_16x16x32_bf16 v[24:27], a[140:143], v[72:75], v[24:27]
    v_mfma_f32_16x16x32_bf16 v[28:31], a[140:143], v[76:79], v[28:31]
    v_mfma_f32_16x16x32_bf16 v[32:35], a[196:199], v[72:75], v[32:35]
    v_mfma_f32_16x16x32_bf16 v[36:39], a[196:199], v[76:79], v[36:39]
    v_mfma_f32_16x16x32_bf16 v[40:43], a[252:255], v[72:75], v[40:43]
    v_mfma_f32_16x16x32_bf16 v[44:47], a[252:255], v[76:79], v[44:47]
    v_mfma_f32_16x16x32_bf16 v[48:51], v[172:175], v[72:75], v[48:51]
    v_mfma_f32_16x16x32_bf16 v[52:55], v[172:175], v[76:79], v[52:55]
    v_mfma_f32_16x16x32_bf16 v[56:59], v[228:231], v[72:75], v[56:59]
    v_mfma_f32_16x16x32_bf16 v[60:63], v[228:231], v[76:79], v[60:63]
    ds_read_b128 v[72:75], v5 offset:9216
    ds_read_b128 v[76:79], v5 offset:23552
    s_waitcnt lgkmcnt(2)
    v_mfma_f32_16x16x32_bf16 v[8:11], a[32:35], v[64:67], v[8:11]
    v_mfma_f32_16x16x32_bf16 v[12:15], a[32:35], v[68:71], v[12:15]
    v_mfma_f32_16x16x32_bf16 v[16:19], a[88:91], v[64:67], v[16:19]
    v_mfma_f32_16x16x32_bf16 v[20:23], a[88:91], v[68:71], v[20:23]
    v_mfma_f32_16x16x32_bf16 v[24:27], a[144:147], v[64:67], v[24:27]
    v_mfma_f32_16x16x32_bf16 v[28:31], a[144:147], v[68:71], v[28:31]
    v_mfma_f32_16x16x32_bf16 v[32:35], a[200:203], v[64:67], v[32:35]
    v_mfma_f32_16x16x32_bf16 v[36:39], a[200:203], v[68:71], v[36:39]
    v_mfma_f32_16x16x32_bf16 v[40:43], v[120:123], v[64:67], v[40:43]
    v_mfma_f32_16x16x32_bf16 v[44:47], v[120:123], v[68:71], v[44:47]
    v_mfma_f32_16x16x32_bf16 v[48:51], v[176:179], v[64:67], v[48:51]
    v_mfma_f32_16x16x32_bf16 v[52:55], v[176:179], v[68:71], v[52:55]
    v_mfma_f32_16x16x32_bf16 v[56:59], v[232:235], v[64:67], v[56:59]
    v_mfma_f32_16x16x32_bf16 v[60:63], v[232:235], v[68:71], v[60:63]
    ds_read_b128 v[64:67], v5 offset:10240
    ds_read_b128 v[68:71], v5 offset:24576
    s_waitcnt lgkmcnt(2)
    v_mfma_f32_16x16x32_bf16 v[8:11], a[36:39], v[72:75], v[8:11]
    v_mfma_f32_16x16x32_bf16 v[12:15], a[36:39], v[76:79], v[12:15]
    v_mfma_f32_16x16x32_bf16 v[16:19], a[92:95], v[72:75], v[16:19]
    v_mfma_f32_16x16x32_bf16 v[20:23], a[92:95], v[76:79], v[20:23]
    v_mfma_f32_16x16x32_bf16 v[24:27], a[148:151], v[72:75], v[24:27]
    v_mfma_f32_16x16x32_bf16 v[28:31], a[148:151], v[76:79], v[28:31]
    v_mfma_f32_16x16x32_bf16 v[32:35], a[204:207], v[72:75], v[32:35]
    v_mfma_f32_16x16x32_bf16 v[36:39], a[204:207], v[76:79], v[36:39]
    v_mfma_f32_16x16x32_bf16 v[40:43], v[124:127], v[72:75], v[40:43]
    v_mfma_f32_16x16x32_bf16 v[44:47], v[124:127], v[76:79], v[44:47]
    v_mfma_f32_16x16x32_bf16 v[48:51], v[180:183], v[72:75], v[48:51]
    v_mfma_f32_16x16x32_bf16 v[52:55], v[180:183], v[76:79], v[52:55]
    v_mfma_f32_16x16x32_bf16 v[56:59], v[236:239], v[72:75], v[56:59]
    v_mfma_f32_16x16x32_bf16 v[60:63], v[236:239], v[76:79], v[60:63]
    ds_read_b128 v[72:75], v5 offset:11264
    ds_read_b128 v[76:79], v5 offset:25600
    s_waitcnt lgkmcnt(2)
    v_mfma_f32_16x16x32_bf16 v[8:11], a[40:43], v[64:67], v[8:11]
    v_mfma_f32_16x16x32_bf16 v[12:15], a[40:43], v[68:71], v[12:15]
    v_mfma_f32_16x16x32_bf16 v[16:19], a[96:99], v[64:67], v[16:19]
    v_mfma_f32_16x16x32_bf16 v[20:23], a[96:99], v[68:71], v[20:23]
    v_mfma_f32_16x16x32_bf16 v[24:27], a[152:155], v[64:67], v[24:27]
    v_mfma_f32_16x16x32_bf16 v[28:31], a[152:155], v[68:71], v[28:31]
    v_mfma_f32_16x16x32_bf16 v[32:35], a[208:211], v[64:67], v[32:35]
    v_mfma_f32_16x16x32_bf16 v[36:39], a[208:211], v[68:71], v[36:39]
    v_mfma_f32_16x16x32_bf16 v[40:43], v[128:131], v[64:67], v[40:43]
    v_mfma_f32_16x16x32_bf16 v[44:47], v[128:131], v[68:71], v[44:47]
    v_mfma_f32_16x16x32_bf16 v[48:51], v[184:187], v[64:67], v[48:51]
    v_mfma_f32_16x16x32_bf16 v[52:55], v[184:187], v[68:71], v[52:55]
    v_mfma_f32_16x16x32_bf16 v[56:59], v[240:243], v[64:67], v[56:59]
    v_mfma_f32_16x16x32_bf16 v[60:63], v[240:243], v[68:71], v[60:63]
    ds_read_b128 v[64:67], v5 offset:12288
    ds_read_b128 v[68:71], v5 offset:26624
    s_waitcnt lgkmcnt(2)
    v_mfma_f32_16x16x32_bf16 v[8:11], a[44:47], v[72:75], v[8:11]
    v_mfma_f32_16x16x32_bf16 v[12:15], a[44:47], v[76:79], v[12:15]
    v_mfma_f32_16x16x32_bf16 v[16:19], a[100:103], v[72:75], v[16:19]
    v_mfma_f32_16x16x32_bf16 v[20:23], a[100:103], v[76:79], v[20:23]
    v_mfma_f32_16x16x32_bf16 v[24:27], a[156:159], v[72:75], v[24:27]
    v_mfma_f32_16x16x32_bf16 v[28:31], a[156:159], v[76:79], v[28:31]
    v_mfma_f32_16x16x32_bf16 v[32:35], a[212:215], v[72:75], v[32:35]
    v_mfma_f32_16x16x32_bf16 v[36:39], a[212:215], v[76:79], v[36:39]
    v_mfma_f32_16x16x32_bf16 v[40:43], v[132:135], v[72:75], v[40:43]
    v_mfma_f32_16x16x32_bf16 v[44:47], v[132:135], v[76:79], v[44:47]
    v_mfma_f32_16x16x32_bf16 v[48:51], v[188:191], v[72:75], v[48:51]
    v_mfma_f32_16x16x32_bf16 v[52:55], v[188:191], v[76:79], v[52:55]
    v_mfma_f32_16x16x32_bf16 v[56:59], v[244:247], v[72:75], v[56:59]
    v_mfma_f32_16x16x32_bf16 v[60:63], v[244:247], v[76:79], v[60:63]
    ds_read_b128 v[72:75], v5 offset:13312
    ds_read_b128 v[76:79], v5 offset:27648
    s_waitcnt lgkmcnt(2)
    v_mfma_f32_16x16x32_bf16 v[8:11], a[48:51], v[64:67], v[8:11]
    v_mfma_f32_16x16x32_bf16 v[12:15], a[48:51], v[68:71], v[12:15]
    v_mfma_f32_16x16x32_bf16 v[16:19], a[104:107], v[64:67], v[16:19]
    v_mfma_f32_16x16x32_bf16 v[20:23], a[104:107], v[68:71], v[20:23]
    v_mfma_f32_16x16x32_bf16 v[24:27], a[160:163], v[64:67], v[24:27]
    v_mfma_f32_16x16x32_bf16 v[28:31], a[160:163], v[68:71], v[28:31]
    v_mfma_f32_16x16x32_bf16 v[32:35], a[216:219], v[64:67], v[32:35]
    v_mfma_f32_16x16x32_bf16 v[36:39], a[216:219], v[68:71], v[36:39]
    v_mfma_f32_16x16x32_bf16 v[40:43], v[136:139], v[64:67], v[40:43]
    v_mfma_f32_16x16x32_bf16 v[44:47], v[136:139], v[68:71], v[44:47]
    v_mfma_f32_16x16x32_bf16 v[48:51], v[192:195], v[64:67], v[48:51]
    v_mfma_f32_16x16x32_bf16 v[52:55], v[192:195], v[68:71], v[52:55]
    v_mfma_f32_16x16x32_bf16 v[56:59], v[248:251], v[64:67], v[56:59]
    v_mfma_f32_16x16x32_bf16 v[60:63], v[248:251], v[68:71], v[60:63]
    s_waitcnt lgkmcnt(0)
    v_mfma_f32_16x16x32_bf16 v[8:11], a[52:55], v[72:75], v[8:11]
    v_mfma_f32_16x16x32_bf16 v[12:15], a[52:55], v[76:79], v[12:15]
    v_mfma_f32_16x16x32_bf16 v[16:19], a[108:111], v[72:75], v[16:19]
    v_mfma_f32_16x16x32_bf16 v[20:23], a[108:111], v[76:79], v[20:23]
    v_mfma_f32_16x16x32_bf16 v[24:27], a[164:167], v[72:75], v[24:27]
    v_mfma_f32_16x16x32_bf16 v[28:31], a[164:167], v[76:79], v[28:31]
    v_mfma_f32_16x16x32_bf16 v[32:35], a[220:223], v[72:75], v[32:35]
    v_mfma_f32_16x16x32_bf16 v[36:39], a[220:223], v[76:79], v[36:39]
    v_mfma_f32_16x16x32_bf16 v[40:43], v[140:143], v[72:75], v[40:43]
    v_mfma_f32_16x16x32_bf16 v[44:47], v[140:143], v[76:79], v[44:47]
    v_mfma_f32_16x16x32_bf16 v[48:51], v[196:199], v[72:75], v[48:51]
    v_mfma_f32_16x16x32_bf16 v[52:55], v[196:199], v[76:79], v[52:55]
    v_mfma_f32_16x16x32_bf16 v[56:59], v[252:255], v[72:75], v[56:59]
    v_mfma_f32_16x16x32_bf16 v[60:63], v[252:255], v[76:79], v[60:63]
    s_nop 7
    v_cvt_pk_bf16_f32 v80, v8, v9
    v_cvt_pk_bf16_f32 v81, v16, v17
    v_cvt_pk_bf16_f32 v82, v10, v11
    v_cvt_pk_bf16_f32 v83, v18, v19
    v_cvt_pk_bf16_f32 v84, v12, v13
    v_cvt_pk_bf16_f32 v85, v20, v21
    v_cvt_pk_bf16_f32 v86, v14, v15
    v_cvt_pk_bf16_f32 v87, v22, v23
    v_cvt_pk_bf16_f32 v88, v24, v25
    v_cvt_pk_bf16_f32 v89, v32, v33
    v_cvt_pk_bf16_f32 v90, v26, v27
    v_cvt_pk_bf16_f32 v91, v34, v35
    v_cvt_pk_bf16_f32 v92, v28, v29
    v_cvt_pk_bf16_f32 v93, v36, v37
    v_cvt_pk_bf16_f32 v94, v30, v31
    v_cvt_pk_bf16_f32 v95, v38, v39
    v_cvt_pk_bf16_f32 v96, v40, v41
    v_cvt_pk_bf16_f32 v97, v48, v49
    v_cvt_pk_bf16_f32 v98, v42, v43
    v_cvt_pk_bf16_f32 v99, v50, v51
    v_cvt_pk_bf16_f32 v100, v44, v45
    v_cvt_pk_bf16_f32 v101, v52, v53
    v_cvt_pk_bf16_f32 v102, v46, v47
    v_cvt_pk_bf16_f32 v103, v54, v55
    v_cvt_pk_bf16_f32 v104, v56, v57
    v_cvt_pk_bf16_f32 v106, v58, v59
    v_and_b32 v105, s51, v104
    v_and_b32 v107, s51, v106
    v_and_b32 v104, s34, v104
    v_and_b32 v106, s34, v106
    v_cvt_pk_bf16_f32 v108, v60, v61
    v_cvt_pk_bf16_f32 v110, v62, v63
    v_and_b32 v109, s51, v108
    v_and_b32 v111, s51, v110
    v_and_b32 v108, s34, v108
    v_and_b32 v110, s34, v110
    v_mov_b32 v119, v115
    s_cmp_lg_u32 s26, 64
    s_cbranch_scc1 K2_T_keys
    v_add_u32 v5, s38, v4
    v_mov_b32 v119, 64
    s_waitcnt vmcnt(0)
    s_barrier
K2_T_keys:
    s_lshl_b32 s28, s32, 10
    v_add_u32 v6, s28, v5
    s_lshl_b32 s28, s33, 10
    v_add_u32 v7, s28, v5
    ds_read_b128 v[8:11], v6 offset:0
    ds_read_b128 v[12:15], v6 offset:14336
    ds_read_b128 v[16:19], v6 offset:1024
    ds_read_b128 v[20:23], v6 offset:15360
    ds_read_b128 v[24:27], v6 offset:2048
    ds_read_b128 v[28:31], v6 offset:16384
    ds_read_b128 v[32:35], v7 offset:0
    ds_read_b128 v[36:39], v7 offset:14336
    s_waitcnt lgkmcnt(0)
    v_mfma_f32_16x16x32_bf16 v[40:43], v[8:11], v[80:83], 0
    v_mfma_f32_16x16x32_bf16 v[52:55], v[8:11], v[84:87], 0
    v_mfma_f32_16x16x32_bf16 v[56:59], v[12:15], v[84:87], 0
    v_mfma_f32_16x16x32_bf16 v[40:43], v[16:19], v[88:91], v[40:43]
    v_mfma_f32_16x16x32_bf16 v[52:55], v[16:19], v[92:95], v[52:55]
    v_mfma_f32_16x16x32_bf16 v[56:59], v[20:23], v[92:95], v[56:59]
    v_mfma_f32_16x16x32_bf16 v[40:43], v[24:27], v[96:99], v[40:43]
    v_mfma_f32_16x16x32_bf16 v[52:55], v[24:27], v[100:103], v[52:55]
    v_mfma_f32_16x16x32_bf16 v[56:59], v[28:31], v[100:103], v[56:59]
    v_mfma_f32_16x16x32_bf16 v[40:43], v[32:35], v[104:107], v[40:43]
    v_mfma_f32_16x16x32_bf16 v[52:55], v[32:35], v[108:111], v[52:55]
    v_mfma_f32_16x16x32_bf16 v[56:59], v[36:39], v[108:111], v[56:59]
    s_nop 7
    ds_write_b128 v113, v[40:43] offset:57344
    ds_write_b128 v113, v[52:55] offset:60416
    ds_write_b128 v113, v[56:59] offset:61440
    v_add_u32 v7, 57344, v114
    s_waitcnt lgkmcnt(0)
    s_barrier
    s_cmp_ge_u32 s24, 2
    s_cbranch_scc1 Ltp_99
    ds_read_b128 v[8:11], v7 offset:0
    ds_read_b128 v[12:15], v7 offset:1024
    ds_read_b128 v[20:23], v7 offset:6144
    ds_read_b128 v[24:27], v7 offset:7168
    ds_read_b128 v[28:31], v7 offset:12288
    ds_read_b128 v[32:35], v7 offset:13312
    ds_read_b128 v[64:67], v7 offset:18432
    ds_read_b128 v[68:71], v7 offset:19456
    s_waitcnt lgkmcnt(0)
    v_pk_add_f32 v[8:9], v[8:9], v[20:21]
    v_pk_add_f32 v[28:29], v[28:29], v[64:65]
    v_pk_add_f32 v[8:9], v[8:9], v[28:29]
    v_pk_add_f32 v[10:11], v[10:11], v[22:23]
    v_pk_add_f32 v[30:31], v[30:31], v[66:67]
    v_pk_add_f32 v[10:11], v[10:11], v[30:31]
    v_pk_add_f32 v[12:13], v[12:13], v[24:25]
    v_pk_add_f32 v[32:33], v[32:33], v[68:69]
    v_pk_add_f32 v[12:13], v[12:13], v[32:33]
    v_pk_add_f32 v[14:15], v[14:15], v[26:27]
    v_pk_add_f32 v[34:35], v[34:35], v[70:71]
    v_pk_add_f32 v[14:15], v[14:15], v[34:35]
    v_mov_b32 v56, 0xff800000
    v_cmp_le_i32 vcc, 0, v119
    s_nop 1
    v_cndmask_b32 v8, v56, v8, vcc
    v_cmp_le_i32 vcc, 1, v119
    s_nop 1
    v_cndmask_b32 v9, v56, v9, vcc
    v_cmp_le_i32 vcc, 2, v119
    s_nop 1
    v_cndmask_b32 v10, v56, v10, vcc
    v_cmp_le_i32 vcc, 3, v119
    s_nop 1
    v_cndmask_b32 v11, v56, v11, vcc
    v_cmp_le_i32 vcc, 16, v119
    s_nop 1
    v_cndmask_b32 v12, v56, v12, vcc
    v_cmp_le_i32 vcc, 17, v119
    s_nop 1
    v_cndmask_b32 v13, v56, v13, vcc
    v_cmp_le_i32 vcc, 18, v119
    s_nop 1
    v_cndmask_b32 v14, v56, v14, vcc
    v_cmp_le_i32 vcc, 19, v119
    s_nop 1
    v_cndmask_b32 v15, v56, v15, vcc
Ltp_99:
    s_and_b32 s52, s26, 63
    s_mul_i32 s52, s52, 7168
    s_lshl_b32 s28, s24, 11
    s_add_u32 s52, s52, s28
    s_add_u32 s52, s52, 70254592
    s_cmp_eq_u32 s24, 3
    s_cselect_b32 s53, 0, 1024
    s_add_u32 s53, s53, s52
    s_add_u32 s28, s28, 81920
    v_add_u32 v6, s28, v4
Ltm_100:
    buffer_load_dwordx4 v[20:23], v4, s[4:7], s52 offen sc1
    buffer_load_dwordx4 v[24:27], v4, s[4:7], s53 offen sc1
    s_waitcnt vmcnt(0)
    v_max3_u32 v28, v20, v21, v22
    v_max3_u32 v29, v23, v24, v25
    v_max3_u32 v28, v28, v26, v27
    v_max_u32 v28, v28, v29
    v_cmp_eq_u32 vcc, -1, v28
    s_cbranch_vccz Ltg_101
    s_sleep 4
    s_sub_u32 s27, s27, 1
    s_cbranch_scc1 K2_end
    s_branch Ltm_100
Ltg_101:
    ds_write_b128 v6, v[20:23]
    ds_write_b128 v6, v[24:27] offset:1024
    s_lshl_b32 s28, s32, 9
    s_add_u32 s28, s28, 81920
    v_add_u32 v28, s28, v112
    s_lshl_b32 s28, s33, 9
    s_add_u32 s28, s28, 81920
    v_add_u32 v29, s28, v112
    s_waitcnt lgkmcnt(0)
    s_barrier
    ds_read_b64 v[64:65], v28 offset:0
    ds_read_b64 v[66:67], v28 offset:32
    ds_read_b64 v[68:69], v28 offset:512
    ds_read_b64 v[70:71], v28 offset:544
    ds_read_b64 v[72:73], v28 offset:1024
    ds_read_b64 v[74:75], v28 offset:1056
    ds_read_b64 v[76:77], v29 offset:0
    ds_read_b64 v[78:79], v29 offset:32
    s_waitcnt lgkmcnt(0)
    v_swap_b32 v65, v66
    v_swap_b32 v69, v70
    v_swap_b32 v73, v74
    v_swap_b32 v77, v78
    s_nop 1
    v_mfma_f32_16x16x32_bf16 v[48:51], v[64:67], v[80:83], 0
    v_mfma_f32_16x16x32_bf16 v[60:63], v[64:67], v[84:87], 0
    v_mfma_f32_16x16x32_bf16 v[48:51], v[68:71], v[88:91], v[48:51]
    v_mfma_f32_16x16x32_bf16 v[60:63], v[68:71], v[92:95], v[60:63]
    v_mfma_f32_16x16x32_bf16 v[48:51], v[72:75], v[96:99], v[48:51]
    v_mfma_f32_16x16x32_bf16 v[60:63], v[72:75], v[100:103], v[60:63]
    v_mfma_f32_16x16x32_bf16 v[48:51], v[76:79], v[104:107], v[48:51]
    v_mfma_f32_16x16x32_bf16 v[60:63], v[76:79], v[108:111], v[60:63]
    s_nop 7
    ds_write_b128 v113, v[48:51] offset:59392
    ds_write_b128 v113, v[60:63] offset:62464
    s_waitcnt lgkmcnt(0)
    s_barrier
    s_cmp_ge_u32 s24, 2
    s_cbranch_scc1 Ltn_102
    ds_read_b128 v[16:19], v7 offset:2048
    ds_read_b128 v[20:23], v7 offset:8192
    ds_read_b128 v[24:27], v7 offset:14336
    ds_read_b128 v[28:31], v7 offset:20480
    s_waitcnt lgkmcnt(0)
    v_pk_add_f32 v[16:17], v[16:17], v[20:21]
    v_pk_add_f32 v[24:25], v[24:25], v[28:29]
    v_pk_add_f32 v[16:17], v[16:17], v[24:25]
    v_pk_add_f32 v[18:19], v[18:19], v[22:23]
    v_pk_add_f32 v[26:27], v[26:27], v[30:31]
    v_pk_add_f32 v[18:19], v[18:19], v[26:27]
    v_cmp_gt_u32 vcc, 32, v1
    s_nop 1
    v_cndmask_b32 v16, v56, v16, vcc
    v_cndmask_b32 v17, v56, v17, vcc
    v_cndmask_b32 v18, v56, v18, vcc
    v_cndmask_b32 v19, v56, v19, vcc
    v_max3_f32 v57, v8, v9, v10
    v_max3_f32 v57, v57, v11, v12
    v_max3_f32 v57, v57, v13, v14
    v_max3_f32 v57, v57, v15, v16
    v_max3_f32 v57, v57, v17, v18
    v_max_f32 v57, v57, v19
    v_mov_b32 v58, v57
    s_nop 1
    v_permlane16_swap_b32 v57, v58
    v_max_f32 v57, v57, v58
    v_mov_b32 v58, v57
    s_nop 1
    v_permlane32_swap_b32 v57, v58
    v_max_f32 v57, v57, v58
    v_sub_f32 v8, v8, v57
    v_sub_f32 v9, v9, v57
    v_sub_f32 v10, v10, v57
    v_sub_f32 v11, v11, v57
    v_sub_f32 v12, v12, v57
    v_sub_f32 v13, v13, v57
    v_sub_f32 v14, v14, v57
    v_sub_f32 v15, v15, v57
    v_sub_f32 v16, v16, v57
    v_sub_f32 v17, v17, v57
    v_sub_f32 v18, v18, v57
    v_sub_f32 v19, v19, v57
    v_exp_f32 v8, v8
    v_exp_f32 v9, v9
    v_exp_f32 v10, v10
    v_exp_f32 v11, v11
    v_exp_f32 v12, v12
    v_exp_f32 v13, v13
    v_exp_f32 v14, v14
    v_exp_f32 v15, v15
    v_exp_f32 v16, v16
    v_exp_f32 v17, v17
    v_exp_f32 v18, v18
    v_exp_f32 v19, v19
    s_nop 0
    v_add_f32 v57, v8, v9
    v_add_f32 v57, v57, v10
    v_add_f32 v57, v57, v11
    v_add_f32 v57, v57, v12
    v_add_f32 v57, v57, v13
    v_add_f32 v57, v57, v14
    v_add_f32 v57, v57, v15
    v_add_f32 v57, v57, v16
    v_add_f32 v57, v57, v17
    v_add_f32 v57, v57, v18
    v_add_f32 v57, v57, v19
    v_mov_b32 v58, v57
    s_nop 1
    v_permlane16_swap_b32 v57, v58
    v_add_f32 v57, v57, v58
    v_mov_b32 v58, v57
    s_nop 1
    v_permlane32_swap_b32 v57, v58
    v_add_f32 v57, v57, v58
    v_rcp_f32 v57, v57
    s_nop 0
    v_mul_f32 v8, v8, v57
    v_mul_f32 v9, v9, v57
    v_mul_f32 v10, v10, v57
    v_mul_f32 v11, v11, v57
    v_mul_f32 v12, v12, v57
    v_mul_f32 v13, v13, v57
    v_mul_f32 v14, v14, v57
    v_mul_f32 v15, v15, v57
    v_mul_f32 v16, v16, v57
    v_mul_f32 v17, v17, v57
    v_mul_f32 v18, v18, v57
    v_mul_f32 v19, v19, v57
    v_cvt_pk_bf16_f32 v60, v8, v9
    v_cvt_pk_bf16_f32 v61, v12, v13
    v_cvt_pk_bf16_f32 v62, v10, v11
    v_cvt_pk_bf16_f32 v63, v14, v15
    v_cvt_pk_bf16_f32 v58, v16, v17
    v_cvt_pk_bf16_f32 v59, v18, v19
    s_lshl_b32 s28, s26, 4
    s_add_u32 s28, s28, s30
    s_lshl_b32 s28, s28, 1
    s_add_u32 s28, s28, s24
    s_lshl_b32 s29, s28, 10
    s_add_u32 s29, s29, 63963136
    buffer_store_dwordx4 v[60:63], v4, s[4:7], s29 offen sc1
    s_lshl_b32 s29, s28, 8
    s_add_u32 s29, s29, 66125824
    s_mov_b32 exec_hi, 0
    buffer_store_dword v58, v118, s[4:7], s29 offen sc1
    buffer_store_dword v59, v118, s[4:7], s29 offen offset:8 sc1
    s_mov_b64 exec, -1
    s_lshl_b32 s39, s26, 13
    s_lshl_b32 s28, s30, 7
    s_add_u32 s39, s39, s28
    s_lshl_b32 s28, s24, 2
    s_add_u32 s39, s39, s28
    s_add_u32 s39, s39, 72355840
Ltn_102:
    s_cmp_eq_u32 s26, 64
    s_cselect_b32 s26, -4, s26
    s_add_u32 s26, s26, 4
    s_cmp_lt_u32 s26, 64
    s_cbranch_scc1 K2_T_loop
    s_cmp_eq_u32 s39, 0
    s_cbranch_scc1 K2_end
    s_waitcnt vmcnt(0)
    s_mov_b64 exec, 1
    buffer_store_dword v117, v116, s[4:7], s39 offen sc1
    s_mov_b64 exec, -1
    s_branch K2_end
K2_W1:
    v_lshlrev_b32 v12, 7, v1
    v_and_b32 v12, 3, v1
    v_lshlrev_b32 v12, 2, v12
    s_and_b32 s28, s25, 15
    s_lshl_b32 s28, s28, 7
    s_add_u32 s28, s28, 72425472
Lwf_103:
    buffer_load_dword v13, v12, s[4:7], s28 offen sc1
    s_waitcnt vmcnt(0)
    v_cmp_ne_u32 vcc, s48, v13
    s_cbranch_vccz Lwd_104
    s_sleep 16
    s_sub_u32 s27, s27, 1
    s_cbranch_scc1 K2_end
    s_branch Lwf_103
Lwd_104:
    s_sub_u32 s25, s25, 144
    s_mul_hi_u32 s30, s25, 0x2aaaaaab
    s_mul_i32 s31, s30, 6
    s_sub_u32 s26, s25, s31
    s_mul_i32 s32, s24, 7
    s_add_u32 s32, s32, 1
    s_lshr_b32 s32, s32, 1
    s_lshr_b32 s33, s24, 1
    s_mul_i32 s33, s33, 7
    s_add_u32 s33, s33, 3
    s_and_b32 s35, s24, 1
    s_sub_u32 s34, s35, 1
    v_lshrrev_b32 v7, 3, v2
    v_lshlrev_b32 v7, 8, v7
    v_and_b32 v6, 7, v2
    v_lshl_add_u32 v7, v6, 4, v7
    v_mul_u32_u24 v6, 7168, v3
    v_add_u32 v7, v7, v6
    s_lshl_b32 s28, s32, 9
    v_add_u32 v5, s28, v7
    s_lshl_b32 s28, s33, 9
    s_lshl_b32 s29, s35, 7
    s_add_u32 s28, s28, s29
    v_add_u32 v6, s28, v7
    v_min_u32 v8, 55, v1
    v_lshlrev_b32 v8, 4, v8
    v_lshrrev_b32 v9, 1, v3
    v_lshlrev_b32 v9, 4, v9
    v_and_b32 v10, 1, v3
    v_lshl_add_u32 v9, v10, 2, v9
    v_bfe_u32 v10, v2, 2, 1
    v_add_u32 v9, v9, v10
    v_lshrrev_b32 v10, 3, v2
    v_lshl_add_u32 v9, v10, 3, v9
    v_mul_u32_u24 v9, 1040, v9
    v_and_b32 v10, 1, v2
    v_lshl_add_u32 v9, v10, 3, v9
    v_bfe_u32 v10, v2, 1, 1
    v_lshl_add_u32 v9, v10, 5, v9
    s_lshl_b32 s28, s32, 6
    v_add_u32 v10, s28, v9
    s_lshl_b32 s28, s33, 6
    s_lshl_b32 s29, s35, 4
    s_add_u32 s28, s28, s29
    v_add_u32 v11, s28, v9
    s_mul_i32 s50, s30, 896
    s_mul_i32 s28, s24, 57344
    s_add_u32 s50, s50, s28
    s_mul_i32 s51, s24, 16640
    s_add_u32 m0, s51, 0
    s_add_u32 s52, s50, 0
    buffer_load_dwordx4 v8, s[40:43], s52 offen lds
    s_add_u32 m0, s51, 1040
    s_add_u32 s52, s50, 3584
    buffer_load_dwordx4 v8, s[40:43], s52 offen lds
    s_add_u32 m0, s51, 2080
    s_add_u32 s52, s50, 7168
    buffer_load_dwordx4 v8, s[40:43], s52 offen lds
    s_add_u32 m0, s51, 3120
    s_add_u32 s52, s50, 10752
    buffer_load_dwordx4 v8, s[40:43], s52 offen lds
    s_add_u32 m0, s51, 4160
    s_add_u32 s52, s50, 14336
    buffer_load_dwordx4 v8, s[40:43], s52 offen lds
    s_add_u32 m0, s51, 5200
    s_add_u32 s52, s50, 17920
    buffer_load_dwordx4 v8, s[40:43], s52 offen lds
    s_add_u32 m0, s51, 6240
    s_add_u32 s52, s50, 21504
    buffer_load_dwordx4 v8, s[40:43], s52 offen lds
    s_add_u32 m0, s51, 7280
    s_add_u32 s52, s50, 25088
    buffer_load_dwordx4 v8, s[40:43], s52 offen lds
    s_add_u32 m0, s51, 8320
    s_add_u32 s52, s50, 28672
    buffer_load_dwordx4 v8, s[40:43], s52 offen lds
    s_add_u32 m0, s51, 9360
    s_add_u32 s52, s50, 32256
    buffer_load_dwordx4 v8, s[40:43], s52 offen lds
    s_add_u32 m0, s51, 10400
    s_add_u32 s52, s50, 35840
    buffer_load_dwordx4 v8, s[40:43], s52 offen lds
    s_add_u32 m0, s51, 11440
    s_add_u32 s52, s50, 39424
    buffer_load_dwordx4 v8, s[40:43], s52 offen lds
    s_add_u32 m0, s51, 12480
    s_add_u32 s52, s50, 43008
    buffer_load_dwordx4 v8, s[40:43], s52 offen lds
    s_add_u32 m0, s51, 13520
    s_add_u32 s52, s50, 46592
    buffer_load_dwordx4 v8, s[40:43], s52 offen lds
    s_add_u32 m0, s51, 14560
    s_add_u32 s52, s50, 50176
    buffer_load_dwordx4 v8, s[40:43], s52 offen lds
    s_add_u32 m0, s51, 15600
    s_add_u32 s52, s50, 53760
    buffer_load_dwordx4 v8, s[40:43], s52 offen lds
    s_add_u32 m0, s51, 66560
    s_add_u32 s52, s50, 229376
    buffer_load_dwordx4 v8, s[40:43], s52 offen lds
    s_add_u32 m0, s51, 67600
    s_add_u32 s52, s50, 232960
    buffer_load_dwordx4 v8, s[40:43], s52 offen lds
    s_add_u32 m0, s51, 68640
    s_add_u32 s52, s50, 236544
    buffer_load_dwordx4 v8, s[40:43], s52 offen lds
    s_add_u32 m0, s51, 69680
    s_add_u32 s52, s50, 240128
    buffer_load_dwordx4 v8, s[40:43], s52 offen lds
    s_add_u32 m0, s51, 70720
    s_add_u32 s52, s50, 243712
    buffer_load_dwordx4 v8, s[40:43], s52 offen lds
    s_add_u32 m0, s51, 71760
    s_add_u32 s52, s50, 247296
    buffer_load_dwordx4 v8, s[40:43], s52 offen lds
    s_add_u32 m0, s51, 72800
    s_add_u32 s52, s50, 250880
    buffer_load_dwordx4 v8, s[40:43], s52 offen lds
    s_add_u32 m0, s51, 73840
    s_add_u32 s52, s50, 254464
    buffer_load_dwordx4 v8, s[40:43], s52 offen lds
    s_add_u32 m0, s51, 74880
    s_add_u32 s52, s50, 258048
    buffer_load_dwordx4 v8, s[40:43], s52 offen lds
    s_add_u32 m0, s51, 75920
    s_add_u32 s52, s50, 261632
    buffer_load_dwordx4 v8, s[40:43], s52 offen lds
    s_add_u32 m0, s51, 76960
    s_add_u32 s52, s50, 265216
    buffer_load_dwordx4 v8, s[40:43], s52 offen lds
    s_add_u32 m0, s51, 78000
    s_add_u32 s52, s50, 268800
    buffer_load_dwordx4 v8, s[40:43], s52 offen lds
    s_add_u32 m0, s51, 79040
    s_add_u32 s52, s50, 272384
    buffer_load_dwordx4 v8, s[40:43], s52 offen lds
    s_add_u32 m0, s51, 80080
    s_add_u32 s52, s50, 275968
    buffer_load_dwordx4 v8, s[40:43], s52 offen lds
    s_add_u32 m0, s51, 81120
    s_add_u32 s52, s50, 279552
    buffer_load_dwordx4 v8, s[40:43], s52 offen lds
    s_add_u32 m0, s51, 82160
    s_add_u32 s52, s50, 283136
    buffer_load_dwordx4 v8, s[40:43], s52 offen lds
    s_waitcnt vmcnt(16)
    s_barrier
    v_mov_b32 v12, v10
    v_mov_b32 v13, v11
    ds_read_b64_tr_b16 a[0:1], v12 offset:0
    ds_read_b64_tr_b16 a[2:3], v12 offset:2080
    ds_read_b64_tr_b16 a[56:57], v12 offset:16
    ds_read_b64_tr_b16 a[58:59], v12 offset:2096
    ds_read_b64_tr_b16 a[112:113], v12 offset:64
    ds_read_b64_tr_b16 a[114:115], v12 offset:2144
    ds_read_b64_tr_b16 a[168:169], v12 offset:80
    ds_read_b64_tr_b16 a[170:171], v12 offset:2160
    ds_read_b64_tr_b16 a[224:225], v12 offset:128
    ds_read_b64_tr_b16 a[226:227], v12 offset:2208
    ds_read_b64_tr_b16 v[144:145], v12 offset:144
    ds_read_b64_tr_b16 v[146:147], v12 offset:2224
    ds_read_b64_tr_b16 v[200:201], v13 offset:0
    ds_read_b64_tr_b16 v[202:203], v13 offset:2080
    s_waitcnt lgkmcnt(0)
    ds_read_b64_tr_b16 a[4:5], v12 offset:33280
    ds_read_b64_tr_b16 a[6:7], v12 offset:35360
    ds_read_b64_tr_b16 a[60:61], v12 offset:33296
    ds_read_b64_tr_b16 a[62:63], v12 offset:35376
    ds_read_b64_tr_b16 a[116:117], v12 offset:33344
    ds_read_b64_tr_b16 a[118:119], v12 offset:35424
    ds_read_b64_tr_b16 a[172:173], v12 offset:33360
    ds_read_b64_tr_b16 a[174:175], v12 offset:35440
    ds_read_b64_tr_b16 a[228:229], v12 offset:33408
    ds_read_b64_tr_b16 a[230:231], v12 offset:35488
    ds_read_b64_tr_b16 v[148:149], v12 offset:33424
    ds_read_b64_tr_b16 v[150:151], v12 offset:35504
    ds_read_b64_tr_b16 v[204:205], v13 offset:33280
    ds_read_b64_tr_b16 v[206:207], v13 offset:35360
    s_waitcnt lgkmcnt(0)
    s_barrier
    s_add_u32 m0, s51, 0
    s_add_u32 s52, s50, 458752
    buffer_load_dwordx4 v8, s[40:43], s52 offen lds
    s_add_u32 m0, s51, 1040
    s_add_u32 s52, s50, 462336
    buffer_load_dwordx4 v8, s[40:43], s52 offen lds
    s_add_u32 m0, s51, 2080
    s_add_u32 s52, s50, 465920
    buffer_load_dwordx4 v8, s[40:43], s52 offen lds
    s_add_u32 m0, s51, 3120
    s_add_u32 s52, s50, 469504
    buffer_load_dwordx4 v8, s[40:43], s52 offen lds
    s_add_u32 m0, s51, 4160
    s_add_u32 s52, s50, 473088
    buffer_load_dwordx4 v8, s[40:43], s52 offen lds
    s_add_u32 m0, s51, 5200
    s_add_u32 s52, s50, 476672
    buffer_load_dwordx4 v8, s[40:43], s52 offen lds
    s_add_u32 m0, s51, 6240
    s_add_u32 s52, s50, 480256
    buffer_load_dwordx4 v8, s[40:43], s52 offen lds
    s_add_u32 m0, s51, 7280
    s_add_u32 s52, s50, 483840
    buffer_load_dwordx4 v8, s[40:43], s52 offen lds
    s_add_u32 m0, s51, 8320
    s_add_u32 s52, s50, 487424
    buffer_load_dwordx4 v8, s[40:43], s52 offen lds
    s_add_u32 m0, s51, 9360
    s_add_u32 s52, s50, 491008
    buffer_load_dwordx4 v8, s[40:43], s52 offen lds
    s_add_u32 m0, s51, 10400
    s_add_u32 s52, s50, 494592
    buffer_load_dwordx4 v8, s[40:43], s52 offen lds
    s_add_u32 m0, s51, 11440
    s_add_u32 s52, s50, 498176
    buffer_load_dwordx4 v8, s[40:43], s52 offen lds
    s_add_u32 m0, s51, 12480
    s_add_u32 s52, s50, 501760
    buffer_load_dwordx4 v8, s[40:43], s52 offen lds
    s_add_u32 m0, s51, 13520
    s_add_u32 s52, s50, 505344
    buffer_load_dwordx4 v8, s[40:43], s52 offen lds
    s_add_u32 m0, s51, 14560
    s_add_u32 s52, s50, 508928
    buffer_load_dwordx4 v8, s[40:43], s52 offen lds
    s_add_u32 m0, s51, 15600
    s_add_u32 s52, s50, 512512
    buffer_load_dwordx4 v8, s[40:43], s52 offen lds
    s_waitcnt vmcnt(16)
    s_barrier
    v_add_u32 v12, 66560, v10
    v_add_u32 v13, 66560, v11
    ds_read_b64_tr_b16 a[8:9], v12 offset:0
    ds_read_b64_tr_b16 a[10:11], v12 offset:2080
    ds_read_b64_tr_b16 a[64:65], v12 offset:16
    ds_read_b64_tr_b16 a[66:67], v12 offset:2096
    ds_read_b64_tr_b16 a[120:121], v12 offset:64
    ds_read_b64_tr_b16 a[122:123], v12 offset:2144
    ds_read_b64_tr_b16 a[176:177], v12 offset:80
    ds_read_b64_tr_b16 a[178:179], v12 offset:2160
    ds_read_b64_tr_b16 a[232:233], v12 offset:128
    ds_read_b64_tr_b16 a[234:235], v12 offset:2208
    ds_read_b64_tr_b16 v[152:153], v12 offset:144
    ds_read_b64_tr_b16 v[154:155], v12 offset:2224
    ds_read_b64_tr_b16 v[208:209], v13 offset:0
    ds_read_b64_tr_b16 v[210:211], v13 offset:2080
    s_waitcnt lgkmcnt(0)
    ds_read_b64_tr_b16 a[12:13], v12 offset:33280
    ds_read_b64_tr_b16 a[14:15], v12 offset:35360
    ds_read_b64_tr_b16 a[68:69], v12 offset:33296
    ds_read_b64_tr_b16 a[70:71], v12 offset:35376
    ds_read_b64_tr_b16 a[124:125], v12 offset:33344
    ds_read_b64_tr_b16 a[126:127], v12 offset:35424
    ds_read_b64_tr_b16 a[180:181], v12 offset:33360
    ds_read_b64_tr_b16 a[182:183], v12 offset:35440
    ds_read_b64_tr_b16 a[236:237], v12 offset:33408
    ds_read_b64_tr_b16 a[238:239], v12 offset:35488
    ds_read_b64_tr_b16 v[156:157], v12 offset:33424
    ds_read_b64_tr_b16 v[158:159], v12 offset:35504
    ds_read_b64_tr_b16 v[212:213], v13 offset:33280
    ds_read_b64_tr_b16 v[214:215], v13 offset:35360
    s_waitcnt lgkmcnt(0)
    s_barrier
    s_add_u32 m0, s51, 66560
    s_add_u32 s52, s50, 688128
    buffer_load_dwordx4 v8, s[40:43], s52 offen lds
    s_add_u32 m0, s51, 67600
    s_add_u32 s52, s50, 691712
    buffer_load_dwordx4 v8, s[40:43], s52 offen lds
    s_add_u32 m0, s51, 68640
    s_add_u32 s52, s50, 695296
    buffer_load_dwordx4 v8, s[40:43], s52 offen lds
    s_add_u32 m0, s51, 69680
    s_add_u32 s52, s50, 698880
    buffer_load_dwordx4 v8, s[40:43], s52 offen lds
    s_add_u32 m0, s51, 70720
    s_add_u32 s52, s50, 702464
    buffer_load_dwordx4 v8, s[40:43], s52 offen lds
    s_add_u32 m0, s51, 71760
    s_add_u32 s52, s50, 706048
    buffer_load_dwordx4 v8, s[40:43], s52 offen lds
    s_add_u32 m0, s51, 72800
    s_add_u32 s52, s50, 709632
    buffer_load_dwordx4 v8, s[40:43], s52 offen lds
    s_add_u32 m0, s51, 73840
    s_add_u32 s52, s50, 713216
    buffer_load_dwordx4 v8, s[40:43], s52 offen lds
    s_add_u32 m0, s51, 74880
    s_add_u32 s52, s50, 716800
    buffer_load_dwordx4 v8, s[40:43], s52 offen lds
    s_add_u32 m0, s51, 75920
    s_add_u32 s52, s50, 720384
    buffer_load_dwordx4 v8, s[40:43], s52 offen lds
    s_add_u32 m0, s51, 76960
    s_add_u32 s52, s50, 723968
    buffer_load_dwordx4 v8, s[40:43], s52 offen lds
    s_add_u32 m0, s51, 78000
    s_add_u32 s52, s50, 727552
    buffer_load_dwordx4 v8, s[40:43], s52 offen lds
    s_add_u32 m0, s51, 79040
    s_add_u32 s52, s50, 731136
    buffer_load_dwordx4 v8, s[40:43], s52 offen lds
    s_add_u32 m0, s51, 80080
    s_add_u32 s52, s50, 734720
    buffer_load_dwordx4 v8, s[40:43], s52 offen lds
    s_add_u32 m0, s51, 81120
    s_add_u32 s52, s50, 738304
    buffer_load_dwordx4 v8, s[40:43], s52 offen lds
    s_add_u32 m0, s51, 82160
    s_add_u32 s52, s50, 741888
    buffer_load_dwordx4 v8, s[40:43], s52 offen lds
    s_waitcnt vmcnt(16)
    s_barrier
    v_mov_b32 v12, v10
    v_mov_b32 v13, v11
    ds_read_b64_tr_b16 a[16:17], v12 offset:0
    ds_read_b64_tr_b16 a[18:19], v12 offset:2080
    ds_read_b64_tr_b16 a[72:73], v12 offset:16
    ds_read_b64_tr_b16 a[74:75], v12 offset:2096
    ds_read_b64_tr_b16 a[128:129], v12 offset:64
    ds_read_b64_tr_b16 a[130:131], v12 offset:2144
    ds_read_b64_tr_b16 a[184:185], v12 offset:80
    ds_read_b64_tr_b16 a[186:187], v12 offset:2160
    ds_read_b64_tr_b16 a[240:241], v12 offset:128
    ds_read_b64_tr_b16 a[242:243], v12 offset:2208
    ds_read_b64_tr_b16 v[160:161], v12 offset:144
    ds_read_b64_tr_b16 v[162:163], v12 offset:2224
    ds_read_b64_tr_b16 v[216:217], v13 offset:0
    ds_read_b64_tr_b16 v[218:219], v13 offset:2080
    s_waitcnt lgkmcnt(0)
    ds_read_b64_tr_b16 a[20:21], v12 offset:33280
    ds_read_b64_tr_b16 a[22:23], v12 offset:35360
    ds_read_b64_tr_b16 a[76:77], v12 offset:33296
    ds_read_b64_tr_b16 a[78:79], v12 offset:35376
    ds_read_b64_tr_b16 a[132:133], v12 offset:33344
    ds_read_b64_tr_b16 a[134:135], v12 offset:35424
    ds_read_b64_tr_b16 a[188:189], v12 offset:33360
    ds_read_b64_tr_b16 a[190:191], v12 offset:35440
    ds_read_b64_tr_b16 a[244:245], v12 offset:33408
    ds_read_b64_tr_b16 a[246:247], v12 offset:35488
    ds_read_b64_tr_b16 v[164:165], v12 offset:33424
    ds_read_b64_tr_b16 v[166:167], v12 offset:35504
    ds_read_b64_tr_b16 v[220:221], v13 offset:33280
    ds_read_b64_tr_b16 v[222:223], v13 offset:35360
    s_waitcnt lgkmcnt(0)
    s_barrier
    s_add_u32 m0, s51, 0
    s_add_u32 s52, s50, 917504
    buffer_load_dwordx4 v8, s[40:43], s52 offen lds
    s_add_u32 m0, s51, 1040
    s_add_u32 s52, s50, 921088
    buffer_load_dwordx4 v8, s[40:43], s52 offen lds
    s_add_u32 m0, s51, 2080
    s_add_u32 s52, s50, 924672
    buffer_load_dwordx4 v8, s[40:43], s52 offen lds
    s_add_u32 m0, s51, 3120
    s_add_u32 s52, s50, 928256
    buffer_load_dwordx4 v8, s[40:43], s52 offen lds
    s_add_u32 m0, s51, 4160
    s_add_u32 s52, s50, 931840
    buffer_load_dwordx4 v8, s[40:43], s52 offen lds
    s_add_u32 m0, s51, 5200
    s_add_u32 s52, s50, 935424
    buffer_load_dwordx4 v8, s[40:43], s52 offen lds
    s_add_u32 m0, s51, 6240
    s_add_u32 s52, s50, 939008
    buffer_load_dwordx4 v8, s[40:43], s52 offen lds
    s_add_u32 m0, s51, 7280
    s_add_u32 s52, s50, 942592
    buffer_load_dwordx4 v8, s[40:43], s52 offen lds
    s_add_u32 m0, s51, 8320
    s_add_u32 s52, s50, 946176
    buffer_load_dwordx4 v8, s[40:43], s52 offen lds
    s_add_u32 m0, s51, 9360
    s_add_u32 s52, s50, 949760
    buffer_load_dwordx4 v8, s[40:43], s52 offen lds
    s_add_u32 m0, s51, 10400
    s_add_u32 s52, s50, 953344
    buffer_load_dwordx4 v8, s[40:43], s52 offen lds
    s_add_u32 m0, s51, 11440
    s_add_u32 s52, s50, 956928
    buffer_load_dwordx4 v8, s[40:43], s52 offen lds
    s_add_u32 m0, s51, 12480
    s_add_u32 s52, s50, 960512
    buffer_load_dwordx4 v8, s[40:43], s52 offen lds
    s_add_u32 m0, s51, 13520
    s_add_u32 s52, s50, 964096
    buffer_load_dwordx4 v8, s[40:43], s52 offen lds
    s_add_u32 m0, s51, 14560
    s_add_u32 s52, s50, 967680
    buffer_load_dwordx4 v8, s[40:43], s52 offen lds
    s_add_u32 m0, s51, 15600
    s_add_u32 s52, s50, 971264
    buffer_load_dwordx4 v8, s[40:43], s52 offen lds
    s_waitcnt vmcnt(16)
    s_barrier
    v_add_u32 v12, 66560, v10
    v_add_u32 v13, 66560, v11
    ds_read_b64_tr_b16 a[24:25], v12 offset:0
    ds_read_b64_tr_b16 a[26:27], v12 offset:2080
    ds_read_b64_tr_b16 a[80:81], v12 offset:16
    ds_read_b64_tr_b16 a[82:83], v12 offset:2096
    ds_read_b64_tr_b16 a[136:137], v12 offset:64
    ds_read_b64_tr_b16 a[138:139], v12 offset:2144
    ds_read_b64_tr_b16 a[192:193], v12 offset:80
    ds_read_b64_tr_b16 a[194:195], v12 offset:2160
    ds_read_b64_tr_b16 a[248:249], v12 offset:128
    ds_read_b64_tr_b16 a[250:251], v12 offset:2208
    ds_read_b64_tr_b16 v[168:169], v12 offset:144
    ds_read_b64_tr_b16 v[170:171], v12 offset:2224
    ds_read_b64_tr_b16 v[224:225], v13 offset:0
    ds_read_b64_tr_b16 v[226:227], v13 offset:2080
    s_waitcnt lgkmcnt(0)
    ds_read_b64_tr_b16 a[28:29], v12 offset:33280
    ds_read_b64_tr_b16 a[30:31], v12 offset:35360
    ds_read_b64_tr_b16 a[84:85], v12 offset:33296
    ds_read_b64_tr_b16 a[86:87], v12 offset:35376
    ds_read_b64_tr_b16 a[140:141], v12 offset:33344
    ds_read_b64_tr_b16 a[142:143], v12 offset:35424
    ds_read_b64_tr_b16 a[196:197], v12 offset:33360
    ds_read_b64_tr_b16 a[198:199], v12 offset:35440
    ds_read_b64_tr_b16 a[252:253], v12 offset:33408
    ds_read_b64_tr_b16 a[254:255], v12 offset:35488
    ds_read_b64_tr_b16 v[172:173], v12 offset:33424
    ds_read_b64_tr_b16 v[174:175], v12 offset:35504
    ds_read_b64_tr_b16 v[228:229], v13 offset:33280
    ds_read_b64_tr_b16 v[230:231], v13 offset:35360
    s_waitcnt lgkmcnt(0)
    s_barrier
    s_add_u32 m0, s51, 66560
    s_add_u32 s52, s50, 1146880
    buffer_load_dwordx4 v8, s[40:43], s52 offen lds
    s_add_u32 m0, s51, 67600
    s_add_u32 s52, s50, 1150464
    buffer_load_dwordx4 v8, s[40:43], s52 offen lds
    s_add_u32 m0, s51, 68640
    s_add_u32 s52, s50, 1154048
    buffer_load_dwordx4 v8, s[40:43], s52 offen lds
    s_add_u32 m0, s51, 69680
    s_add_u32 s52, s50, 1157632
    buffer_load_dwordx4 v8, s[40:43], s52 offen lds
    s_add_u32 m0, s51, 70720
    s_add_u32 s52, s50, 1161216
    buffer_load_dwordx4 v8, s[40:43], s52 offen lds
    s_add_u32 m0, s51, 71760
    s_add_u32 s52, s50, 1164800
    buffer_load_dwordx4 v8, s[40:43], s52 offen lds
    s_add_u32 m0, s51, 72800
    s_add_u32 s52, s50, 1168384
    buffer_load_dwordx4 v8, s[40:43], s52 offen lds
    s_add_u32 m0, s51, 73840
    s_add_u32 s52, s50, 1171968
    buffer_load_dwordx4 v8, s[40:43], s52 offen lds
    s_add_u32 m0, s51, 74880
    s_add_u32 s52, s50, 1175552
    buffer_load_dwordx4 v8, s[40:43], s52 offen lds
    s_add_u32 m0, s51, 75920
    s_add_u32 s52, s50, 1179136
    buffer_load_dwordx4 v8, s[40:43], s52 offen lds
    s_add_u32 m0, s51, 76960
    s_add_u32 s52, s50, 1182720
    buffer_load_dwordx4 v8, s[40:43], s52 offen lds
    s_add_u32 m0, s51, 78000
    s_add_u32 s52, s50, 1186304
    buffer_load_dwordx4 v8, s[40:43], s52 offen lds
    s_add_u32 m0, s51, 79040
    s_add_u32 s52, s50, 1189888
    buffer_load_dwordx4 v8, s[40:43], s52 offen lds
    s_add_u32 m0, s51, 80080
    s_add_u32 s52, s50, 1193472
    buffer_load_dwordx4 v8, s[40:43], s52 offen lds
    s_add_u32 m0, s51, 81120
    s_add_u32 s52, s50, 1197056
    buffer_load_dwordx4 v8, s[40:43], s52 offen lds
    s_add_u32 m0, s51, 82160
    s_add_u32 s52, s50, 1200640
    buffer_load_dwordx4 v8, s[40:43], s52 offen lds
    s_waitcnt vmcnt(16)
    s_barrier
    v_mov_b32 v12, v10
    v_mov_b32 v13, v11
    ds_read_b64_tr_b16 a[32:33], v12 offset:0
    ds_read_b64_tr_b16 a[34:35], v12 offset:2080
    ds_read_b64_tr_b16 a[88:89], v12 offset:16
    ds_read_b64_tr_b16 a[90:91], v12 offset:2096
    ds_read_b64_tr_b16 a[144:145], v12 offset:64
    ds_read_b64_tr_b16 a[146:147], v12 offset:2144
    ds_read_b64_tr_b16 a[200:201], v12 offset:80
    ds_read_b64_tr_b16 a[202:203], v12 offset:2160
    ds_read_b64_tr_b16 v[120:121], v12 offset:128
    ds_read_b64_tr_b16 v[122:123], v12 offset:2208
    ds_read_b64_tr_b16 v[176:177], v12 offset:144
    ds_read_b64_tr_b16 v[178:179], v12 offset:2224
    ds_read_b64_tr_b16 v[232:233], v13 offset:0
    ds_read_b64_tr_b16 v[234:235], v13 offset:2080
    s_waitcnt lgkmcnt(0)
    ds_read_b64_tr_b16 a[36:37], v12 offset:33280
    ds_read_b64_tr_b16 a[38:39], v12 offset:35360
    ds_read_b64_tr_b16 a[92:93], v12 offset:33296
    ds_read_b64_tr_b16 a[94:95], v12 offset:35376
    ds_read_b64_tr_b16 a[148:149], v12 offset:33344
    ds_read_b64_tr_b16 a[150:151], v12 offset:35424
    ds_read_b64_tr_b16 a[204:205], v12 offset:33360
    ds_read_b64_tr_b16 a[206:207], v12 offset:35440
    ds_read_b64_tr_b16 v[124:125], v12 offset:33408
    ds_read_b64_tr_b16 v[126:127], v12 offset:35488
    ds_read_b64_tr_b16 v[180:181], v12 offset:33424
    ds_read_b64_tr_b16 v[182:183], v12 offset:35504
    ds_read_b64_tr_b16 v[236:237], v13 offset:33280
    ds_read_b64_tr_b16 v[238:239], v13 offset:35360
    s_waitcnt lgkmcnt(0)
    s_barrier
    s_add_u32 m0, s51, 0
    s_add_u32 s52, s50, 1376256
    buffer_load_dwordx4 v8, s[40:43], s52 offen lds
    s_add_u32 m0, s51, 1040
    s_add_u32 s52, s50, 1379840
    buffer_load_dwordx4 v8, s[40:43], s52 offen lds
    s_add_u32 m0, s51, 2080
    s_add_u32 s52, s50, 1383424
    buffer_load_dwordx4 v8, s[40:43], s52 offen lds
    s_add_u32 m0, s51, 3120
    s_add_u32 s52, s50, 1387008
    buffer_load_dwordx4 v8, s[40:43], s52 offen lds
    s_add_u32 m0, s51, 4160
    s_add_u32 s52, s50, 1390592
    buffer_load_dwordx4 v8, s[40:43], s52 offen lds
    s_add_u32 m0, s51, 5200
    s_add_u32 s52, s50, 1394176
    buffer_load_dwordx4 v8, s[40:43], s52 offen lds
    s_add_u32 m0, s51, 6240
    s_add_u32 s52, s50, 1397760
    buffer_load_dwordx4 v8, s[40:43], s52 offen lds
    s_add_u32 m0, s51, 7280
    s_add_u32 s52, s50, 1401344
    buffer_load_dwordx4 v8, s[40:43], s52 offen lds
    s_add_u32 m0, s51, 8320
    s_add_u32 s52, s50, 1404928
    buffer_load_dwordx4 v8, s[40:43], s52 offen lds
    s_add_u32 m0, s51, 9360
    s_add_u32 s52, s50, 1408512
    buffer_load_dwordx4 v8, s[40:43], s52 offen lds
    s_add_u32 m0, s51, 10400
    s_add_u32 s52, s50, 1412096
    buffer_load_dwordx4 v8, s[40:43], s52 offen lds
    s_add_u32 m0, s51, 11440
    s_add_u32 s52, s50, 1415680
    buffer_load_dwordx4 v8, s[40:43], s52 offen lds
    s_add_u32 m0, s51, 12480
    s_add_u32 s52, s50, 1419264
    buffer_load_dwordx4 v8, s[40:43], s52 offen lds
    s_add_u32 m0, s51, 13520
    s_add_u32 s52, s50, 1422848
    buffer_load_dwordx4 v8, s[40:43], s52 offen lds
    s_add_u32 m0, s51, 14560
    s_add_u32 s52, s50, 1426432
    buffer_load_dwordx4 v8, s[40:43], s52 offen lds
    s_add_u32 m0, s51, 15600
    s_add_u32 s52, s50, 1430016
    buffer_load_dwordx4 v8, s[40:43], s52 offen lds
    s_waitcnt vmcnt(16)
    s_barrier
    v_add_u32 v12, 66560, v10
    v_add_u32 v13, 66560, v11
    ds_read_b64_tr_b16 a[40:41], v12 offset:0
    ds_read_b64_tr_b16 a[42:43], v12 offset:2080
    ds_read_b64_tr_b16 a[96:97], v12 offset:16
    ds_read_b64_tr_b16 a[98:99], v12 offset:2096
    ds_read_b64_tr_b16 a[152:153], v12 offset:64
    ds_read_b64_tr_b16 a[154:155], v12 offset:2144
    ds_read_b64_tr_b16 a[208:209], v12 offset:80
    ds_read_b64_tr_b16 a[210:211], v12 offset:2160
    ds_read_b64_tr_b16 v[128:129], v12 offset:128
    ds_read_b64_tr_b16 v[130:131], v12 offset:2208
    ds_read_b64_tr_b16 v[184:185], v12 offset:144
    ds_read_b64_tr_b16 v[186:187], v12 offset:2224
    ds_read_b64_tr_b16 v[240:241], v13 offset:0
    ds_read_b64_tr_b16 v[242:243], v13 offset:2080
    s_waitcnt lgkmcnt(0)
    ds_read_b64_tr_b16 a[44:45], v12 offset:33280
    ds_read_b64_tr_b16 a[46:47], v12 offset:35360
    ds_read_b64_tr_b16 a[100:101], v12 offset:33296
    ds_read_b64_tr_b16 a[102:103], v12 offset:35376
    ds_read_b64_tr_b16 a[156:157], v12 offset:33344
    ds_read_b64_tr_b16 a[158:159], v12 offset:35424
    ds_read_b64_tr_b16 a[212:213], v12 offset:33360
    ds_read_b64_tr_b16 a[214:215], v12 offset:35440
    ds_read_b64_tr_b16 v[132:133], v12 offset:33408
    ds_read_b64_tr_b16 v[134:135], v12 offset:35488
    ds_read_b64_tr_b16 v[188:189], v12 offset:33424
    ds_read_b64_tr_b16 v[190:191], v12 offset:35504
    ds_read_b64_tr_b16 v[244:245], v13 offset:33280
    ds_read_b64_tr_b16 v[246:247], v13 offset:35360
    s_waitcnt lgkmcnt(0)
    s_barrier
    s_waitcnt vmcnt(0)
    s_barrier
    v_mov_b32 v12, v10
    v_mov_b32 v13, v11
    ds_read_b64_tr_b16 a[48:49], v12 offset:0
    ds_read_b64_tr_b16 a[50:51], v12 offset:2080
    ds_read_b64_tr_b16 a[104:105], v12 offset:16
    ds_read_b64_tr_b16 a[106:107], v12 offset:2096
    ds_read_b64_tr_b16 a[160:161], v12 offset:64
    ds_read_b64_tr_b16 a[162:163], v12 offset:2144
    ds_read_b64_tr_b16 a[216:217], v12 offset:80
    ds_read_b64_tr_b16 a[218:219], v12 offset:2160
    ds_read_b64_tr_b16 v[136:137], v12 offset:128
    ds_read_b64_tr_b16 v[138:139], v12 offset:2208
    ds_read_b64_tr_b16 v[192:193], v12 offset:144
    ds_read_b64_tr_b16 v[194:195], v12 offset:2224
    ds_read_b64_tr_b16 v[248:249], v13 offset:0
    ds_read_b64_tr_b16 v[250:251], v13 offset:2080
    s_waitcnt lgkmcnt(0)
    ds_read_b64_tr_b16 a[52:53], v12 offset:33280
    ds_read_b64_tr_b16 a[54:55], v12 offset:35360
    ds_read_b64_tr_b16 a[108:109], v12 offset:33296
    ds_read_b64_tr_b16 a[110:111], v12 offset:35376
    ds_read_b64_tr_b16 a[164:165], v12 offset:33344
    ds_read_b64_tr_b16 a[166:167], v12 offset:35424
    ds_read_b64_tr_b16 a[220:221], v12 offset:33360
    ds_read_b64_tr_b16 a[222:223], v12 offset:35440
    ds_read_b64_tr_b16 v[140:141], v12 offset:33408
    ds_read_b64_tr_b16 v[142:143], v12 offset:35488
    ds_read_b64_tr_b16 v[196:197], v12 offset:33424
    ds_read_b64_tr_b16 v[198:199], v12 offset:35504
    ds_read_b64_tr_b16 v[252:253], v13 offset:33280
    ds_read_b64_tr_b16 v[254:255], v13 offset:35360
    s_waitcnt lgkmcnt(0)
    s_barrier
    v_lshrrev_b32 v7, 1, v3
    v_lshlrev_b32 v7, 5, v7
    v_and_b32 v6, 1, v3
    v_lshl_add_u32 v7, v6, 3, v7
    s_mul_i32 s28, s30, 896
    s_lshl_b32 s29, s32, 6
    s_add_u32 s52, s28, s29
    s_lshl_b32 s29, s33, 6
    s_add_u32 s53, s28, s29
    s_lshl_b32 s29, s35, 4
    s_add_u32 s53, s53, s29
    buffer_load_dwordx2 v[8:9], v7, s[16:19], s52 offen offset:0
    buffer_load_dwordx2 v[10:11], v7, s[16:19], s52 offen offset:16
    buffer_load_dwordx2 v[12:13], v7, s[16:19], s52 offen offset:64
    buffer_load_dwordx2 v[14:15], v7, s[16:19], s52 offen offset:80
    buffer_load_dwordx2 v[16:17], v7, s[16:19], s52 offen offset:128
    buffer_load_dwordx2 v[18:19], v7, s[16:19], s52 offen offset:144
    buffer_load_dwordx2 v[20:21], v7, s[16:19], s53 offen
    s_waitcnt vmcnt(0)
    v_lshlrev_b32 v80, 16, v8
    v_and_b32 v81, 0xffff0000, v8
    v_lshlrev_b32 v82, 16, v9
    v_and_b32 v83, 0xffff0000, v9
    v_lshlrev_b32 v84, 16, v10
    v_and_b32 v85, 0xffff0000, v10
    v_lshlrev_b32 v86, 16, v11
    v_and_b32 v87, 0xffff0000, v11
    v_lshlrev_b32 v88, 16, v12
    v_and_b32 v89, 0xffff0000, v12
    v_lshlrev_b32 v90, 16, v13
    v_and_b32 v91, 0xffff0000, v13
    v_lshlrev_b32 v92, 16, v14
    v_and_b32 v93, 0xffff0000, v14
    v_lshlrev_b32 v94, 16, v15
    v_and_b32 v95, 0xffff0000, v15
    v_lshlrev_b32 v96, 16, v16
    v_and_b32 v97, 0xffff0000, v16
    v_lshlrev_b32 v98, 16, v17
    v_and_b32 v99, 0xffff0000, v17
    v_lshlrev_b32 v100, 16, v18
    v_and_b32 v101, 0xffff0000, v18
    v_lshlrev_b32 v102, 16, v19
    v_and_b32 v103, 0xffff0000, v19
    v_lshlrev_b32 v104, 16, v20
    v_and_b32 v105, 0xffff0000, v20
    v_lshlrev_b32 v106, 16, v21
    v_and_b32 v107, 0xffff0000, v21
    v_mov_b32 v116, 0
    v_mov_b32 v117, s48
    s_lshl_b32 s29, s35, 2
    v_add_u32 v118, s29, v4
    s_mov_b32 s38, 0
    s_mov_b32 s39, 0
    s_mul_i32 s36, s26, 28672
    s_mul_i32 s37, s24, 7168
    s_add_u32 s36, s36, s37
    s_add_u32 m0, s38, s37
    s_nop 0
    buffer_load_dwordx4 v4, s[4:7], s36 offen offset:0 lds
    buffer_load_dwordx4 v4, s[4:7], s36 offen offset:1024 lds
    buffer_load_dwordx4 v4, s[4:7], s36 offen offset:2048 lds
    buffer_load_dwordx4 v4, s[4:7], s36 offen offset:3072 lds
    s_add_u32 s36, s36, 4096
    s_add_u32 m0, m0, 4096
    s_nop 0
    buffer_load_dwordx4 v4, s[4:7], s36 offen offset:0 lds
    buffer_load_dwordx4 v4, s[4:7], s36 offen offset:1024 lds
    buffer_load_dwordx4 v4, s[4:7], s36 offen offset:2048 lds
    s_waitcnt vmcnt(0)
    s_branch K2_W1_go
K2_W1_loop:
    s_waitcnt vmcnt(10)
K2_W1_go:
    s_barrier
    v_add_u32 v5, s38, v4
    s_xor_b32 s38, s38, 28672
    s_add_u32 s61, s26, 6
    s_min_u32 s61, s61, 63
    s_cmp_eq_u32 s26, 64
    s_cselect_b32 s61, 0, s61
    s_mul_i32 s36, s61, 28672
    s_mul_i32 s37, s24, 7168
    s_add_u32 s36, s36, s37
    s_add_u32 m0, s38, s37
    s_nop 0
    buffer_load_dwordx4 v4, s[4:7], s36 offen offset:0 lds
    buffer_load_dwordx4 v4, s[4:7], s36 offen offset:1024 lds
    buffer_load_dwordx4 v4, s[4:7], s36 offen offset:2048 lds
    buffer_load_dwordx4 v4, s[4:7], s36 offen offset:3072 lds
    s_add_u32 s36, s36, 4096
    s_add_u32 m0, m0, 4096
    s_nop 0
    buffer_load_dwordx4 v4, s[4:7], s36 offen offset:0 lds
    buffer_load_dwordx4 v4, s[4:7], s36 offen offset:1024 lds
    buffer_load_dwordx4 v4, s[4:7], s36 offen offset:2048 lds
    ds_read_b128 v[64:67], v5 offset:0
    ds_read_b128 v[68:71], v5 offset:14336
    ds_read_b128 v[72:75], v5 offset:1024
    ds_read_b128 v[76:79], v5 offset:15360
    s_waitcnt lgkmcnt(2)
    v_mfma_f32_16x16x32_bf16 v[8:11], a[0:3], v[64:67], 0
    v_mfma_f32_16x16x32_bf16 v[12:15], a[0:3], v[68:71], 0
    v_mfma_f32_16x16x32_bf16 v[16:19], a[56:59], v[64:67], 0
    v_mfma_f32_16x16x32_bf16 v[20:23], a[56:59], v[68:71], 0
    v_mfma_f32_16x16x32_bf16 v[24:27], a[112:115], v[64:67], 0
    v_mfma_f32_16x16x32_bf16 v[28:31], a[112:115], v[68:71], 0
    v_mfma_f32_16x16x32_bf16 v[32:35], a[168:171], v[64:67], 0
    v_mfma_f32_16x16x32_bf16 v[36:39], a[168:171], v[68:71], 0
    v_mfma_f32_16x16x32_bf16 v[40:43], a[224:227], v[64:67], 0
    v_mfma_f32_16x16x32_bf16 v[44:47], a[224:227], v[68:71], 0
    v_mfma_f32_16x16x32_bf16 v[48:51], v[144:147], v[64:67], 0
    v_mfma_f32_16x16x32_bf16 v[52:55], v[144:147], v[68:71], 0
    v_mfma_f32_16x16x32_bf16 v[56:59], v[200:203], v[64:67], 0
    v_mfma_f32_16x16x32_bf16 v[60:63], v[200:203], v[68:71], 0
    ds_read_b128 v[64:67], v5 offset:2048
    ds_read_b128 v[68:71], v5 offset:16384
    s_waitcnt lgkmcnt(2)
    v_mfma_f32_16x16x32_bf16 v[8:11], a[4:7], v[72:75], v[8:11]
    v_mfma_f32_16x16x32_bf16 v[12:15], a[4:7], v[76:79], v[12:15]
    v_mfma_f32_16x16x32_bf16 v[16:19], a[60:63], v[72:75], v[16:19]
    v_mfma_f32_16x16x32_bf16 v[20:23], a[60:63], v[76:79], v[20:23]
    v_mfma_f32_16x16x32_bf16 v[24:27], a[116:119], v[72:75], v[24:27]
    v_mfma_f32_16x16x32_bf16 v[28:31], a[116:119], v[76:79], v[28:31]
    v_mfma_f32_16x16x32_bf16 v[32:35], a[172:175], v[72:75], v[32:35]
    v_mfma_f32_16x16x32_bf16 v[36:39], a[172:175], v[76:79], v[36:39]
    v_mfma_f32_16x16x32_bf16 v[40:43], a[228:231], v[72:75], v[40:43]
    v_mfma_f32_16x16x32_bf16 v[44:47], a[228:231], v[76:79], v[44:47]
    v_mfma_f32_16x16x32_bf16 v[48:51], v[148:151], v[72:75], v[48:51]
    v_mfma_f32_16x16x32_bf16 v[52:55], v[148:151], v[76:79], v[52:55]
    v_mfma_f32_16x16x32_bf16 v[56:59], v[204:207], v[72:75], v[56:59]
    v_mfma_f32_16x16x32_bf16 v[60:63], v[204:207], v[76:79], v[60:63]
    ds_read_b128 v[72:75], v5 offset:3072
    ds_read_b128 v[76:79], v5 offset:17408
    s_waitcnt lgkmcnt(2)
    v_mfma_f32_16x16x32_bf16 v[8:11], a[8:11], v[64:67], v[8:11]
    v_mfma_f32_16x16x32_bf16 v[12:15], a[8:11], v[68:71], v[12:15]
    v_mfma_f32_16x16x32_bf16 v[16:19], a[64:67], v[64:67], v[16:19]
    v_mfma_f32_16x16x32_bf16 v[20:23], a[64:67], v[68:71], v[20:23]
    v_mfma_f32_16x16x32_bf16 v[24:27], a[120:123], v[64:67], v[24:27]
    v_mfma_f32_16x16x32_bf16 v[28:31], a[120:123], v[68:71], v[28:31]
    v_mfma_f32_16x16x32_bf16 v[32:35], a[176:179], v[64:67], v[32:35]
    v_mfma_f32_16x16x32_bf16 v[36:39], a[176:179], v[68:71], v[36:39]
    v_mfma_f32_16x16x32_bf16 v[40:43], a[232:235], v[64:67], v[40:43]
    v_mfma_f32_16x16x32_bf16 v[44:47], a[232:235], v[68:71], v[44:47]
    v_mfma_f32_16x16x32_bf16 v[48:51], v[152:155], v[64:67], v[48:51]
    v_mfma_f32_16x16x32_bf16 v[52:55], v[152:155], v[68:71], v[52:55]
    v_mfma_f32_16x16x32_bf16 v[56:59], v[208:211], v[64:67], v[56:59]
    v_mfma_f32_16x16x32_bf16 v[60:63], v[208:211], v[68:71], v[60:63]
    ds_read_b128 v[64:67], v5 offset:4096
    ds_read_b128 v[68:71], v5 offset:18432
    s_waitcnt lgkmcnt(2)
    v_mfma_f32_16x16x32_bf16 v[8:11], a[12:15], v[72:75], v[8:11]
    v_mfma_f32_16x16x32_bf16 v[12:15], a[12:15], v[76:79], v[12:15]
    v_mfma_f32_16x16x32_bf16 v[16:19], a[68:71], v[72:75], v[16:19]
    v_mfma_f32_16x16x32_bf16 v[20:23], a[68:71], v[76:79], v[20:23]
    v_mfma_f32_16x16x32_bf16 v[24:27], a[124:127], v[72:75], v[24:27]
    v_mfma_f32_16x16x32_bf16 v[28:31], a[124:127], v[76:79], v[28:31]
    v_mfma_f32_16x16x32_bf16 v[32:35], a[180:183], v[72:75], v[32:35]
    v_mfma_f32_16x16x32_bf16 v[36:39], a[180:183], v[76:79], v[36:39]
    v_mfma_f32_16x16x32_bf16 v[40:43], a[236:239], v[72:75], v[40:43]
    v_mfma_f32_16x16x32_bf16 v[44:47], a[236:239], v[76:79], v[44:47]
    v_mfma_f32_16x16x32_bf16 v[48:51], v[156:159], v[72:75], v[48:51]
    v_mfma_f32_16x16x32_bf16 v[52:55], v[156:159], v[76:79], v[52:55]
    v_mfma_f32_16x16x32_bf16 v[56:59], v[212:215], v[72:75], v[56:59]
    v_mfma_f32_16x16x32_bf16 v[60:63], v[212:215], v[76:79], v[60:63]
    ds_read_b128 v[72:75], v5 offset:5120
    ds_read_b128 v[76:79], v5 offset:19456
    s_waitcnt lgkmcnt(2)
    v_mfma_f32_16x16x32_bf16 v[8:11], a[16:19], v[64:67], v[8:11]
    v_mfma_f32_16x16x32_bf16 v[12:15], a[16:19], v[68:71], v[12:15]
    v_mfma_f32_16x16x32_bf16 v[16:19], a[72:75], v[64:67], v[16:19]
    v_mfma_f32_16x16x32_bf16 v[20:23], a[72:75], v[68:71], v[20:23]
    v_mfma_f32_16x16x32_bf16 v[24:27], a[128:131], v[64:67], v[24:27]
    v_mfma_f32_16x16x32_bf16 v[28:31], a[128:131], v[68:71], v[28:31]
    v_mfma_f32_16x16x32_bf16 v[32:35], a[184:187], v[64:67], v[32:35]
    v_mfma_f32_16x16x32_bf16 v[36:39], a[184:187], v[68:71], v[36:39]
    v_mfma_f32_16x16x32_bf16 v[40:43], a[240:243], v[64:67], v[40:43]
    v_mfma_f32_16x16x32_bf16 v[44:47], a[240:243], v[68:71], v[44:47]
    v_mfma_f32_16x16x32_bf16 v[48:51], v[160:163], v[64:67], v[48:51]
    v_mfma_f32_16x16x32_bf16 v[52:55], v[160:163], v[68:71], v[52:55]
    v_mfma_f32_16x16x32_bf16 v[56:59], v[216:219], v[64:67], v[56:59]
    v_mfma_f32_16x16x32_bf16 v[60:63], v[216:219], v[68:71], v[60:63]
    ds_read_b128 v[64:67], v5 offset:6144
    ds_read_b128 v[68:71], v5 offset:20480
    s_waitcnt lgkmcnt(2)
    v_mfma_f32_16x16x32_bf16 v[8:11], a[20:23], v[72:75], v[8:11]
    v_mfma_f32_16x16x32_bf16 v[12:15], a[20:23], v[76:79], v[12:15]
    v_mfma_f32_16x16x32_bf16 v[16:19], a[76:79], v[72:75], v[16:19]
    v_mfma_f32_16x16x32_bf16 v[20:23], a[76:79], v[76:79], v[20:23]
    v_mfma_f32_16x16x32_bf16 v[24:27], a[132:135], v[72:75], v[24:27]
    v_mfma_f32_16x16x32_bf16 v[28:31], a[132:135], v[76:79], v[28:31]
    v_mfma_f32_16x16x32_bf16 v[32:35], a[188:191], v[72:75], v[32:35]
    v_mfma_f32_16x16x32_bf16 v[36:39], a[188:191], v[76:79], v[36:39]
    v_mfma_f32_16x16x32_bf16 v[40:43], a[244:247], v[72:75], v[40:43]
    v_mfma_f32_16x16x32_bf16 v[44:47], a[244:247], v[76:79], v[44:47]
    v_mfma_f32_16x16x32_bf16 v[48:51], v[164:167], v[72:75], v[48:51]
    v_mfma_f32_16x16x32_bf16 v[52:55], v[164:167], v[76:79], v[52:55]
    v_mfma_f32_16x16x32_bf16 v[56:59], v[220:223], v[72:75], v[56:59]
    v_mfma_f32_16x16x32_bf16 v[60:63], v[220:223], v[76:79], v[60:63]
    ds_read_b128 v[72:75], v5 offset:7168
    ds_read_b128 v[76:79], v5 offset:21504
    s_waitcnt lgkmcnt(2)
    v_mfma_f32_16x16x32_bf16 v[8:11], a[24:27], v[64:67], v[8:11]
    v_mfma_f32_16x16x32_bf16 v[12:15], a[24:27], v[68:71], v[12:15]
    v_mfma_f32_16x16x32_bf16 v[16:19], a[80:83], v[64:67], v[16:19]
    v_mfma_f32_16x16x32_bf16 v[20:23], a[80:83], v[68:71], v[20:23]
    v_mfma_f32_16x16x32_bf16 v[24:27], a[136:139], v[64:67], v[24:27]
    v_mfma_f32_16x16x32_bf16 v[28:31], a[136:139], v[68:71], v[28:31]
    v_mfma_f32_16x16x32_bf16 v[32:35], a[192:195], v[64:67], v[32:35]
    v_mfma_f32_16x16x32_bf16 v[36:39], a[192:195], v[68:71], v[36:39]
    v_mfma_f32_16x16x32_bf16 v[40:43], a[248:251], v[64:67], v[40:43]
    v_mfma_f32_16x16x32_bf16 v[44:47], a[248:251], v[68:71], v[44:47]
    v_mfma_f32_16x16x32_bf16 v[48:51], v[168:171], v[64:67], v[48:51]
    v_mfma_f32_16x16x32_bf16 v[52:55], v[168:171], v[68:71], v[52:55]
    v_mfma_f32_16x16x32_bf16 v[56:59], v[224:227], v[64:67], v[56:59]
    v_mfma_f32_16x16x32_bf16 v[60:63], v[224:227], v[68:71], v[60:63]
    s_cmp_eq_u32 s39, 0
    s_cbranch_scc1 Lpf_106
    s_waitcnt vmcnt(7)
    s_mov_b64 exec, 1
    buffer_store_dword v117, v116, s[4:7], s39 offen sc1
    s_mov_b64 exec, -1
Lpf_106:
    ds_read_b128 v[64:67], v5 offset:8192
    ds_read_b128 v[68:71], v5 offset:22528
    s_waitcnt lgkmcnt(2)
    v_mfma_f32_16x16x32_bf16 v[8:11], a[28:31], v[72:75], v[8:11]
    v_mfma_f32_16x16x32_bf16 v[12:15], a[28:31], v[76:79], v[12:15]
    v_mfma_f32_16x16x32_bf16 v[16:19], a[84:87], v[72:75], v[16:19]
    v_mfma_f32_16x16x32_bf16 v[20:23], a[84:87], v[76:79], v[20:23]
    v_mfma_f32_16x16x32_bf16 v[24:27], a[140:143], v[72:75], v[24:27]
    v_mfma_f32_16x16x32_bf16 v[28:31], a[140:143], v[76:79], v[28:31]
    v_mfma_f32_16x16x32_bf16 v[32:35], a[196:199], v[72:75], v[32:35]
    v_mfma_f32_16x16x32_bf16 v[36:39], a[196:199], v[76:79], v[36:39]
    v_mfma_f32_16x16x32_bf16 v[40:43], a[252:255], v[72:75], v[40:43]
    v_mfma_f32_16x16x32_bf16 v[44:47], a[252:255], v[76:79], v[44:47]
    v_mfma_f32_16x16x32_bf16 v[48:51], v[172:175], v[72:75], v[48:51]
    v_mfma_f32_16x16x32_bf16 v[52:55], v[172:175], v[76:79], v[52:55]
    v_mfma_f32_16x16x32_bf16 v[56:59], v[228:231], v[72:75], v[56:59]
    v_mfma_f32_16x16x32_bf16 v[60:63], v[228:231], v[76:79], v[60:63]
    ds_read_b128 v[72:75], v5 offset:9216
    ds_read_b128 v[76:79], v5 offset:23552
    s_waitcnt lgkmcnt(2)
    v_mfma_f32_16x16x32_bf16 v[8:11], a[32:35], v[64:67], v[8:11]
    v_mfma_f32_16x16x32_bf16 v[12:15], a[32:35], v[68:71], v[12:15]
    v_mfma_f32_16x16x32_bf16 v[16:19], a[88:91], v[64:67], v[16:19]
    v_mfma_f32_16x16x32_bf16 v[20:23], a[88:91], v[68:71], v[20:23]
    v_mfma_f32_16x16x32_bf16 v[24:27], a[144:147], v[64:67], v[24:27]
    v_mfma_f32_16x16x32_bf16 v[28:31], a[144:147], v[68:71], v[28:31]
    v_mfma_f32_16x16x32_bf16 v[32:35], a[200:203], v[64:67], v[32:35]
    v_mfma_f32_16x16x32_bf16 v[36:39], a[200:203], v[68:71], v[36:39]
    v_mfma_f32_16x16x32_bf16 v[40:43], v[120:123], v[64:67], v[40:43]
    v_mfma_f32_16x16x32_bf16 v[44:47], v[120:123], v[68:71], v[44:47]
    v_mfma_f32_16x16x32_bf16 v[48:51], v[176:179], v[64:67], v[48:51]
    v_mfma_f32_16x16x32_bf16 v[52:55], v[176:179], v[68:71], v[52:55]
    v_mfma_f32_16x16x32_bf16 v[56:59], v[232:235], v[64:67], v[56:59]
    v_mfma_f32_16x16x32_bf16 v[60:63], v[232:235], v[68:71], v[60:63]
    ds_read_b128 v[64:67], v5 offset:10240
    ds_read_b128 v[68:71], v5 offset:24576
    s_waitcnt lgkmcnt(2)
    v_mfma_f32_16x16x32_bf16 v[8:11], a[36:39], v[72:75], v[8:11]
    v_mfma_f32_16x16x32_bf16 v[12:15], a[36:39], v[76:79], v[12:15]
    v_mfma_f32_16x16x32_bf16 v[16:19], a[92:95], v[72:75], v[16:19]
    v_mfma_f32_16x16x32_bf16 v[20:23], a[92:95], v[76:79], v[20:23]
    v_mfma_f32_16x16x32_bf16 v[24:27], a[148:151], v[72:75], v[24:27]
    v_mfma_f32_16x16x32_bf16 v[28:31], a[148:151], v[76:79], v[28:31]
    v_mfma_f32_16x16x32_bf16 v[32:35], a[204:207], v[72:75], v[32:35]
    v_mfma_f32_16x16x32_bf16 v[36:39], a[204:207], v[76:79], v[36:39]
    v_mfma_f32_16x16x32_bf16 v[40:43], v[124:127], v[72:75], v[40:43]
    v_mfma_f32_16x16x32_bf16 v[44:47], v[124:127], v[76:79], v[44:47]
    v_mfma_f32_16x16x32_bf16 v[48:51], v[180:183], v[72:75], v[48:51]
    v_mfma_f32_16x16x32_bf16 v[52:55], v[180:183], v[76:79], v[52:55]
    v_mfma_f32_16x16x32_bf16 v[56:59], v[236:239], v[72:75], v[56:59]
    v_mfma_f32_16x16x32_bf16 v[60:63], v[236:239], v[76:79], v[60:63]
    ds_read_b128 v[72:75], v5 offset:11264
    ds_read_b128 v[76:79], v5 offset:25600
    s_waitcnt lgkmcnt(2)
    v_mfma_f32_16x16x32_bf16 v[8:11], a[40:43], v[64:67], v[8:11]
    v_mfma_f32_16x16x32_bf16 v[12:15], a[40:43], v[68:71], v[12:15]
    v_mfma_f32_16x16x32_bf16 v[16:19], a[96:99], v[64:67], v[16:19]
    v_mfma_f32_16x16x32_bf16 v[20:23], a[96:99], v[68:71], v[20:23]
    v_mfma_f32_16x16x32_bf16 v[24:27], a[152:155], v[64:67], v[24:27]
    v_mfma_f32_16x16x32_bf16 v[28:31], a[152:155], v[68:71], v[28:31]
    v_mfma_f32_16x16x32_bf16 v[32:35], a[208:211], v[64:67], v[32:35]
    v_mfma_f32_16x16x32_bf16 v[36:39], a[208:211], v[68:71], v[36:39]
    v_mfma_f32_16x16x32_bf16 v[40:43], v[128:131], v[64:67], v[40:43]
    v_mfma_f32_16x16x32_bf16 v[44:47], v[128:131], v[68:71], v[44:47]
    v_mfma_f32_16x16x32_bf16 v[48:51], v[184:187], v[64:67], v[48:51]
    v_mfma_f32_16x16x32_bf16 v[52:55], v[184:187], v[68:71], v[52:55]
    v_mfma_f32_16x16x32_bf16 v[56:59], v[240:243], v[64:67], v[56:59]
    v_mfma_f32_16x16x32_bf16 v[60:63], v[240:243], v[68:71], v[60:63]
    ds_read_b128 v[64:67], v5 offset:12288
    ds_read_b128 v[68:71], v5 offset:26624
    s_waitcnt lgkmcnt(2)
    v_mfma_f32_16x16x32_bf16 v[8:11], a[44:47], v[72:75], v[8:11]
    v_mfma_f32_16x16x32_bf16 v[12:15], a[44:47], v[76:79], v[12:15]
    v_mfma_f32_16x16x32_bf16 v[16:19], a[100:103], v[72:75], v[16:19]
    v_mfma_f32_16x16x32_bf16 v[20:23], a[100:103], v[76:79], v[20:23]
    v_mfma_f32_16x16x32_bf16 v[24:27], a[156:159], v[72:75], v[24:27]
    v_mfma_f32_16x16x32_bf16 v[28:31], a[156:159], v[76:79], v[28:31]
    v_mfma_f32_16x16x32_bf16 v[32:35], a[212:215], v[72:75], v[32:35]
    v_mfma_f32_16x16x32_bf16 v[36:39], a[212:215], v[76:79], v[36:39]
    v_mfma_f32_16x16x32_bf16 v[40:43], v[132:135], v[72:75], v[40:43]
    v_mfma_f32_16x16x32_bf16 v[44:47], v[132:135], v[76:79], v[44:47]
    v_mfma_f32_16x16x32_bf16 v[48:51], v[188:191], v[72:75], v[48:51]
    v_mfma_f32_16x16x32_bf16 v[52:55], v[188:191], v[76:79], v[52:55]
    v_mfma_f32_16x16x32_bf16 v[56:59], v[244:247], v[72:75], v[56:59]
    v_mfma_f32_16x16x32_bf16 v[60:63], v[244:247], v[76:79], v[60:63]
    ds_read_b128 v[72:75], v5 offset:13312
    ds_read_b128 v[76:79], v5 offset:27648
    s_waitcnt lgkmcnt(2)
    v_mfma_f32_16x16x32_bf16 v[8:11], a[48:51], v[64:67], v[8:11]
    v_mfma_f32_16x16x32_bf16 v[12:15], a[48:51], v[68:71], v[12:15]
    v_mfma_f32_16x16x32_bf16 v[16:19], a[104:107], v[64:67], v[16:19]
    v_mfma_f32_16x16x32_bf16 v[20:23], a[104:107], v[68:71], v[20:23]
    v_mfma_f32_16x16x32_bf16 v[24:27], a[160:163], v[64:67], v[24:27]
    v_mfma_f32_16x16x32_bf16 v[28:31], a[160:163], v[68:71], v[28:31]
    v_mfma_f32_16x16x32_bf16 v[32:35], a[216:219], v[64:67], v[32:35]
    v_mfma_f32_16x16x32_bf16 v[36:39], a[216:219], v[68:71], v[36:39]
    v_mfma_f32_16x16x32_bf16 v[40:43], v[136:139], v[64:67], v[40:43]
    v_mfma_f32_16x16x32_bf16 v[44:47], v[136:139], v[68:71], v[44:47]
    v_mfma_f32_16x16x32_bf16 v[48:51], v[192:195], v[64:67], v[48:51]
    v_mfma_f32_16x16x32_bf16 v[52:55], v[192:195], v[68:71], v[52:55]
    v_mfma_f32_16x16x32_bf16 v[56:59], v[248:251], v[64:67], v[56:59]
    v_mfma_f32_16x16x32_bf16 v[60:63], v[248:251], v[68:71], v[60:63]
    s_waitcnt lgkmcnt(0)
    v_mfma_f32_16x16x32_bf16 v[8:11], a[52:55], v[72:75], v[8:11]
    v_mfma_f32_16x16x32_bf16 v[12:15], a[52:55], v[76:79], v[12:15]
    v_mfma_f32_16x16x32_bf16 v[16:19], a[108:111], v[72:75], v[16:19]
    v_mfma_f32_16x16x32_bf16 v[20:23], a[108:111], v[76:79], v[20:23]
    v_mfma_f32_16x16x32_bf16 v[24:27], a[164:167], v[72:75], v[24:27]
    v_mfma_f32_16x16x32_bf16 v[28:31], a[164:167], v[76:79], v[28:31]
    v_mfma_f32_16x16x32_bf16 v[32:35], a[220:223], v[72:75], v[32:35]
    v_mfma_f32_16x16x32_bf16 v[36:39], a[220:223], v[76:79], v[36:39]
    v_mfma_f32_16x16x32_bf16 v[40:43], v[140:143], v[72:75], v[40:43]
    v_mfma_f32_16x16x32_bf16 v[44:47], v[140:143], v[76:79], v[44:47]
    v_mfma_f32_16x16x32_bf16 v[48:51], v[196:199], v[72:75], v[48:51]
    v_mfma_f32_16x16x32_bf16 v[52:55], v[196:199], v[76:79], v[52:55]
    v_mfma_f32_16x16x32_bf16 v[56:59], v[252:255], v[72:75], v[56:59]
    v_mfma_f32_16x16x32_bf16 v[60:63], v[252:255], v[76:79], v[60:63]
    s_nop 7
    s_mul_i32 s28, s26, 114688
    s_mul_i32 s29, s30, 14336
    s_add_u32 s28, s28, s29
    s_add_u32 s28, s28, 48234496
    s_lshl_b32 s29, s33, 10
    s_add_u32 s53, s28, s29
    s_lshl_b32 s29, s32, 10
    s_add_u32 s52, s28, s29
    v_cvt_pk_bf16_f32 v108, v8, v9
    v_lshlrev_b32 v109, 16, v108
    v_and_b32 v110, 0xffff0000, v108
    v_add_f32 v109, v109, v80
    v_add_f32 v110, v110, v81
    v_cvt_pk_bf16_f32 v108, v109, v110
    v_lshlrev_b32 v109, 16, v108
    v_and_b32 v110, 0xffff0000, v108
    v_max_f32 v109, 0, v109
    v_max_f32 v110, 0, v110
    v_mul_f32 v109, v109, v109
    v_mul_f32 v110, v110, v110
    v_cvt_pk_bf16_f32 v64, v109, v110
    v_cvt_pk_bf16_f32 v108, v16, v17
    v_lshlrev_b32 v109, 16, v108
    v_and_b32 v110, 0xffff0000, v108
    v_add_f32 v109, v109, v84
    v_add_f32 v110, v110, v85
    v_cvt_pk_bf16_f32 v108, v109, v110
    v_lshlrev_b32 v109, 16, v108
    v_and_b32 v110, 0xffff0000, v108
    v_max_f32 v109, 0, v109
    v_max_f32 v110, 0, v110
    v_mul_f32 v109, v109, v109
    v_mul_f32 v110, v110, v110
    v_cvt_pk_bf16_f32 v65, v109, v110
    v_cvt_pk_bf16_f32 v108, v10, v11
    v_lshlrev_b32 v109, 16, v108
    v_and_b32 v110, 0xffff0000, v108
    v_add_f32 v109, v109, v82
    v_add_f32 v110, v110, v83
    v_cvt_pk_bf16_f32 v108, v109, v110
    v_lshlrev_b32 v109, 16, v108
    v_and_b32 v110, 0xffff0000, v108
    v_max_f32 v109, 0, v109
    v_max_f32 v110, 0, v110
    v_mul_f32 v109, v109, v109
    v_mul_f32 v110, v110, v110
    v_cvt_pk_bf16_f32 v66, v109, v110
    v_cvt_pk_bf16_f32 v108, v18, v19
    v_lshlrev_b32 v109, 16, v108
    v_and_b32 v110, 0xffff0000, v108
    v_add_f32 v109, v109, v86
    v_add_f32 v110, v110, v87
    v_cvt_pk_bf16_f32 v108, v109, v110
    v_lshlrev_b32 v109, 16, v108
    v_and_b32 v110, 0xffff0000, v108
    v_max_f32 v109, 0, v109
    v_max_f32 v110, 0, v110
    v_mul_f32 v109, v109, v109
    v_mul_f32 v110, v110, v110
    v_cvt_pk_bf16_f32 v67, v109, v110
    buffer_store_dwordx4 v[64:67], v4, s[4:7], s52 offen offset:0 sc1
    v_cvt_pk_bf16_f32 v108, v24, v25
    v_lshlrev_b32 v109, 16, v108
    v_and_b32 v110, 0xffff0000, v108
    v_add_f32 v109, v109, v88
    v_add_f32 v110, v110, v89
    v_cvt_pk_bf16_f32 v108, v109, v110
    v_lshlrev_b32 v109, 16, v108
    v_and_b32 v110, 0xffff0000, v108
    v_max_f32 v109, 0, v109
    v_max_f32 v110, 0, v110
    v_mul_f32 v109, v109, v109
    v_mul_f32 v110, v110, v110
    v_cvt_pk_bf16_f32 v68, v109, v110
    v_cvt_pk_bf16_f32 v108, v32, v33
    v_lshlrev_b32 v109, 16, v108
    v_and_b32 v110, 0xffff0000, v108
    v_add_f32 v109, v109, v92
    v_add_f32 v110, v110, v93
    v_cvt_pk_bf16_f32 v108, v109, v110
    v_lshlrev_b32 v109, 16, v108
    v_and_b32 v110, 0xffff0000, v108
    v_max_f32 v109, 0, v109
    v_max_f32 v110, 0, v110
    v_mul_f32 v109, v109, v109
    v_mul_f32 v110, v110, v110
    v_cvt_pk_bf16_f32 v69, v109, v110
    v_cvt_pk_bf16_f32 v108, v26, v27
    v_lshlrev_b32 v109, 16, v108
    v_and_b32 v110, 0xffff0000, v108
    v_add_f32 v109, v109, v90
    v_add_f32 v110, v110, v91
    v_cvt_pk_bf16_f32 v108, v109, v110
    v_lshlrev_b32 v109, 16, v108
    v_and_b32 v110, 0xffff0000, v108
    v_max_f32 v109, 0, v109
    v_max_f32 v110, 0, v110
    v_mul_f32 v109, v109, v109
    v_mul_f32 v110, v110, v110
    v_cvt_pk_bf16_f32 v70, v109, v110
    v_cvt_pk_bf16_f32 v108, v34, v35
    v_lshlrev_b32 v109, 16, v108
    v_and_b32 v110, 0xffff0000, v108
    v_add_f32 v109, v109, v94
    v_add_f32 v110, v110, v95
    v_cvt_pk_bf16_f32 v108, v109, v110
    v_lshlrev_b32 v109, 16, v108
    v_and_b32 v110, 0xffff0000, v108
    v_max_f32 v109, 0, v109
    v_max_f32 v110, 0, v110
    v_mul_f32 v109, v109, v109
    v_mul_f32 v110, v110, v110
    v_cvt_pk_bf16_f32 v71, v109, v110
    buffer_store_dwordx4 v[68:71], v4, s[4:7], s52 offen offset:1024 sc1
    v_cvt_pk_bf16_f32 v108, v40, v41
    v_lshlrev_b32 v109, 16, v108
    v_and_b32 v110, 0xffff0000, v108
    v_add_f32 v109, v109, v96
    v_add_f32 v110, v110, v97
    v_cvt_pk_bf16_f32 v108, v109, v110
    v_lshlrev_b32 v109, 16, v108
    v_and_b32 v110, 0xffff0000, v108
    v_max_f32 v109, 0, v109
    v_max_f32 v110, 0, v110
    v_mul_f32 v109, v109, v109
    v_mul_f32 v110, v110, v110
    v_cvt_pk_bf16_f32 v72, v109, v110
    v_cvt_pk_bf16_f32 v108, v48, v49
    v_lshlrev_b32 v109, 16, v108
    v_and_b32 v110, 0xffff0000, v108
    v_add_f32 v109, v109, v100
    v_add_f32 v110, v110, v101
    v_cvt_pk_bf16_f32 v108, v109, v110
    v_lshlrev_b32 v109, 16, v108
    v_and_b32 v110, 0xffff0000, v108
    v_max_f32 v109, 0, v109
    v_max_f32 v110, 0, v110
    v_mul_f32 v109, v109, v109
    v_mul_f32 v110, v110, v110
    v_cvt_pk_bf16_f32 v73, v109, v110
    v_cvt_pk_bf16_f32 v108, v42, v43
    v_lshlrev_b32 v109, 16, v108
    v_and_b32 v110, 0xffff0000, v108
    v_add_f32 v109, v109, v98
    v_add_f32 v110, v110, v99
    v_cvt_pk_bf16_f32 v108, v109, v110
    v_lshlrev_b32 v109, 16, v108
    v_and_b32 v110, 0xffff0000, v108
    v_max_f32 v109, 0, v109
    v_max_f32 v110, 0, v110
    v_mul_f32 v109, v109, v109
    v_mul_f32 v110, v110, v110
    v_cvt_pk_bf16_f32 v74, v109, v110
    v_cvt_pk_bf16_f32 v108, v50, v51
    v_lshlrev_b32 v109, 16, v108
    v_and_b32 v110, 0xffff0000, v108
    v_add_f32 v109, v109, v102
    v_add_f32 v110, v110, v103
    v_cvt_pk_bf16_f32 v108, v109, v110
    v_lshlrev_b32 v109, 16, v108
    v_and_b32 v110, 0xffff0000, v108
    v_max_f32 v109, 0, v109
    v_max_f32 v110, 0, v110
    v_mul_f32 v109, v109, v109
    v_mul_f32 v110, v110, v110
    v_cvt_pk_bf16_f32 v75, v109, v110
    buffer_store_dwordx4 v[72:75], v4, s[4:7], s52 offen offset:2048 sc1
    v_cvt_pk_bf16_f32 v108, v56, v57
    v_lshlrev_b32 v109, 16, v108
    v_and_b32 v110, 0xffff0000, v108
    v_add_f32 v109, v109, v104
    v_add_f32 v110, v110, v105
    v_cvt_pk_bf16_f32 v108, v109, v110
    v_lshlrev_b32 v109, 16, v108
    v_and_b32 v110, 0xffff0000, v108
    v_max_f32 v109, 0, v109
    v_max_f32 v110, 0, v110
    v_mul_f32 v109, v109, v109
    v_mul_f32 v110, v110, v110
    v_cvt_pk_bf16_f32 v112, v109, v110
    v_cvt_pk_bf16_f32 v108, v58, v59
    v_lshlrev_b32 v109, 16, v108
    v_and_b32 v110, 0xffff0000, v108
    v_add_f32 v109, v109, v106
    v_add_f32 v110, v110, v107
    v_cvt_pk_bf16_f32 v108, v109, v110
    v_lshlrev_b32 v109, 16, v108
    v_and_b32 v110, 0xffff0000, v108
    v_max_f32 v109, 0, v109
    v_max_f32 v110, 0, v110
    v_mul_f32 v109, v109, v109
    v_mul_f32 v110, v110, v110
    v_cvt_pk_bf16_f32 v113, v109, v110
    buffer_store_dword v112, v118, s[4:7], s53 offen sc1
    buffer_store_dword v113, v118, s[4:7], s53 offen offset:8 sc1
    s_add_u32 s52, s52, 57344
    s_add_u32 s53, s53, 57344
    v_cvt_pk_bf16_f32 v108, v12, v13
    v_lshlrev_b32 v109, 16, v108
    v_and_b32 v110, 0xffff0000, v108
    v_add_f32 v109, v109, v80
    v_add_f32 v110, v110, v81
    v_cvt_pk_bf16_f32 v108, v109, v110
    v_lshlrev_b32 v109, 16, v108
    v_and_b32 v110, 0xffff0000, v108
    v_max_f32 v109, 0, v109
    v_max_f32 v110, 0, v110
    v_mul_f32 v109, v109, v109
    v_mul_f32 v110, v110, v110
    v_cvt_pk_bf16_f32 v76, v109, v110
    v_cvt_pk_bf16_f32 v108, v20, v21
    v_lshlrev_b32 v109, 16, v108
    v_and_b32 v110, 0xffff0000, v108
    v_add_f32 v109, v109, v84
    v_add_f32 v110, v110, v85
    v_cvt_pk_bf16_f32 v108, v109, v110
    v_lshlrev_b32 v109, 16, v108
    v_and_b32 v110, 0xffff0000, v108
    v_max_f32 v109, 0, v109
    v_max_f32 v110, 0, v110
    v_mul_f32 v109, v109, v109
    v_mul_f32 v110, v110, v110
    v_cvt_pk_bf16_f32 v77, v109, v110
    v_cvt_pk_bf16_f32 v108, v14, v15
    v_lshlrev_b32 v109, 16, v108
    v_and_b32 v110, 0xffff0000, v108
    v_add_f32 v109, v109, v82
    v_add_f32 v110, v110, v83
    v_cvt_pk_bf16_f32 v108, v109, v110
    v_lshlrev_b32 v109, 16, v108
    v_and_b32 v110, 0xffff0000, v108
    v_max_f32 v109, 0, v109
    v_max_f32 v110, 0, v110
    v_mul_f32 v109, v109, v109
    v_mul_f32 v110, v110, v110
    v_cvt_pk_bf16_f32 v78, v109, v110
    v_cvt_pk_bf16_f32 v108, v22, v23
    v_lshlrev_b32 v109, 16, v108
    v_and_b32 v110, 0xffff0000, v108
    v_add_f32 v109, v109, v86
    v_add_f32 v110, v110, v87
    v_cvt_pk_bf16_f32 v108, v109, v110
    v_lshlrev_b32 v109, 16, v108
    v_and_b32 v110, 0xffff0000, v108
    v_max_f32 v109, 0, v109
    v_max_f32 v110, 0, v110
    v_mul_f32 v109, v109, v109
    v_mul_f32 v110, v110, v110
    v_cvt_pk_bf16_f32 v79, v109, v110
    buffer_store_dwordx4 v[76:79], v4, s[4:7], s52 offen offset:0 sc1
    v_cvt_pk_bf16_f32 v108, v28, v29
    v_lshlrev_b32 v109, 16, v108
    v_and_b32 v110, 0xffff0000, v108
    v_add_f32 v109, v109, v88
    v_add_f32 v110, v110, v89
    v_cvt_pk_bf16_f32 v108, v109, v110
    v_lshlrev_b32 v109, 16, v108
    v_and_b32 v110, 0xffff0000, v108
    v_max_f32 v109, 0, v109
    v_max_f32 v110, 0, v110
    v_mul_f32 v109, v109, v109
    v_mul_f32 v110, v110, v110
    v_cvt_pk_bf16_f32 v64, v109, v110
    v_cvt_pk_bf16_f32 v108, v36, v37
    v_lshlrev_b32 v109, 16, v108
    v_and_b32 v110, 0xffff0000, v108
    v_add_f32 v109, v109, v92
    v_add_f32 v110, v110, v93
    v_cvt_pk_bf16_f32 v108, v109, v110
    v_lshlrev_b32 v109, 16, v108
    v_and_b32 v110, 0xffff0000, v108
    v_max_f32 v109, 0, v109
    v_max_f32 v110, 0, v110
    v_mul_f32 v109, v109, v109
    v_mul_f32 v110, v110, v110
    v_cvt_pk_bf16_f32 v65, v109, v110
    v_cvt_pk_bf16_f32 v108, v30, v31
    v_lshlrev_b32 v109, 16, v108
    v_and_b32 v110, 0xffff0000, v108
    v_add_f32 v109, v109, v90
    v_add_f32 v110, v110, v91
    v_cvt_pk_bf16_f32 v108, v109, v110
    v_lshlrev_b32 v109, 16, v108
    v_and_b32 v110, 0xffff0000, v108
    v_max_f32 v109, 0, v109
    v_max_f32 v110, 0, v110
    v_mul_f32 v109, v109, v109
    v_mul_f32 v110, v110, v110
    v_cvt_pk_bf16_f32 v66, v109, v110
    v_cvt_pk_bf16_f32 v108, v38, v39
    v_lshlrev_b32 v109, 16, v108
    v_and_b32 v110, 0xffff0000, v108
    v_add_f32 v109, v109, v94
    v_add_f32 v110, v110, v95
    v_cvt_pk_bf16_f32 v108, v109, v110
    v_lshlrev_b32 v109, 16, v108
    v_and_b32 v110, 0xffff0000, v108
    v_max_f32 v109, 0, v109
    v_max_f32 v110, 0, v110
    v_mul_f32 v109, v109, v109
    v_mul_f32 v110, v110, v110
    v_cvt_pk_bf16_f32 v67, v109, v110
    buffer_store_dwordx4 v[64:67], v4, s[4:7], s52 offen offset:1024 sc1
    v_cvt_pk_bf16_f32 v108, v44, v45
    v_lshlrev_b32 v109, 16, v108
    v_and_b32 v110, 0xffff0000, v108
    v_add_f32 v109, v109, v96
    v_add_f32 v110, v110, v97
    v_cvt_pk_bf16_f32 v108, v109, v110
    v_lshlrev_b32 v109, 16, v108
    v_and_b32 v110, 0xffff0000, v108
    v_max_f32 v109, 0, v109
    v_max_f32 v110, 0, v110
    v_mul_f32 v109, v109, v109
    v_mul_f32 v110, v110, v110
    v_cvt_pk_bf16_f32 v68, v109, v110
    v_cvt_pk_bf16_f32 v108, v52, v53
    v_lshlrev_b32 v109, 16, v108
    v_and_b32 v110, 0xffff0000, v108
    v_add_f32 v109, v109, v100
    v_add_f32 v110, v110, v101
    v_cvt_pk_bf16_f32 v108, v109, v110
    v_lshlrev_b32 v109, 16, v108
    v_and_b32 v110, 0xffff0000, v108
    v_max_f32 v109, 0, v109
    v_max_f32 v110, 0, v110
    v_mul_f32 v109, v109, v109
    v_mul_f32 v110, v110, v110
    v_cvt_pk_bf16_f32 v69, v109, v110
    v_cvt_pk_bf16_f32 v108, v46, v47
    v_lshlrev_b32 v109, 16, v108
    v_and_b32 v110, 0xffff0000, v108
    v_add_f32 v109, v109, v98
    v_add_f32 v110, v110, v99
    v_cvt_pk_bf16_f32 v108, v109, v110
    v_lshlrev_b32 v109, 16, v108
    v_and_b32 v110, 0xffff0000, v108
    v_max_f32 v109, 0, v109
    v_max_f32 v110, 0, v110
    v_mul_f32 v109, v109, v109
    v_mul_f32 v110, v110, v110
    v_cvt_pk_bf16_f32 v70, v109, v110
    v_cvt_pk_bf16_f32 v108, v54, v55
    v_lshlrev_b32 v109, 16, v108
    v_and_b32 v110, 0xffff0000, v108
    v_add_f32 v109, v109, v102
    v_add_f32 v110, v110, v103
    v_cvt_pk_bf16_f32 v108, v109, v110
    v_lshlrev_b32 v109, 16, v108
    v_and_b32 v110, 0xffff0000, v108
    v_max_f32 v109, 0, v109
    v_max_f32 v110, 0, v110
    v_mul_f32 v109, v109, v109
    v_mul_f32 v110, v110, v110
    v_cvt_pk_bf16_f32 v71, v109, v110
    buffer_store_dwordx4 v[68:71], v4, s[4:7], s52 offen offset:2048 sc1
    v_cvt_pk_bf16_f32 v108, v60, v61
    v_lshlrev_b32 v109, 16, v108
    v_and_b32 v110, 0xffff0000, v108
    v_add_f32 v109, v109, v104
    v_add_f32 v110, v110, v105
    v_cvt_pk_bf16_f32 v108, v109, v110
    v_lshlrev_b32 v109, 16, v108
    v_and_b32 v110, 0xffff0000, v108
    v_max_f32 v109, 0, v109
    v_max_f32 v110, 0, v110
    v_mul_f32 v109, v109, v109
    v_mul_f32 v110, v110, v110
    v_cvt_pk_bf16_f32 v114, v109, v110
    v_cvt_pk_bf16_f32 v108, v62, v63
    v_lshlrev_b32 v109, 16, v108
    v_and_b32 v110, 0xffff0000, v108
    v_add_f32 v109, v109, v106
    v_add_f32 v110, v110, v107
    v_cvt_pk_bf16_f32 v108, v109, v110
    v_lshlrev_b32 v109, 16, v108
    v_and_b32 v110, 0xffff0000, v108
    v_max_f32 v109, 0, v109
    v_max_f32 v110, 0, v110
    v_mul_f32 v109, v109, v109
    v_mul_f32 v110, v110, v110
    v_cvt_pk_bf16_f32 v115, v109, v110
    buffer_store_dword v114, v118, s[4:7], s53 offen sc1
    buffer_store_dword v115, v118, s[4:7], s53 offen offset:8 sc1
    s_add_u32 s52, s52, 57344
    s_add_u32 s53, s53, 57344
    s_lshl_b32 s39, s26, 13
    s_lshl_b32 s28, s30, 7
    s_add_u32 s39, s39, s28
    s_lshl_b32 s28, s24, 2
    s_add_u32 s39, s39, s28
    s_add_u32 s39, s39, 72357888
    s_add_u32 s26, s26, 6
    s_cmp_lt_u32 s26, 64
    s_cbranch_scc1 K2_W1_loop
    s_waitcnt vmcnt(0)
    s_mov_b64 exec, 1
    buffer_store_dword v117, v116, s[4:7], s39 offen sc1
    s_mov_b64 exec, -1
    s_branch K2_end
K2_W2:
    v_lshlrev_b32 v12, 7, v1
    v_and_b32 v12, 3, v1
    v_lshlrev_b32 v12, 2, v12
    s_and_b32 s28, s25, 15
    s_lshl_b32 s28, s28, 7
    s_add_u32 s28, s28, 72425472
Lwf_107:
    buffer_load_dword v13, v12, s[4:7], s28 offen sc1
    s_waitcnt vmcnt(0)
    v_cmp_ne_u32 vcc, s48, v13
    s_cbranch_vccz Lwd_108
    s_sleep 16
    s_sub_u32 s27, s27, 1
    s_cbranch_scc1 K2_end
    s_branch Lwf_107
Lwd_108:
    s_sub_u32 s25, s25, 168
    s_mul_hi_u32 s30, s25, 0x2aaaaaab
    s_mul_i32 s31, s30, 6
    s_sub_u32 s26, s25, s31
    s_mov_b32 s28, 0x12492493
    v_add_u32 v8, 0, v1
    v_mul_hi_u32 v9, s28, v8
    v_mul_u32_u24 v10, 14, v9
    v_sub_u32 v10, v8, v10
    v_mul_u32_u24 v9, 896, v9
    v_lshl_add_u32 v16, v10, 4, v9
    v_add_u32 v8, 64, v1
    v_mul_hi_u32 v9, s28, v8
    v_mul_u32_u24 v10, 14, v9
    v_sub_u32 v10, v8, v10
    v_mul_u32_u24 v9, 896, v9
    v_lshl_add_u32 v17, v10, 4, v9
    v_add_u32 v8, 128, v1
    v_mul_hi_u32 v9, s28, v8
    v_mul_u32_u24 v10, 14, v9
    v_sub_u32 v10, v8, v10
    v_mul_u32_u24 v9, 896, v9
    v_lshl_add_u32 v18, v10, 4, v9
    v_add_u32 v8, 192, v1
    v_mul_hi_u32 v9, s28, v8
    v_mul_u32_u24 v10, 14, v9
    v_sub_u32 v10, v8, v10
    v_mul_u32_u24 v9, 896, v9
    v_lshl_add_u32 v19, v10, 4, v9
    v_add_u32 v8, 256, v1
    v_mul_hi_u32 v9, s28, v8
    v_mul_u32_u24 v10, 14, v9
    v_sub_u32 v10, v8, v10
    v_mul_u32_u24 v9, 896, v9
    v_lshl_add_u32 v20, v10, 4, v9
    v_add_u32 v8, 320, v1
    v_mul_hi_u32 v9, s28, v8
    v_mul_u32_u24 v10, 14, v9
    v_sub_u32 v10, v8, v10
    v_mul_u32_u24 v9, 896, v9
    v_lshl_add_u32 v21, v10, 4, v9
    v_add_u32 v8, 384, v1
    v_mul_hi_u32 v9, s28, v8
    v_mul_u32_u24 v10, 14, v9
    v_sub_u32 v10, v8, v10
    v_mul_u32_u24 v9, 896, v9
    v_lshl_add_u32 v22, v10, 4, v9
    v_lshrrev_b32 v9, 1, v3
    v_lshlrev_b32 v9, 4, v9
    v_and_b32 v10, 1, v3
    v_lshl_add_u32 v9, v10, 2, v9
    v_bfe_u32 v10, v2, 2, 1
    v_add_u32 v9, v9, v10
    v_lshrrev_b32 v10, 3, v2
    v_lshl_add_u32 v9, v10, 3, v9
    v_mul_u32_u24 v9, 224, v9
    v_and_b32 v10, 3, v2
    v_lshl_add_u32 v9, v10, 3, v9
    s_mul_i32 s51, s24, 28672
    v_add_u32 v9, s51, v9
    s_mul_i32 s50, s24, 401408
    s_mul_i32 s28, s30, 224
    s_add_u32 s50, s50, s28
    s_add_u32 s52, s50, 0
    s_add_u32 m0, s51, 0
    s_nop 0
    buffer_load_dwordx4 v16, s[44:47], s52 offen lds
    s_add_u32 m0, s51, 1024
    s_nop 0
    buffer_load_dwordx4 v17, s[44:47], s52 offen lds
    s_add_u32 m0, s51, 2048
    s_nop 0
    buffer_load_dwordx4 v18, s[44:47], s52 offen lds
    s_add_u32 m0, s51, 3072
    s_nop 0
    buffer_load_dwordx4 v19, s[44:47], s52 offen lds
    s_add_u32 m0, s51, 4096
    s_nop 0
    buffer_load_dwordx4 v20, s[44:47], s52 offen lds
    s_add_u32 m0, s51, 5120
    s_nop 0
    buffer_load_dwordx4 v21, s[44:47], s52 offen lds
    s_add_u32 m0, s51, 6144
    s_nop 0
    buffer_load_dwordx4 v22, s[44:47], s52 offen lds
    s_add_u32 s52, s50, 28672
    s_add_u32 m0, s51, 7168
    s_nop 0
    buffer_load_dwordx4 v16, s[44:47], s52 offen lds
    s_add_u32 m0, s51, 8192
    s_nop 0
    buffer_load_dwordx4 v17, s[44:47], s52 offen lds
    s_add_u32 m0, s51, 9216
    s_nop 0
    buffer_load_dwordx4 v18, s[44:47], s52 offen lds
    s_add_u32 m0, s51, 10240
    s_nop 0
    buffer_load_dwordx4 v19, s[44:47], s52 offen lds
    s_add_u32 m0, s51, 11264
    s_nop 0
    buffer_load_dwordx4 v20, s[44:47], s52 offen lds
    s_add_u32 m0, s51, 12288
    s_nop 0
    buffer_load_dwordx4 v21, s[44:47], s52 offen lds
    s_add_u32 m0, s51, 13312
    s_nop 0
    buffer_load_dwordx4 v22, s[44:47], s52 offen lds
    s_add_u32 s52, s50, 57344
    s_add_u32 m0, s51, 14336
    s_nop 0
    buffer_load_dwordx4 v16, s[44:47], s52 offen lds
    s_add_u32 m0, s51, 15360
    s_nop 0
    buffer_load_dwordx4 v17, s[44:47], s52 offen lds
    s_add_u32 m0, s51, 16384
    s_nop 0
    buffer_load_dwordx4 v18, s[44:47], s52 offen lds
    s_add_u32 m0, s51, 17408
    s_nop 0
    buffer_load_dwordx4 v19, s[44:47], s52 offen lds
    s_add_u32 m0, s51, 18432
    s_nop 0
    buffer_load_dwordx4 v20, s[44:47], s52 offen lds
    s_add_u32 m0, s51, 19456
    s_nop 0
    buffer_load_dwordx4 v21, s[44:47], s52 offen lds
    s_add_u32 m0, s51, 20480
    s_nop 0
    buffer_load_dwordx4 v22, s[44:47], s52 offen lds
    s_add_u32 s52, s50, 86016
    s_add_u32 m0, s51, 21504
    s_nop 0
    buffer_load_dwordx4 v16, s[44:47], s52 offen lds
    s_add_u32 m0, s51, 22528
    s_nop 0
    buffer_load_dwordx4 v17, s[44:47], s52 offen lds
    s_add_u32 m0, s51, 23552
    s_nop 0
    buffer_load_dwordx4 v18, s[44:47], s52 offen lds
    s_add_u32 m0, s51, 24576
    s_nop 0
    buffer_load_dwordx4 v19, s[44:47], s52 offen lds
    s_add_u32 m0, s51, 25600
    s_nop 0
    buffer_load_dwordx4 v20, s[44:47], s52 offen lds
    s_add_u32 m0, s51, 26624
    s_nop 0
    buffer_load_dwordx4 v21, s[44:47], s52 offen lds
    s_add_u32 m0, s51, 27648
    s_nop 0
    buffer_load_dwordx4 v22, s[44:47], s52 offen lds
    s_waitcnt vmcnt(21)
    ds_read_b64_tr_b16 a[0:1], v9 offset:0
    ds_read_b64_tr_b16 a[2:3], v9 offset:448
    ds_read_b64_tr_b16 a[56:57], v9 offset:32
    ds_read_b64_tr_b16 a[58:59], v9 offset:480
    ds_read_b64_tr_b16 a[112:113], v9 offset:64
    ds_read_b64_tr_b16 a[114:115], v9 offset:512
    ds_read_b64_tr_b16 a[168:169], v9 offset:96
    ds_read_b64_tr_b16 a[170:171], v9 offset:544
    ds_read_b64_tr_b16 a[224:225], v9 offset:128
    ds_read_b64_tr_b16 a[226:227], v9 offset:576
    ds_read_b64_tr_b16 v[144:145], v9 offset:160
    ds_read_b64_tr_b16 v[146:147], v9 offset:608
    ds_read_b64_tr_b16 v[200:201], v9 offset:192
    ds_read_b64_tr_b16 v[202:203], v9 offset:640
    s_waitcnt lgkmcnt(0)
    s_add_u32 s52, s50, 114688
    s_add_u32 m0, s51, 0
    s_nop 0
    buffer_load_dwordx4 v16, s[44:47], s52 offen lds
    s_add_u32 m0, s51, 1024
    s_nop 0
    buffer_load_dwordx4 v17, s[44:47], s52 offen lds
    s_add_u32 m0, s51, 2048
    s_nop 0
    buffer_load_dwordx4 v18, s[44:47], s52 offen lds
    s_add_u32 m0, s51, 3072
    s_nop 0
    buffer_load_dwordx4 v19, s[44:47], s52 offen lds
    s_add_u32 m0, s51, 4096
    s_nop 0
    buffer_load_dwordx4 v20, s[44:47], s52 offen lds
    s_add_u32 m0, s51, 5120
    s_nop 0
    buffer_load_dwordx4 v21, s[44:47], s52 offen lds
    s_add_u32 m0, s51, 6144
    s_nop 0
    buffer_load_dwordx4 v22, s[44:47], s52 offen lds
    s_waitcnt vmcnt(21)
    ds_read_b64_tr_b16 a[4:5], v9 offset:7168
    ds_read_b64_tr_b16 a[6:7], v9 offset:7616
    ds_read_b64_tr_b16 a[60:61], v9 offset:7200
    ds_read_b64_tr_b16 a[62:63], v9 offset:7648
    ds_read_b64_tr_b16 a[116:117], v9 offset:7232
    ds_read_b64_tr_b16 a[118:119], v9 offset:7680
    ds_read_b64_tr_b16 a[172:173], v9 offset:7264
    ds_read_b64_tr_b16 a[174:175], v9 offset:7712
    ds_read_b64_tr_b16 a[228:229], v9 offset:7296
    ds_read_b64_tr_b16 a[230:231], v9 offset:7744
    ds_read_b64_tr_b16 v[148:149], v9 offset:7328
    ds_read_b64_tr_b16 v[150:151], v9 offset:7776
    ds_read_b64_tr_b16 v[204:205], v9 offset:7360
    ds_read_b64_tr_b16 v[206:207], v9 offset:7808
    s_waitcnt lgkmcnt(0)
    s_add_u32 s52, s50, 143360
    s_add_u32 m0, s51, 7168
    s_nop 0
    buffer_load_dwordx4 v16, s[44:47], s52 offen lds
    s_add_u32 m0, s51, 8192
    s_nop 0
    buffer_load_dwordx4 v17, s[44:47], s52 offen lds
    s_add_u32 m0, s51, 9216
    s_nop 0
    buffer_load_dwordx4 v18, s[44:47], s52 offen lds
    s_add_u32 m0, s51, 10240
    s_nop 0
    buffer_load_dwordx4 v19, s[44:47], s52 offen lds
    s_add_u32 m0, s51, 11264
    s_nop 0
    buffer_load_dwordx4 v20, s[44:47], s52 offen lds
    s_add_u32 m0, s51, 12288
    s_nop 0
    buffer_load_dwordx4 v21, s[44:47], s52 offen lds
    s_add_u32 m0, s51, 13312
    s_nop 0
    buffer_load_dwordx4 v22, s[44:47], s52 offen lds
    s_waitcnt vmcnt(21)
    ds_read_b64_tr_b16 a[8:9], v9 offset:14336
    ds_read_b64_tr_b16 a[10:11], v9 offset:14784
    ds_read_b64_tr_b16 a[64:65], v9 offset:14368
    ds_read_b64_tr_b16 a[66:67], v9 offset:14816
    ds_read_b64_tr_b16 a[120:121], v9 offset:14400
    ds_read_b64_tr_b16 a[122:123], v9 offset:14848
    ds_read_b64_tr_b16 a[176:177], v9 offset:14432
    ds_read_b64_tr_b16 a[178:179], v9 offset:14880
    ds_read_b64_tr_b16 a[232:233], v9 offset:14464
    ds_read_b64_tr_b16 a[234:235], v9 offset:14912
    ds_read_b64_tr_b16 v[152:153], v9 offset:14496
    ds_read_b64_tr_b16 v[154:155], v9 offset:14944
    ds_read_b64_tr_b16 v[208:209], v9 offset:14528
    ds_read_b64_tr_b16 v[210:211], v9 offset:14976
    s_waitcnt lgkmcnt(0)
    s_add_u32 s52, s50, 172032
    s_add_u32 m0, s51, 14336
    s_nop 0
    buffer_load_dwordx4 v16, s[44:47], s52 offen lds
    s_add_u32 m0, s51, 15360
    s_nop 0
    buffer_load_dwordx4 v17, s[44:47], s52 offen lds
    s_add_u32 m0, s51, 16384
    s_nop 0
    buffer_load_dwordx4 v18, s[44:47], s52 offen lds
    s_add_u32 m0, s51, 17408
    s_nop 0
    buffer_load_dwordx4 v19, s[44:47], s52 offen lds
    s_add_u32 m0, s51, 18432
    s_nop 0
    buffer_load_dwordx4 v20, s[44:47], s52 offen lds
    s_add_u32 m0, s51, 19456
    s_nop 0
    buffer_load_dwordx4 v21, s[44:47], s52 offen lds
    s_add_u32 m0, s51, 20480
    s_nop 0
    buffer_load_dwordx4 v22, s[44:47], s52 offen lds
    s_waitcnt vmcnt(21)
    ds_read_b64_tr_b16 a[12:13], v9 offset:21504
    ds_read_b64_tr_b16 a[14:15], v9 offset:21952
    ds_read_b64_tr_b16 a[68:69], v9 offset:21536
    ds_read_b64_tr_b16 a[70:71], v9 offset:21984
    ds_read_b64_tr_b16 a[124:125], v9 offset:21568
    ds_read_b64_tr_b16 a[126:127], v9 offset:22016
    ds_read_b64_tr_b16 a[180:181], v9 offset:21600
    ds_read_b64_tr_b16 a[182:183], v9 offset:22048
    ds_read_b64_tr_b16 a[236:237], v9 offset:21632
    ds_read_b64_tr_b16 a[238:239], v9 offset:22080
    ds_read_b64_tr_b16 v[156:157], v9 offset:21664
    ds_read_b64_tr_b16 v[158:159], v9 offset:22112
    ds_read_b64_tr_b16 v[212:213], v9 offset:21696
    ds_read_b64_tr_b16 v[214:215], v9 offset:22144
    s_waitcnt lgkmcnt(0)
    s_add_u32 s52, s50, 200704
    s_add_u32 m0, s51, 21504
    s_nop 0
    buffer_load_dwordx4 v16, s[44:47], s52 offen lds
    s_add_u32 m0, s51, 22528
    s_nop 0
    buffer_load_dwordx4 v17, s[44:47], s52 offen lds
    s_add_u32 m0, s51, 23552
    s_nop 0
    buffer_load_dwordx4 v18, s[44:47], s52 offen lds
    s_add_u32 m0, s51, 24576
    s_nop 0
    buffer_load_dwordx4 v19, s[44:47], s52 offen lds
    s_add_u32 m0, s51, 25600
    s_nop 0
    buffer_load_dwordx4 v20, s[44:47], s52 offen lds
    s_add_u32 m0, s51, 26624
    s_nop 0
    buffer_load_dwordx4 v21, s[44:47], s52 offen lds
    s_add_u32 m0, s51, 27648
    s_nop 0
    buffer_load_dwordx4 v22, s[44:47], s52 offen lds
    s_waitcnt vmcnt(21)
    ds_read_b64_tr_b16 a[16:17], v9 offset:0
    ds_read_b64_tr_b16 a[18:19], v9 offset:448
    ds_read_b64_tr_b16 a[72:73], v9 offset:32
    ds_read_b64_tr_b16 a[74:75], v9 offset:480
    ds_read_b64_tr_b16 a[128:129], v9 offset:64
    ds_read_b64_tr_b16 a[130:131], v9 offset:512
    ds_read_b64_tr_b16 a[184:185], v9 offset:96
    ds_read_b64_tr_b16 a[186:187], v9 offset:544
    ds_read_b64_tr_b16 a[240:241], v9 offset:128
    ds_read_b64_tr_b16 a[242:243], v9 offset:576
    ds_read_b64_tr_b16 v[160:161], v9 offset:160
    ds_read_b64_tr_b16 v[162:163], v9 offset:608
    ds_read_b64_tr_b16 v[216:217], v9 offset:192
    ds_read_b64_tr_b16 v[218:219], v9 offset:640
    s_waitcnt lgkmcnt(0)
    s_add_u32 s52, s50, 229376
    s_add_u32 m0, s51, 0
    s_nop 0
    buffer_load_dwordx4 v16, s[44:47], s52 offen lds
    s_add_u32 m0, s51, 1024
    s_nop 0
    buffer_load_dwordx4 v17, s[44:47], s52 offen lds
    s_add_u32 m0, s51, 2048
    s_nop 0
    buffer_load_dwordx4 v18, s[44:47], s52 offen lds
    s_add_u32 m0, s51, 3072
    s_nop 0
    buffer_load_dwordx4 v19, s[44:47], s52 offen lds
    s_add_u32 m0, s51, 4096
    s_nop 0
    buffer_load_dwordx4 v20, s[44:47], s52 offen lds
    s_add_u32 m0, s51, 5120
    s_nop 0
    buffer_load_dwordx4 v21, s[44:47], s52 offen lds
    s_add_u32 m0, s51, 6144
    s_nop 0
    buffer_load_dwordx4 v22, s[44:47], s52 offen lds
    s_waitcnt vmcnt(21)
    ds_read_b64_tr_b16 a[20:21], v9 offset:7168
    ds_read_b64_tr_b16 a[22:23], v9 offset:7616
    ds_read_b64_tr_b16 a[76:77], v9 offset:7200
    ds_read_b64_tr_b16 a[78:79], v9 offset:7648
    ds_read_b64_tr_b16 a[132:133], v9 offset:7232
    ds_read_b64_tr_b16 a[134:135], v9 offset:7680
    ds_read_b64_tr_b16 a[188:189], v9 offset:7264
    ds_read_b64_tr_b16 a[190:191], v9 offset:7712
    ds_read_b64_tr_b16 a[244:245], v9 offset:7296
    ds_read_b64_tr_b16 a[246:247], v9 offset:7744
    ds_read_b64_tr_b16 v[164:165], v9 offset:7328
    ds_read_b64_tr_b16 v[166:167], v9 offset:7776
    ds_read_b64_tr_b16 v[220:221], v9 offset:7360
    ds_read_b64_tr_b16 v[222:223], v9 offset:7808
    s_waitcnt lgkmcnt(0)
    s_add_u32 s52, s50, 258048
    s_add_u32 m0, s51, 7168
    s_nop 0
    buffer_load_dwordx4 v16, s[44:47], s52 offen lds
    s_add_u32 m0, s51, 8192
    s_nop 0
    buffer_load_dwordx4 v17, s[44:47], s52 offen lds
    s_add_u32 m0, s51, 9216
    s_nop 0
    buffer_load_dwordx4 v18, s[44:47], s52 offen lds
    s_add_u32 m0, s51, 10240
    s_nop 0
    buffer_load_dwordx4 v19, s[44:47], s52 offen lds
    s_add_u32 m0, s51, 11264
    s_nop 0
    buffer_load_dwordx4 v20, s[44:47], s52 offen lds
    s_add_u32 m0, s51, 12288
    s_nop 0
    buffer_load_dwordx4 v21, s[44:47], s52 offen lds
    s_add_u32 m0, s51, 13312
    s_nop 0
    buffer_load_dwordx4 v22, s[44:47], s52 offen lds
    s_waitcnt vmcnt(21)
    ds_read_b64_tr_b16 a[24:25], v9 offset:14336
    ds_read_b64_tr_b16 a[26:27], v9 offset:14784
    ds_read_b64_tr_b16 a[80:81], v9 offset:14368
    ds_read_b64_tr_b16 a[82:83], v9 offset:14816
    ds_read_b64_tr_b16 a[136:137], v9 offset:14400
    ds_read_b64_tr_b16 a[138:139], v9 offset:14848
    ds_read_b64_tr_b16 a[192:193], v9 offset:14432
    ds_read_b64_tr_b16 a[194:195], v9 offset:14880
    ds_read_b64_tr_b16 a[248:249], v9 offset:14464
    ds_read_b64_tr_b16 a[250:251], v9 offset:14912
    ds_read_b64_tr_b16 v[168:169], v9 offset:14496
    ds_read_b64_tr_b16 v[170:171], v9 offset:14944
    ds_read_b64_tr_b16 v[224:225], v9 offset:14528
    ds_read_b64_tr_b16 v[226:227], v9 offset:14976
    s_waitcnt lgkmcnt(0)
    s_add_u32 s52, s50, 286720
    s_add_u32 m0, s51, 14336
    s_nop 0
    buffer_load_dwordx4 v16, s[44:47], s52 offen lds
    s_add_u32 m0, s51, 15360
    s_nop 0
    buffer_load_dwordx4 v17, s[44:47], s52 offen lds
    s_add_u32 m0, s51, 16384
    s_nop 0
    buffer_load_dwordx4 v18, s[44:47], s52 offen lds
    s_add_u32 m0, s51, 17408
    s_nop 0
    buffer_load_dwordx4 v19, s[44:47], s52 offen lds
    s_add_u32 m0, s51, 18432
    s_nop 0
    buffer_load_dwordx4 v20, s[44:47], s52 offen lds
    s_add_u32 m0, s51, 19456
    s_nop 0
    buffer_load_dwordx4 v21, s[44:47], s52 offen lds
    s_add_u32 m0, s51, 20480
    s_nop 0
    buffer_load_dwordx4 v22, s[44:47], s52 offen lds
    s_waitcnt vmcnt(21)
    ds_read_b64_tr_b16 a[28:29], v9 offset:21504
    ds_read_b64_tr_b16 a[30:31], v9 offset:21952
    ds_read_b64_tr_b16 a[84:85], v9 offset:21536
    ds_read_b64_tr_b16 a[86:87], v9 offset:21984
    ds_read_b64_tr_b16 a[140:141], v9 offset:21568
    ds_read_b64_tr_b16 a[142:143], v9 offset:22016
    ds_read_b64_tr_b16 a[196:197], v9 offset:21600
    ds_read_b64_tr_b16 a[198:199], v9 offset:22048
    ds_read_b64_tr_b16 a[252:253], v9 offset:21632
    ds_read_b64_tr_b16 a[254:255], v9 offset:22080
    ds_read_b64_tr_b16 v[172:173], v9 offset:21664
    ds_read_b64_tr_b16 v[174:175], v9 offset:22112
    ds_read_b64_tr_b16 v[228:229], v9 offset:21696
    ds_read_b64_tr_b16 v[230:231], v9 offset:22144
    s_waitcnt lgkmcnt(0)
    s_add_u32 s52, s50, 315392
    s_add_u32 m0, s51, 21504
    s_nop 0
    buffer_load_dwordx4 v16, s[44:47], s52 offen lds
    s_add_u32 m0, s51, 22528
    s_nop 0
    buffer_load_dwordx4 v17, s[44:47], s52 offen lds
    s_add_u32 m0, s51, 23552
    s_nop 0
    buffer_load_dwordx4 v18, s[44:47], s52 offen lds
    s_add_u32 m0, s51, 24576
    s_nop 0
    buffer_load_dwordx4 v19, s[44:47], s52 offen lds
    s_add_u32 m0, s51, 25600
    s_nop 0
    buffer_load_dwordx4 v20, s[44:47], s52 offen lds
    s_add_u32 m0, s51, 26624
    s_nop 0
    buffer_load_dwordx4 v21, s[44:47], s52 offen lds
    s_add_u32 m0, s51, 27648
    s_nop 0
    buffer_load_dwordx4 v22, s[44:47], s52 offen lds
    s_waitcnt vmcnt(21)
    ds_read_b64_tr_b16 a[32:33], v9 offset:0
    ds_read_b64_tr_b16 a[34:35], v9 offset:448
    ds_read_b64_tr_b16 a[88:89], v9 offset:32
    ds_read_b64_tr_b16 a[90:91], v9 offset:480
    ds_read_b64_tr_b16 a[144:145], v9 offset:64
    ds_read_b64_tr_b16 a[146:147], v9 offset:512
    ds_read_b64_tr_b16 a[200:201], v9 offset:96
    ds_read_b64_tr_b16 a[202:203], v9 offset:544
    ds_read_b64_tr_b16 v[120:121], v9 offset:128
    ds_read_b64_tr_b16 v[122:123], v9 offset:576
    ds_read_b64_tr_b16 v[176:177], v9 offset:160
    ds_read_b64_tr_b16 v[178:179], v9 offset:608
    ds_read_b64_tr_b16 v[232:233], v9 offset:192
    ds_read_b64_tr_b16 v[234:235], v9 offset:640
    s_waitcnt lgkmcnt(0)
    s_add_u32 s52, s50, 344064
    s_add_u32 m0, s51, 0
    s_nop 0
    buffer_load_dwordx4 v16, s[44:47], s52 offen lds
    s_add_u32 m0, s51, 1024
    s_nop 0
    buffer_load_dwordx4 v17, s[44:47], s52 offen lds
    s_add_u32 m0, s51, 2048
    s_nop 0
    buffer_load_dwordx4 v18, s[44:47], s52 offen lds
    s_add_u32 m0, s51, 3072
    s_nop 0
    buffer_load_dwordx4 v19, s[44:47], s52 offen lds
    s_add_u32 m0, s51, 4096
    s_nop 0
    buffer_load_dwordx4 v20, s[44:47], s52 offen lds
    s_add_u32 m0, s51, 5120
    s_nop 0
    buffer_load_dwordx4 v21, s[44:47], s52 offen lds
    s_add_u32 m0, s51, 6144
    s_nop 0
    buffer_load_dwordx4 v22, s[44:47], s52 offen lds
    s_waitcnt vmcnt(21)
    ds_read_b64_tr_b16 a[36:37], v9 offset:7168
    ds_read_b64_tr_b16 a[38:39], v9 offset:7616
    ds_read_b64_tr_b16 a[92:93], v9 offset:7200
    ds_read_b64_tr_b16 a[94:95], v9 offset:7648
    ds_read_b64_tr_b16 a[148:149], v9 offset:7232
    ds_read_b64_tr_b16 a[150:151], v9 offset:7680
    ds_read_b64_tr_b16 a[204:205], v9 offset:7264
    ds_read_b64_tr_b16 a[206:207], v9 offset:7712
    ds_read_b64_tr_b16 v[124:125], v9 offset:7296
    ds_read_b64_tr_b16 v[126:127], v9 offset:7744
    ds_read_b64_tr_b16 v[180:181], v9 offset:7328
    ds_read_b64_tr_b16 v[182:183], v9 offset:7776
    ds_read_b64_tr_b16 v[236:237], v9 offset:7360
    ds_read_b64_tr_b16 v[238:239], v9 offset:7808
    s_waitcnt lgkmcnt(0)
    s_add_u32 s52, s50, 372736
    s_add_u32 m0, s51, 7168
    s_nop 0
    buffer_load_dwordx4 v16, s[44:47], s52 offen lds
    s_add_u32 m0, s51, 8192
    s_nop 0
    buffer_load_dwordx4 v17, s[44:47], s52 offen lds
    s_add_u32 m0, s51, 9216
    s_nop 0
    buffer_load_dwordx4 v18, s[44:47], s52 offen lds
    s_add_u32 m0, s51, 10240
    s_nop 0
    buffer_load_dwordx4 v19, s[44:47], s52 offen lds
    s_add_u32 m0, s51, 11264
    s_nop 0
    buffer_load_dwordx4 v20, s[44:47], s52 offen lds
    s_add_u32 m0, s51, 12288
    s_nop 0
    buffer_load_dwordx4 v21, s[44:47], s52 offen lds
    s_add_u32 m0, s51, 13312
    s_nop 0
    buffer_load_dwordx4 v22, s[44:47], s52 offen lds
    s_waitcnt vmcnt(21)
    ds_read_b64_tr_b16 a[40:41], v9 offset:14336
    ds_read_b64_tr_b16 a[42:43], v9 offset:14784
    ds_read_b64_tr_b16 a[96:97], v9 offset:14368
    ds_read_b64_tr_b16 a[98:99], v9 offset:14816
    ds_read_b64_tr_b16 a[152:153], v9 offset:14400
    ds_read_b64_tr_b16 a[154:155], v9 offset:14848
    ds_read_b64_tr_b16 a[208:209], v9 offset:14432
    ds_read_b64_tr_b16 a[210:211], v9 offset:14880
    ds_read_b64_tr_b16 v[128:129], v9 offset:14464
    ds_read_b64_tr_b16 v[130:131], v9 offset:14912
    ds_read_b64_tr_b16 v[184:185], v9 offset:14496
    ds_read_b64_tr_b16 v[186:187], v9 offset:14944
    ds_read_b64_tr_b16 v[240:241], v9 offset:14528
    ds_read_b64_tr_b16 v[242:243], v9 offset:14976
    s_waitcnt lgkmcnt(0)
    s_waitcnt vmcnt(14)
    ds_read_b64_tr_b16 a[44:45], v9 offset:21504
    ds_read_b64_tr_b16 a[46:47], v9 offset:21952
    ds_read_b64_tr_b16 a[100:101], v9 offset:21536
    ds_read_b64_tr_b16 a[102:103], v9 offset:21984
    ds_read_b64_tr_b16 a[156:157], v9 offset:21568
    ds_read_b64_tr_b16 a[158:159], v9 offset:22016
    ds_read_b64_tr_b16 a[212:213], v9 offset:21600
    ds_read_b64_tr_b16 a[214:215], v9 offset:22048
    ds_read_b64_tr_b16 v[132:133], v9 offset:21632
    ds_read_b64_tr_b16 v[134:135], v9 offset:22080
    ds_read_b64_tr_b16 v[188:189], v9 offset:21664
    ds_read_b64_tr_b16 v[190:191], v9 offset:22112
    ds_read_b64_tr_b16 v[244:245], v9 offset:21696
    ds_read_b64_tr_b16 v[246:247], v9 offset:22144
    s_waitcnt lgkmcnt(0)
    s_waitcnt vmcnt(7)
    ds_read_b64_tr_b16 a[48:49], v9 offset:0
    ds_read_b64_tr_b16 a[50:51], v9 offset:448
    ds_read_b64_tr_b16 a[104:105], v9 offset:32
    ds_read_b64_tr_b16 a[106:107], v9 offset:480
    ds_read_b64_tr_b16 a[160:161], v9 offset:64
    ds_read_b64_tr_b16 a[162:163], v9 offset:512
    ds_read_b64_tr_b16 a[216:217], v9 offset:96
    ds_read_b64_tr_b16 a[218:219], v9 offset:544
    ds_read_b64_tr_b16 v[136:137], v9 offset:128
    ds_read_b64_tr_b16 v[138:139], v9 offset:576
    ds_read_b64_tr_b16 v[192:193], v9 offset:160
    ds_read_b64_tr_b16 v[194:195], v9 offset:608
    ds_read_b64_tr_b16 v[248:249], v9 offset:192
    ds_read_b64_tr_b16 v[250:251], v9 offset:640
    s_waitcnt lgkmcnt(0)
    s_waitcnt vmcnt(0)
    ds_read_b64_tr_b16 a[52:53], v9 offset:7168
    ds_read_b64_tr_b16 a[54:55], v9 offset:7616
    ds_read_b64_tr_b16 a[108:109], v9 offset:7200
    ds_read_b64_tr_b16 a[110:111], v9 offset:7648
    ds_read_b64_tr_b16 a[164:165], v9 offset:7232
    ds_read_b64_tr_b16 a[166:167], v9 offset:7680
    ds_read_b64_tr_b16 a[220:221], v9 offset:7264
    ds_read_b64_tr_b16 a[222:223], v9 offset:7712
    ds_read_b64_tr_b16 v[140:141], v9 offset:7296
    ds_read_b64_tr_b16 v[142:143], v9 offset:7744
    ds_read_b64_tr_b16 v[196:197], v9 offset:7328
    ds_read_b64_tr_b16 v[198:199], v9 offset:7776
    ds_read_b64_tr_b16 v[252:253], v9 offset:7360
    ds_read_b64_tr_b16 v[254:255], v9 offset:7808
    s_waitcnt lgkmcnt(0)
    v_and_b32 v104, 3, v1
    v_lshlrev_b32 v104, 2, v104
    v_mul_u32_u24 v105, 464, v2
    v_lshl_add_u32 v105, v3, 4, v105
    s_mul_i32 s28, s24, 14848
    v_add_u32 v105, s28, v105
    s_mov_b32 s28, 0x12492493
    v_mul_hi_u32 v7, s28, v0
    v_mul_u32_u24 v6, 14, v7
    v_sub_u32 v6, v0, v6
    v_mul_u32_u24 v106, 464, v7
    v_lshl_add_u32 v106, v6, 5, v106
    v_mul_u32_u24 v107, 896, v7
    v_lshl_add_u32 v107, v6, 4, v107
    v_lshlrev_b32 v6, 4, v6
    s_mul_i32 s28, s30, 224
    buffer_load_dwordx4 v[108:111], v6, s[20:23], s28 offen
    s_movk_i32 s28, 224
    v_cmp_gt_u32 s[62:63], s28, v0
    v_mov_b32 v116, 0
    v_mov_b32 v117, s48
K2_W2_loop:
    s_lshl_b32 s32, s26, 13
    s_add_u32 s32, s32, 72351744
    s_lshl_b32 s28, s24, 7
    s_add_u32 s33, s32, s28
    s_add_u32 s33, s33, 6144
Lwf_109:
    buffer_load_dword v7, v104, s[4:7], s33 offen sc1
    s_waitcnt vmcnt(0)
    v_cmp_ne_u32 vcc, s48, v7
    s_cbranch_vccz Lwd_110
    s_sleep 8
    s_sub_u32 s27, s27, 1
    s_cbranch_scc1 K2_end
    s_branch Lwf_109
Lwd_110:
    s_mul_i32 s34, s26, 114688
    s_mul_i32 s28, s24, 14336
    s_add_u32 s34, s34, s28
    s_add_u32 s34, s34, 48234496
    s_add_u32 s35, s34, 57344
    buffer_load_dwordx4 v[64:67], v4, s[4:7], s34 offen offset:0 sc1
    buffer_load_dwordx4 v[68:71], v4, s[4:7], s35 offen offset:0 sc1
    buffer_load_dwordx4 v[72:75], v4, s[4:7], s34 offen offset:1024 sc1
    buffer_load_dwordx4 v[76:79], v4, s[4:7], s35 offen offset:1024 sc1
    buffer_load_dwordx4 v[80:83], v4, s[4:7], s34 offen offset:2048 sc1
    buffer_load_dwordx4 v[84:87], v4, s[4:7], s35 offen offset:2048 sc1
    buffer_load_dwordx4 v[88:91], v4, s[4:7], s34 offen offset:3072 sc1
    buffer_load_dwordx4 v[92:95], v4, s[4:7], s35 offen offset:3072 sc1
    s_add_u32 s34, s34, 4096
    s_add_u32 s35, s35, 4096
    buffer_load_dwordx4 v[96:99], v4, s[4:7], s34 offen offset:0 sc1
    buffer_load_dwordx4 v[100:103], v4, s[4:7], s35 offen offset:0 sc1
    s_waitcnt vmcnt(8)
    v_mfma_f32_16x16x32_bf16 v[8:11], a[0:3], v[64:67], 0
    v_mfma_f32_16x16x32_bf16 v[12:15], a[0:3], v[68:71], 0
    v_mfma_f32_16x16x32_bf16 v[16:19], a[56:59], v[64:67], 0
    v_mfma_f32_16x16x32_bf16 v[20:23], a[56:59], v[68:71], 0
    v_mfma_f32_16x16x32_bf16 v[24:27], a[112:115], v[64:67], 0
    v_mfma_f32_16x16x32_bf16 v[28:31], a[112:115], v[68:71], 0
    v_mfma_f32_16x16x32_bf16 v[32:35], a[168:171], v[64:67], 0
    v_mfma_f32_16x16x32_bf16 v[36:39], a[168:171], v[68:71], 0
    v_mfma_f32_16x16x32_bf16 v[40:43], a[224:227], v[64:67], 0
    v_mfma_f32_16x16x32_bf16 v[44:47], a[224:227], v[68:71], 0
    v_mfma_f32_16x16x32_bf16 v[48:51], v[144:147], v[64:67], 0
    v_mfma_f32_16x16x32_bf16 v[52:55], v[144:147], v[68:71], 0
    v_mfma_f32_16x16x32_bf16 v[56:59], v[200:203], v[64:67], 0
    v_mfma_f32_16x16x32_bf16 v[60:63], v[200:203], v[68:71], 0
    buffer_load_dwordx4 v[64:67], v4, s[4:7], s34 offen offset:1024 sc1
    buffer_load_dwordx4 v[68:71], v4, s[4:7], s35 offen offset:1024 sc1
    s_waitcnt vmcnt(8)
    v_mfma_f32_16x16x32_bf16 v[8:11], a[4:7], v[72:75], v[8:11]
    v_mfma_f32_16x16x32_bf16 v[12:15], a[4:7], v[76:79], v[12:15]
    v_mfma_f32_16x16x32_bf16 v[16:19], a[60:63], v[72:75], v[16:19]
    v_mfma_f32_16x16x32_bf16 v[20:23], a[60:63], v[76:79], v[20:23]
    v_mfma_f32_16x16x32_bf16 v[24:27], a[116:119], v[72:75], v[24:27]
    v_mfma_f32_16x16x32_bf16 v[28:31], a[116:119], v[76:79], v[28:31]
    v_mfma_f32_16x16x32_bf16 v[32:35], a[172:175], v[72:75], v[32:35]
    v_mfma_f32_16x16x32_bf16 v[36:39], a[172:175], v[76:79], v[36:39]
    v_mfma_f32_16x16x32_bf16 v[40:43], a[228:231], v[72:75], v[40:43]
    v_mfma_f32_16x16x32_bf16 v[44:47], a[228:231], v[76:79], v[44:47]
    v_mfma_f32_16x16x32_bf16 v[48:51], v[148:151], v[72:75], v[48:51]
    v_mfma_f32_16x16x32_bf16 v[52:55], v[148:151], v[76:79], v[52:55]
    v_mfma_f32_16x16x32_bf16 v[56:59], v[204:207], v[72:75], v[56:59]
    v_mfma_f32_16x16x32_bf16 v[60:63], v[204:207], v[76:79], v[60:63]
    buffer_load_dwordx4 v[72:75], v4, s[4:7], s34 offen offset:2048 sc1
    buffer_load_dwordx4 v[76:79], v4, s[4:7], s35 offen offset:2048 sc1
    s_waitcnt vmcnt(8)
    v_mfma_f32_16x16x32_bf16 v[8:11], a[8:11], v[80:83], v[8:11]
    v_mfma_f32_16x16x32_bf16 v[12:15], a[8:11], v[84:87], v[12:15]
    v_mfma_f32_16x16x32_bf16 v[16:19], a[64:67], v[80:83], v[16:19]
    v_mfma_f32_16x16x32_bf16 v[20:23], a[64:67], v[84:87], v[20:23]
    v_mfma_f32_16x16x32_bf16 v[24:27], a[120:123], v[80:83], v[24:27]
    v_mfma_f32_16x16x32_bf16 v[28:31], a[120:123], v[84:87], v[28:31]
    v_mfma_f32_16x16x32_bf16 v[32:35], a[176:179], v[80:83], v[32:35]
    v_mfma_f32_16x16x32_bf16 v[36:39], a[176:179], v[84:87], v[36:39]
    v_mfma_f32_16x16x32_bf16 v[40:43], a[232:235], v[80:83], v[40:43]
    v_mfma_f32_16x16x32_bf16 v[44:47], a[232:235], v[84:87], v[44:47]
    v_mfma_f32_16x16x32_bf16 v[48:51], v[152:155], v[80:83], v[48:51]
    v_mfma_f32_16x16x32_bf16 v[52:55], v[152:155], v[84:87], v[52:55]
    v_mfma_f32_16x16x32_bf16 v[56:59], v[208:211], v[80:83], v[56:59]
    v_mfma_f32_16x16x32_bf16 v[60:63], v[208:211], v[84:87], v[60:63]
    buffer_load_dwordx4 v[80:83], v4, s[4:7], s34 offen offset:3072 sc1
    buffer_load_dwordx4 v[84:87], v4, s[4:7], s35 offen offset:3072 sc1
    s_add_u32 s34, s34, 4096
    s_add_u32 s35, s35, 4096
    s_waitcnt vmcnt(8)
    v_mfma_f32_16x16x32_bf16 v[8:11], a[12:15], v[88:91], v[8:11]
    v_mfma_f32_16x16x32_bf16 v[12:15], a[12:15], v[92:95], v[12:15]
    v_mfma_f32_16x16x32_bf16 v[16:19], a[68:71], v[88:91], v[16:19]
    v_mfma_f32_16x16x32_bf16 v[20:23], a[68:71], v[92:95], v[20:23]
    v_mfma_f32_16x16x32_bf16 v[24:27], a[124:127], v[88:91], v[24:27]
    v_mfma_f32_16x16x32_bf16 v[28:31], a[124:127], v[92:95], v[28:31]
    v_mfma_f32_16x16x32_bf16 v[32:35], a[180:183], v[88:91], v[32:35]
    v_mfma_f32_16x16x32_bf16 v[36:39], a[180:183], v[92:95], v[36:39]
    v_mfma_f32_16x16x32_bf16 v[40:43], a[236:239], v[88:91], v[40:43]
    v_mfma_f32_16x16x32_bf16 v[44:47], a[236:239], v[92:95], v[44:47]
    v_mfma_f32_16x16x32_bf16 v[48:51], v[156:159], v[88:91], v[48:51]
    v_mfma_f32_16x16x32_bf16 v[52:55], v[156:159], v[92:95], v[52:55]
    v_mfma_f32_16x16x32_bf16 v[56:59], v[212:215], v[88:91], v[56:59]
    v_mfma_f32_16x16x32_bf16 v[60:63], v[212:215], v[92:95], v[60:63]
    buffer_load_dwordx4 v[88:91], v4, s[4:7], s34 offen offset:0 sc1
    buffer_load_dwordx4 v[92:95], v4, s[4:7], s35 offen offset:0 sc1
    s_waitcnt vmcnt(8)
    v_mfma_f32_16x16x32_bf16 v[8:11], a[16:19], v[96:99], v[8:11]
    v_mfma_f32_16x16x32_bf16 v[12:15], a[16:19], v[100:103], v[12:15]
    v_mfma_f32_16x16x32_bf16 v[16:19], a[72:75], v[96:99], v[16:19]
    v_mfma_f32_16x16x32_bf16 v[20:23], a[72:75], v[100:103], v[20:23]
    v_mfma_f32_16x16x32_bf16 v[24:27], a[128:131], v[96:99], v[24:27]
    v_mfma_f32_16x16x32_bf16 v[28:31], a[128:131], v[100:103], v[28:31]
    v_mfma_f32_16x16x32_bf16 v[32:35], a[184:187], v[96:99], v[32:35]
    v_mfma_f32_16x16x32_bf16 v[36:39], a[184:187], v[100:103], v[36:39]
    v_mfma_f32_16x16x32_bf16 v[40:43], a[240:243], v[96:99], v[40:43]
    v_mfma_f32_16x16x32_bf16 v[44:47], a[240:243], v[100:103], v[44:47]
    v_mfma_f32_16x16x32_bf16 v[48:51], v[160:163], v[96:99], v[48:51]
    v_mfma_f32_16x16x32_bf16 v[52:55], v[160:163], v[100:103], v[52:55]
    v_mfma_f32_16x16x32_bf16 v[56:59], v[216:219], v[96:99], v[56:59]
    v_mfma_f32_16x16x32_bf16 v[60:63], v[216:219], v[100:103], v[60:63]
    buffer_load_dwordx4 v[96:99], v4, s[4:7], s34 offen offset:1024 sc1
    buffer_load_dwordx4 v[100:103], v4, s[4:7], s35 offen offset:1024 sc1
    s_waitcnt vmcnt(8)
    v_mfma_f32_16x16x32_bf16 v[8:11], a[20:23], v[64:67], v[8:11]
    v_mfma_f32_16x16x32_bf16 v[12:15], a[20:23], v[68:71], v[12:15]
    v_mfma_f32_16x16x32_bf16 v[16:19], a[76:79], v[64:67], v[16:19]
    v_mfma_f32_16x16x32_bf16 v[20:23], a[76:79], v[68:71], v[20:23]
    v_mfma_f32_16x16x32_bf16 v[24:27], a[132:135], v[64:67], v[24:27]
    v_mfma_f32_16x16x32_bf16 v[28:31], a[132:135], v[68:71], v[28:31]
    v_mfma_f32_16x16x32_bf16 v[32:35], a[188:191], v[64:67], v[32:35]
    v_mfma_f32_16x16x32_bf16 v[36:39], a[188:191], v[68:71], v[36:39]
    v_mfma_f32_16x16x32_bf16 v[40:43], a[244:247], v[64:67], v[40:43]
    v_mfma_f32_16x16x32_bf16 v[44:47], a[244:247], v[68:71], v[44:47]
    v_mfma_f32_16x16x32_bf16 v[48:51], v[164:167], v[64:67], v[48:51]
    v_mfma_f32_16x16x32_bf16 v[52:55], v[164:167], v[68:71], v[52:55]
    v_mfma_f32_16x16x32_bf16 v[56:59], v[220:223], v[64:67], v[56:59]
    v_mfma_f32_16x16x32_bf16 v[60:63], v[220:223], v[68:71], v[60:63]
    buffer_load_dwordx4 v[64:67], v4, s[4:7], s34 offen offset:2048 sc1
    buffer_load_dwordx4 v[68:71], v4, s[4:7], s35 offen offset:2048 sc1
    s_waitcnt vmcnt(8)
    v_mfma_f32_16x16x32_bf16 v[8:11], a[24:27], v[72:75], v[8:11]
    v_mfma_f32_16x16x32_bf16 v[12:15], a[24:27], v[76:79], v[12:15]
    v_mfma_f32_16x16x32_bf16 v[16:19], a[80:83], v[72:75], v[16:19]
    v_mfma_f32_16x16x32_bf16 v[20:23], a[80:83], v[76:79], v[20:23]
    v_mfma_f32_16x16x32_bf16 v[24:27], a[136:139], v[72:75], v[24:27]
    v_mfma_f32_16x16x32_bf16 v[28:31], a[136:139], v[76:79], v[28:31]
    v_mfma_f32_16x16x32_bf16 v[32:35], a[192:195], v[72:75], v[32:35]
    v_mfma_f32_16x16x32_bf16 v[36:39], a[192:195], v[76:79], v[36:39]
    v_mfma_f32_16x16x32_bf16 v[40:43], a[248:251], v[72:75], v[40:43]
    v_mfma_f32_16x16x32_bf16 v[44:47], a[248:251], v[76:79], v[44:47]
    v_mfma_f32_16x16x32_bf16 v[48:51], v[168:171], v[72:75], v[48:51]
    v_mfma_f32_16x16x32_bf16 v[52:55], v[168:171], v[76:79], v[52:55]
    v_mfma_f32_16x16x32_bf16 v[56:59], v[224:227], v[72:75], v[56:59]
    v_mfma_f32_16x16x32_bf16 v[60:63], v[224:227], v[76:79], v[60:63]
    buffer_load_dwordx4 v[72:75], v4, s[4:7], s34 offen offset:3072 sc1
    buffer_load_dwordx4 v[76:79], v4, s[4:7], s35 offen offset:3072 sc1
    s_add_u32 s34, s34, 4096
    s_add_u32 s35, s35, 4096
    s_waitcnt vmcnt(8)
    v_mfma_f32_16x16x32_bf16 v[8:11], a[28:31], v[80:83], v[8:11]
    v_mfma_f32_16x16x32_bf16 v[12:15], a[28:31], v[84:87], v[12:15]
    v_mfma_f32_16x16x32_bf16 v[16:19], a[84:87], v[80:83], v[16:19]
    v_mfma_f32_16x16x32_bf16 v[20:23], a[84:87], v[84:87], v[20:23]
    v_mfma_f32_16x16x32_bf16 v[24:27], a[140:143], v[80:83], v[24:27]
    v_mfma_f32_16x16x32_bf16 v[28:31], a[140:143], v[84:87], v[28:31]
    v_mfma_f32_16x16x32_bf16 v[32:35], a[196:199], v[80:83], v[32:35]
    v_mfma_f32_16x16x32_bf16 v[36:39], a[196:199], v[84:87], v[36:39]
    v_mfma_f32_16x16x32_bf16 v[40:43], a[252:255], v[80:83], v[40:43]
    v_mfma_f32_16x16x32_bf16 v[44:47], a[252:255], v[84:87], v[44:47]
    v_mfma_f32_16x16x32_bf16 v[48:51], v[172:175], v[80:83], v[48:51]
    v_mfma_f32_16x16x32_bf16 v[52:55], v[172:175], v[84:87], v[52:55]
    v_mfma_f32_16x16x32_bf16 v[56:59], v[228:231], v[80:83], v[56:59]
    v_mfma_f32_16x16x32_bf16 v[60:63], v[228:231], v[84:87], v[60:63]
    buffer_load_dwordx4 v[80:83], v4, s[4:7], s34 offen offset:0 sc1
    buffer_load_dwordx4 v[84:87], v4, s[4:7], s35 offen offset:0 sc1
    s_waitcnt vmcnt(8)
    v_mfma_f32_16x16x32_bf16 v[8:11], a[32:35], v[88:91], v[8:11]
    v_mfma_f32_16x16x32_bf16 v[12:15], a[32:35], v[92:95], v[12:15]
    v_mfma_f32_16x16x32_bf16 v[16:19], a[88:91], v[88:91], v[16:19]
    v_mfma_f32_16x16x32_bf16 v[20:23], a[88:91], v[92:95], v[20:23]
    v_mfma_f32_16x16x32_bf16 v[24:27], a[144:147], v[88:91], v[24:27]
    v_mfma_f32_16x16x32_bf16 v[28:31], a[144:147], v[92:95], v[28:31]
    v_mfma_f32_16x16x32_bf16 v[32:35], a[200:203], v[88:91], v[32:35]
    v_mfma_f32_16x16x32_bf16 v[36:39], a[200:203], v[92:95], v[36:39]
    v_mfma_f32_16x16x32_bf16 v[40:43], v[120:123], v[88:91], v[40:43]
    v_mfma_f32_16x16x32_bf16 v[44:47], v[120:123], v[92:95], v[44:47]
    v_mfma_f32_16x16x32_bf16 v[48:51], v[176:179], v[88:91], v[48:51]
    v_mfma_f32_16x16x32_bf16 v[52:55], v[176:179], v[92:95], v[52:55]
    v_mfma_f32_16x16x32_bf16 v[56:59], v[232:235], v[88:91], v[56:59]
    v_mfma_f32_16x16x32_bf16 v[60:63], v[232:235], v[92:95], v[60:63]
    buffer_load_dwordx4 v[88:91], v4, s[4:7], s34 offen offset:1024 sc1
    buffer_load_dwordx4 v[92:95], v4, s[4:7], s35 offen offset:1024 sc1
    s_waitcnt vmcnt(8)
    v_mfma_f32_16x16x32_bf16 v[8:11], a[36:39], v[96:99], v[8:11]
    v_mfma_f32_16x16x32_bf16 v[12:15], a[36:39], v[100:103], v[12:15]
    v_mfma_f32_16x16x32_bf16 v[16:19], a[92:95], v[96:99], v[16:19]
    v_mfma_f32_16x16x32_bf16 v[20:23], a[92:95], v[100:103], v[20:23]
    v_mfma_f32_16x16x32_bf16 v[24:27], a[148:151], v[96:99], v[24:27]
    v_mfma_f32_16x16x32_bf16 v[28:31], a[148:151], v[100:103], v[28:31]
    v_mfma_f32_16x16x32_bf16 v[32:35], a[204:207], v[96:99], v[32:35]
    v_mfma_f32_16x16x32_bf16 v[36:39], a[204:207], v[100:103], v[36:39]
    v_mfma_f32_16x16x32_bf16 v[40:43], v[124:127], v[96:99], v[40:43]
    v_mfma_f32_16x16x32_bf16 v[44:47], v[124:127], v[100:103], v[44:47]
    v_mfma_f32_16x16x32_bf16 v[48:51], v[180:183], v[96:99], v[48:51]
    v_mfma_f32_16x16x32_bf16 v[52:55], v[180:183], v[100:103], v[52:55]
    v_mfma_f32_16x16x32_bf16 v[56:59], v[236:239], v[96:99], v[56:59]
    v_mfma_f32_16x16x32_bf16 v[60:63], v[236:239], v[100:103], v[60:63]
    s_waitcnt vmcnt(6)
    v_mfma_f32_16x16x32_bf16 v[8:11], a[40:43], v[64:67], v[8:11]
    v_mfma_f32_16x16x32_bf16 v[12:15], a[40:43], v[68:71], v[12:15]
    v_mfma_f32_16x16x32_bf16 v[16:19], a[96:99], v[64:67], v[16:19]
    v_mfma_f32_16x16x32_bf16 v[20:23], a[96:99], v[68:71], v[20:23]
    v_mfma_f32_16x16x32_bf16 v[24:27], a[152:155], v[64:67], v[24:27]
    v_mfma_f32_16x16x32_bf16 v[28:31], a[152:155], v[68:71], v[28:31]
    v_mfma_f32_16x16x32_bf16 v[32:35], a[208:211], v[64:67], v[32:35]
    v_mfma_f32_16x16x32_bf16 v[36:39], a[208:211], v[68:71], v[36:39]
    v_mfma_f32_16x16x32_bf16 v[40:43], v[128:131], v[64:67], v[40:43]
    v_mfma_f32_16x16x32_bf16 v[44:47], v[128:131], v[68:71], v[44:47]
    v_mfma_f32_16x16x32_bf16 v[48:51], v[184:187], v[64:67], v[48:51]
    v_mfma_f32_16x16x32_bf16 v[52:55], v[184:187], v[68:71], v[52:55]
    v_mfma_f32_16x16x32_bf16 v[56:59], v[240:243], v[64:67], v[56:59]
    v_mfma_f32_16x16x32_bf16 v[60:63], v[240:243], v[68:71], v[60:63]
    s_waitcnt vmcnt(4)
    v_mfma_f32_16x16x32_bf16 v[8:11], a[44:47], v[72:75], v[8:11]
    v_mfma_f32_16x16x32_bf16 v[12:15], a[44:47], v[76:79], v[12:15]
    v_mfma_f32_16x16x32_bf16 v[16:19], a[100:103], v[72:75], v[16:19]
    v_mfma_f32_16x16x32_bf16 v[20:23], a[100:103], v[76:79], v[20:23]
    v_mfma_f32_16x16x32_bf16 v[24:27], a[156:159], v[72:75], v[24:27]
    v_mfma_f32_16x16x32_bf16 v[28:31], a[156:159], v[76:79], v[28:31]
    v_mfma_f32_16x16x32_bf16 v[32:35], a[212:215], v[72:75], v[32:35]
    v_mfma_f32_16x16x32_bf16 v[36:39], a[212:215], v[76:79], v[36:39]
    v_mfma_f32_16x16x32_bf16 v[40:43], v[132:135], v[72:75], v[40:43]
    v_mfma_f32_16x16x32_bf16 v[44:47], v[132:135], v[76:79], v[44:47]
    v_mfma_f32_16x16x32_bf16 v[48:51], v[188:191], v[72:75], v[48:51]
    v_mfma_f32_16x16x32_bf16 v[52:55], v[188:191], v[76:79], v[52:55]
    v_mfma_f32_16x16x32_bf16 v[56:59], v[244:247], v[72:75], v[56:59]
    v_mfma_f32_16x16x32_bf16 v[60:63], v[244:247], v[76:79], v[60:63]
    s_waitcnt vmcnt(2)
    v_mfma_f32_16x16x32_bf16 v[8:11], a[48:51], v[80:83], v[8:11]
    v_mfma_f32_16x16x32_bf16 v[12:15], a[48:51], v[84:87], v[12:15]
    v_mfma_f32_16x16x32_bf16 v[16:19], a[104:107], v[80:83], v[16:19]
    v_mfma_f32_16x16x32_bf16 v[20:23], a[104:107], v[84:87], v[20:23]
    v_mfma_f32_16x16x32_bf16 v[24:27], a[160:163], v[80:83], v[24:27]
    v_mfma_f32_16x16x32_bf16 v[28:31], a[160:163], v[84:87], v[28:31]
    v_mfma_f32_16x16x32_bf16 v[32:35], a[216:219], v[80:83], v[32:35]
    v_mfma_f32_16x16x32_bf16 v[36:39], a[216:219], v[84:87], v[36:39]
    v_mfma_f32_16x16x32_bf16 v[40:43], v[136:139], v[80:83], v[40:43]
    v_mfma_f32_16x16x32_bf16 v[44:47], v[136:139], v[84:87], v[44:47]
    v_mfma_f32_16x16x32_bf16 v[48:51], v[192:195], v[80:83], v[48:51]
    v_mfma_f32_16x16x32_bf16 v[52:55], v[192:195], v[84:87], v[52:55]
    v_mfma_f32_16x16x32_bf16 v[56:59], v[248:251], v[80:83], v[56:59]
    v_mfma_f32_16x16x32_bf16 v[60:63], v[248:251], v[84:87], v[60:63]
    s_waitcnt vmcnt(0)
    v_mfma_f32_16x16x32_bf16 v[8:11], a[52:55], v[88:91], v[8:11]
    v_mfma_f32_16x16x32_bf16 v[12:15], a[52:55], v[92:95], v[12:15]
    v_mfma_f32_16x16x32_bf16 v[16:19], a[108:111], v[88:91], v[16:19]
    v_mfma_f32_16x16x32_bf16 v[20:23], a[108:111], v[92:95], v[20:23]
    v_mfma_f32_16x16x32_bf16 v[24:27], a[164:167], v[88:91], v[24:27]
    v_mfma_f32_16x16x32_bf16 v[28:31], a[164:167], v[92:95], v[28:31]
    v_mfma_f32_16x16x32_bf16 v[32:35], a[220:223], v[88:91], v[32:35]
    v_mfma_f32_16x16x32_bf16 v[36:39], a[220:223], v[92:95], v[36:39]
    v_mfma_f32_16x16x32_bf16 v[40:43], v[140:143], v[88:91], v[40:43]
    v_mfma_f32_16x16x32_bf16 v[44:47], v[140:143], v[92:95], v[44:47]
    v_mfma_f32_16x16x32_bf16 v[48:51], v[196:199], v[88:91], v[48:51]
    v_mfma_f32_16x16x32_bf16 v[52:55], v[196:199], v[92:95], v[52:55]
    v_mfma_f32_16x16x32_bf16 v[56:59], v[252:255], v[88:91], v[56:59]
    v_mfma_f32_16x16x32_bf16 v[60:63], v[252:255], v[92:95], v[60:63]
    s_nop 7
    s_barrier
    ds_write_b128 v105, v[8:11] offset:0
    ds_write_b128 v105, v[12:15] offset:7424
    ds_write_b128 v105, v[16:19] offset:64
    ds_write_b128 v105, v[20:23] offset:7488
    ds_write_b128 v105, v[24:27] offset:128
    ds_write_b128 v105, v[28:31] offset:7552
    ds_write_b128 v105, v[32:35] offset:192
    ds_write_b128 v105, v[36:39] offset:7616
    ds_write_b128 v105, v[40:43] offset:256
    ds_write_b128 v105, v[44:47] offset:7680
    ds_write_b128 v105, v[48:51] offset:320
    ds_write_b128 v105, v[52:55] offset:7744
    ds_write_b128 v105, v[56:59] offset:384
    ds_write_b128 v105, v[60:63] offset:7808
    s_waitcnt lgkmcnt(0)
    s_barrier
    s_mul_i32 s37, s26, 28672
    s_mul_i32 s28, s30, 224
    s_add_u32 s37, s37, s28
    s_add_u32 s37, s37, 67108864
    ds_read_b128 v[8:11], v106 offset:0
    ds_read_b128 v[12:15], v106 offset:16
    ds_read_b128 v[16:19], v106 offset:14848
    ds_read_b128 v[20:23], v106 offset:14864
    ds_read_b128 v[24:27], v106 offset:29696
    ds_read_b128 v[28:31], v106 offset:29712
    ds_read_b128 v[32:35], v106 offset:44544
    ds_read_b128 v[36:39], v106 offset:44560
    s_waitcnt lgkmcnt(0)
    v_pk_add_f32 v[8:9], v[8:9], v[16:17]
    v_pk_add_f32 v[24:25], v[24:25], v[32:33]
    v_pk_add_f32 v[8:9], v[8:9], v[24:25]
    v_pk_add_f32 v[10:11], v[10:11], v[18:19]
    v_pk_add_f32 v[26:27], v[26:27], v[34:35]
    v_pk_add_f32 v[10:11], v[10:11], v[26:27]
    v_pk_add_f32 v[12:13], v[12:13], v[20:21]
    v_pk_add_f32 v[28:29], v[28:29], v[36:37]
    v_pk_add_f32 v[12:13], v[12:13], v[28:29]
    v_pk_add_f32 v[14:15], v[14:15], v[22:23]
    v_pk_add_f32 v[30:31], v[30:31], v[38:39]
    v_pk_add_f32 v[14:15], v[14:15], v[30:31]
    v_cvt_pk_bf16_f32 v40, v8, v9
    v_lshlrev_b32 v41, 16, v40
    v_and_b32 v42, 0xffff0000, v40
    v_lshlrev_b32 v43, 16, v108
    v_and_b32 v44, 0xffff0000, v108
    v_add_f32 v41, v41, v43
    v_add_f32 v42, v42, v44
    v_cvt_pk_bf16_f32 v48, v41, v42
    v_cvt_pk_bf16_f32 v40, v10, v11
    v_lshlrev_b32 v41, 16, v40
    v_and_b32 v42, 0xffff0000, v40
    v_lshlrev_b32 v43, 16, v109
    v_and_b32 v44, 0xffff0000, v109
    v_add_f32 v41, v41, v43
    v_add_f32 v42, v42, v44
    v_cvt_pk_bf16_f32 v49, v41, v42
    v_cvt_pk_bf16_f32 v40, v12, v13
    v_lshlrev_b32 v41, 16, v40
    v_and_b32 v42, 0xffff0000, v40
    v_lshlrev_b32 v43, 16, v110
    v_and_b32 v44, 0xffff0000, v110
    v_add_f32 v41, v41, v43
    v_add_f32 v42, v42, v44
    v_cvt_pk_bf16_f32 v50, v41, v42
    v_cvt_pk_bf16_f32 v40, v14, v15
    v_lshlrev_b32 v41, 16, v40
    v_and_b32 v42, 0xffff0000, v40
    v_lshlrev_b32 v43, 16, v111
    v_and_b32 v44, 0xffff0000, v111
    v_add_f32 v41, v41, v43
    v_add_f32 v42, v42, v44
    v_cvt_pk_bf16_f32 v51, v41, v42
    s_mov_b64 exec, s[62:63]
    buffer_store_dwordx4 v[48:51], v107, s[4:7], s37 offen sc1
    s_mov_b64 exec, -1
    s_add_u32 s37, s37, 14336
    ds_read_b128 v[8:11], v106 offset:7424
    ds_read_b128 v[12:15], v106 offset:7440
    ds_read_b128 v[16:19], v106 offset:22272
    ds_read_b128 v[20:23], v106 offset:22288
    ds_read_b128 v[24:27], v106 offset:37120
    ds_read_b128 v[28:31], v106 offset:37136
    ds_read_b128 v[32:35], v106 offset:51968
    ds_read_b128 v[36:39], v106 offset:51984
    s_waitcnt lgkmcnt(0)
    v_pk_add_f32 v[8:9], v[8:9], v[16:17]
    v_pk_add_f32 v[24:25], v[24:25], v[32:33]
    v_pk_add_f32 v[8:9], v[8:9], v[24:25]
    v_pk_add_f32 v[10:11], v[10:11], v[18:19]
    v_pk_add_f32 v[26:27], v[26:27], v[34:35]
    v_pk_add_f32 v[10:11], v[10:11], v[26:27]
    v_pk_add_f32 v[12:13], v[12:13], v[20:21]
    v_pk_add_f32 v[28:29], v[28:29], v[36:37]
    v_pk_add_f32 v[12:13], v[12:13], v[28:29]
    v_pk_add_f32 v[14:15], v[14:15], v[22:23]
    v_pk_add_f32 v[30:31], v[30:31], v[38:39]
    v_pk_add_f32 v[14:15], v[14:15], v[30:31]
    v_cvt_pk_bf16_f32 v40, v8, v9
    v_lshlrev_b32 v41, 16, v40
    v_and_b32 v42, 0xffff0000, v40
    v_lshlrev_b32 v43, 16, v108
    v_and_b32 v44, 0xffff0000, v108
    v_add_f32 v41, v41, v43
    v_add_f32 v42, v42, v44
    v_cvt_pk_bf16_f32 v52, v41, v42
    v_cvt_pk_bf16_f32 v40, v10, v11
    v_lshlrev_b32 v41, 16, v40
    v_and_b32 v42, 0xffff0000, v40
    v_lshlrev_b32 v43, 16, v109
    v_and_b32 v44, 0xffff0000, v109
    v_add_f32 v41, v41, v43
    v_add_f32 v42, v42, v44
    v_cvt_pk_bf16_f32 v53, v41, v42
    v_cvt_pk_bf16_f32 v40, v12, v13
    v_lshlrev_b32 v41, 16, v40
    v_and_b32 v42, 0xffff0000, v40
    v_lshlrev_b32 v43, 16, v110
    v_and_b32 v44, 0xffff0000, v110
    v_add_f32 v41, v41, v43
    v_add_f32 v42, v42, v44
    v_cvt_pk_bf16_f32 v54, v41, v42
    v_cvt_pk_bf16_f32 v40, v14, v15
    v_lshlrev_b32 v41, 16, v40
    v_and_b32 v42, 0xffff0000, v40
    v_lshlrev_b32 v43, 16, v111
    v_and_b32 v44, 0xffff0000, v111
    v_add_f32 v41, v41, v43
    v_add_f32 v42, v42, v44
    v_cvt_pk_bf16_f32 v55, v41, v42
    s_mov_b64 exec, s[62:63]
    buffer_store_dwordx4 v[52:55], v107, s[4:7], s37 offen sc1
    s_mov_b64 exec, -1
    s_add_u32 s37, s37, 14336
    s_lshl_b32 s28, s30, 7
    s_add_u32 s33, s32, s28
    s_lshl_b32 s28, s24, 2
    s_add_u32 s33, s33, s28
    s_add_u32 s33, s33, 6656
    s_waitcnt vmcnt(0)
    s_mov_b64 exec, 1
    buffer_store_dword v117, v116, s[4:7], s33 offen sc1
    s_mov_b64 exec, -1
    s_add_u32 s26, s26, 6
    s_cmp_lt_u32 s26, 64
    s_cbranch_scc1 K2_W2_loop
K2_end:
K2_exit:
    s_endpgm
.section .rodata,"a"
.p2align 6
.amdhsa_kernel parallel_sum__memory_aug_recurrent_mem_tr__dense_activation_squared_relu__prompt_kernel
  .amdhsa_next_free_vgpr 512
  .amdhsa_next_free_sgpr 102
  .amdhsa_accum_offset 256
  .amdhsa_group_segment_fixed_size 0
  .amdhsa_kernarg_size 120
  .amdhsa_user_sgpr_count 2
  .amdhsa_user_sgpr_kernarg_segment_ptr 1
  .amdhsa_system_sgpr_workgroup_id_x 1
.end_amdhsa_kernel
.text
```
